```python
import torch

def _softmax(x, axis=-1):
    return torch.softmax(x, dim=axis)

def _gelu(x):
    return torch.nn.functional.gelu(x, approximate='tanh')

def _silu(x):
    return torch.nn.functional.silu(x)

def _sigmoid(x):
    return torch.sigmoid(x)

def _layernorm(x, axis=-1, eps=1e-05):
    m = x.mean(dim=axis, keepdim=True)
    v = x.var(dim=axis, keepdim=True, unbiased=False)
    return (x - m) / torch.sqrt(v + eps)

def _scatter_add(tgt, idx, src, axis=0):
    return tgt.clone().index_add_(axis, idx, src)

def _segment_sum(src, seg, n):
    out = torch.zeros((n,) + src.shape[1:], dtype=src.dtype)
    return out.index_add_(0, seg, src)

def _pad(x, pw):
    flat = tuple((v for pair in reversed(pw) for v in pair))
    return torch.nn.functional.pad(x, flat)
kernel_name = 'adaLN_cond__grouped_kv_mqa__glu_gated_reglu__prompt'

def setup_inputs():

    _w = lambda a: (lambda t: t.to(torch.bfloat16) if t.is_floating_point() else t)(torch.as_tensor(a))

    def _A_setup():
        B, S, D, H = (1, 2048, 512, 32)
        Dh = D // H
        return {'x': _w((lambda *s: torch.randn(*s, dtype=torch.bfloat16) * 0.05)(B, S, D)), 'wq': _w((lambda *s: torch.randn(*s, dtype=torch.bfloat16) * 0.05)(D, H * Dh)), 'wk': _w((lambda *s: torch.randn(*s, dtype=torch.bfloat16) * 0.05)(D, Dh)), 'wv': _w((lambda *s: torch.randn(*s, dtype=torch.bfloat16) * 0.05)(D, Dh)), 'wo': _w((lambda *s: torch.randn(*s, dtype=torch.bfloat16) * 0.05)(H * Dh, D))}
    _A_in = _A_setup()

    def _B_setup():
        B, S, D, F = (1, 2048, 512, 1376)
        return {'x': _w((lambda *s: torch.randn(*s, dtype=torch.bfloat16) * 0.05)(B, S, D)), 'W_gate': _w((lambda *s: torch.randn(*s, dtype=torch.bfloat16) * 0.8)(D, F) * (2.0 / D) ** 0.5), 'W_up': _w((lambda *s: torch.randn(*s, dtype=torch.bfloat16) * 0.8)(D, F) * (2.0 / D) ** 0.5), 'W_down': _w((lambda *s: torch.randn(*s, dtype=torch.bfloat16) * 0.8)(F, D) * (1.0 / F) ** 0.5)}
    _B_in = _B_setup()
    return {'A_x': _A_in['x'], 'A_wq': _A_in['wq'], 'A_wk': _A_in['wk'], 'A_wv': _A_in['wv'], 'A_wo': _A_in['wo'], 'B_x': _B_in['x'], 'B_W_gate': _B_in['W_gate'], 'B_W_up': _B_in['W_up'], 'B_W_down': _B_in['W_down'], 'c': _w((lambda *s: torch.randn(*s, dtype=torch.bfloat16) * 0.2)(1, 512) * 8.0), 'w_mod': _w((lambda *s: torch.randn(*s, dtype=torch.bfloat16) * 0.2)(512, 6 * 512) * 512 ** (-0.5) * 8.0)}

def reference(A_x, A_wq, A_wk, A_wv, A_wo, B_x, B_W_gate, B_W_up, B_W_down, c, w_mod):

    def _A_ref(x, wq, wk, wv, wo):
        B, S, D = x.shape
        H = 32
        Dh = D // H
        q = (lambda x, *d: x.permute(*d))((x @ wq).reshape(B, S, H, Dh), 0, 2, 1, 3)
        k = x @ wk
        v = x @ wv
        scores = torch.einsum('bhqd,bkd->bhqk', q, k) * Dh ** (-0.5)
        p = _softmax(scores, axis=-1)
        o = torch.einsum('bhqk,bkd->bhqd', p, v)
        return (lambda x, *d: x.permute(*d))(o, 0, 2, 1, 3).reshape(B, S, H * Dh) @ wo

    def _B_ref(x, W_gate, W_up, W_down):
        gate = torch.einsum('bsd,df->bsf', x, W_gate)
        up = torch.einsum('bsd,df->bsf', x, W_up)
        gate = gate * (lambda x, dt: x.to(dt))(gate > 0, gate.dtype)
        h = gate * up
        return torch.einsum('bsf,fd->bsd', h, W_down)
    x = A_x
    mod = (_silu(c) @ w_mod).reshape(c.shape[0], 6, 1, -1)
    sa, ca, ga, sb, cb, gb = (mod[:, 0].clone(), mod[:, 1].clone(), mod[:, 2].clone(), mod[:, 3].clone(), mod[:, 4].clone(), mod[:, 5].clone())
    h = _layernorm(x, axis=-1) * (1 + ca) + sa
    x = x + ga * _A_ref(h, A_wq, A_wk, A_wv, A_wo)
    h = _layernorm(x, axis=-1) * (1 + cb) + sb
    x = x + gb * _B_ref(h, B_W_gate, B_W_up, B_W_down)
    return x
```

```asm
; @launch grid=(256,1,1) block=(512,1,1) lds=163840
.amdgcn_target "amdgcn-amd-amdhsa--gfx950"
.text
.globl adaLN_cond__grouped_kv_mqa__glu_gated_reglu__prompt_kernel
.p2align 8
.type adaLN_cond__grouped_kv_mqa__glu_gated_reglu__prompt_kernel,@function
adaLN_cond__grouped_kv_mqa__glu_gated_reglu__prompt_kernel:
    s_load_dwordx2 s[32:33], s[0:1], 72
    s_load_dwordx2 s[36:37], s[0:1], 80
    s_load_dwordx2 s[44:45], s[0:1], 104
    s_load_dwordx2 s[4:5], s[0:1], 0
    s_load_dwordx2 s[8:9], s[0:1], 8
    s_cmp_ge_u32 s2, 256
    s_cbranch_scc1 L_end
    v_lshrrev_b32 v1, 6, v0
    v_and_b32 v0, 63, v0
    v_readfirstlane_b32 s50, v1
    s_lshr_b32 s49, s2, 3
    s_cmp_lg_u32 s50, 1
    s_cbranch_scc1 L_nopf_1
    s_min_u32 s68, s49, (L_end-L_pc0)/2048
    s_getpc_b64 s[74:75]
L_pc0:
    s_lshl_b32 s68, s68, 11
    v_lshl_add_u32 v2, v0, 5, s68
    global_load_dword v255, v2, s[74:75]
L_nopf_1:
    s_and_b32 s48, s2, 7
    s_lshr_b32 s51, s49, 2
    s_and_b32 s52, s49, 3
    s_mov_b32 s34, 1024
    s_mov_b32 s35, 0x20000
    s_mov_b32 s38, 3145728
    s_mov_b32 s39, 0x20000
    s_mov_b32 s46, 268435456
    s_mov_b32 s47, 0x20000
    v_lshrrev_b32 v247, 1, v0
    v_mul_u32_u24 v247, 6144, v247
    v_and_b32 v248, 1, v0
    v_lshl_add_u32 v4, v248, 4, v247
    s_lshl_b32 s68, s48, 3
    s_add_u32 s71, s68, s51
    s_and_b32 s72, s71, 3
    s_and_b32 s70, s71, 0x3c
    s_add_u32 s70, s70, s52
    s_mul_i32 s73, s72, 786432
    s_lshl_b32 s69, s70, 5
    s_add_u32 s73, s73, s69
    s_lshl_b32 s74, s72, 8
    v_lshlrev_b32 v120, 2, v0
    s_cmp_lg_u32 s50, 0
    s_waitcnt lgkmcnt(0)
    s_cbranch_scc1 L_nw0a
    s_setprio 3
    buffer_load_dword v250, v120, s[32:35], s74 offen
    s_mov_b32 m0, 147456
    s_nop 0
    buffer_load_dwordx4 v4, s[36:39], s73 offen  lds
    s_mov_b32 m0, 148480
    s_add_u32 s75, s73, 196608
    buffer_load_dwordx4 v4, s[36:39], s75 offen  lds
    s_mov_b32 m0, 149504
    s_add_u32 s75, s73, 393216
    buffer_load_dwordx4 v4, s[36:39], s75 offen  lds
    s_mov_b32 m0, 150528
    s_add_u32 s75, s73, 589824
    buffer_load_dwordx4 v4, s[36:39], s75 offen  lds
L_nw0a:
    buffer_load_dword v249, off, s[44:47], 0 sc1
    s_and_b32 s68, s49, 1
    s_lshl_b32 s68, s68, 3
    s_add_u32 s68, s68, 16
    s_load_dwordx2 s[12:13], s[0:1], s68
    s_load_dwordx2 s[16:17], s[0:1], 32
    s_load_dwordx2 s[20:21], s[0:1], 48
    s_load_dwordx2 s[24:25], s[0:1], 56
    s_load_dwordx2 s[28:29], s[0:1], 64
    s_load_dwordx2 s[40:41], s[0:1], 88
    s_lshl_b32 s72, s72, 12
    s_lshl_b32 s70, s70, 6
    s_add_u32 s72, s72, s70
    s_add_u32 s72, s72, 4096
    s_lshl_b32 s68, s71, 11
    s_and_b32 s69, s52, 1
    s_lshl_b32 s69, s69, 10
    s_add_u32 s68, s68, s69
    s_lshr_b32 s69, s52, 1
    s_lshl_b32 s69, s69, 9
    s_add_u32 s68, s68, s69
    s_add_u32 s79, s68, 262144
    s_cmp_eq_u32 s50, 0
    s_cselect_b32 s68, s79, 1073741824
    v_mov_b32 v122, -1
    v_mov_b32 v123, -1
    v_lshlrev_b32 v121, 3, v0
    buffer_store_dwordx2 v[122:123], v121, s[44:47], s68 offen sc1
    s_lshr_b32 s53, s49, 3
    s_and_b32 s54, s49, 7
    s_and_b32 s55, s50, 3
    s_lshr_b32 s56, s50, 2
    s_mov_b32 s6, 2097152
    s_mov_b32 s7, 0x20000
    s_mov_b32 s10, 524288
    s_mov_b32 s11, 0x20000
    s_mov_b32 s14, 16384
    s_mov_b32 s15, 0x20000
    s_mov_b32 s18, 524288
    s_mov_b32 s19, 0x20000
    s_mov_b32 s22, 1409024
    s_mov_b32 s23, 0x20000
    s_mov_b32 s26, 1409024
    s_mov_b32 s27, 0x20000
    s_mov_b32 s30, 1409024
    s_mov_b32 s31, 0x20000
    s_mov_b32 s42, 2097152
    s_mov_b32 s43, 0x20000
    s_mov_b32 s62, 60000
    s_mov_b32 s66, 0xffff
    s_mov_b32 s67, 0xffff
    v_lshlrev_b32 v38, 4, v0
    s_mul_i32 s68, s52, 9
    s_and_b32 s68, s68, 17
    s_lshl_b32 s69, s50, 1
    s_xor_b32 s63, s68, s69
    s_lshl_b32 s68, s71, 5
    s_add_u32 s68, s68, s63
    s_lshl_b32 s80, s68, 10
    s_xor_b32 s81, s80, 1024
    s_xor_b32 s82, s80, 16384
    s_xor_b32 s83, s80, 17408
    v_lshrrev_b32 v247, 4, v0
    v_lshlrev_b32 v248, 2, v247
    v_xor_b32 v248, v248, v0
    v_and_b32 v248, 15, v248
    v_lshlrev_b32 v248, 4, v248
    v_lshl_add_u32 v246, v247, 10, v248
    s_lshl_b32 s68, s52, 8
    v_add_u32 v246, s68, v246
    s_lshl_b32 s77, s50, 11
    s_lshl_b32 s78, s50, 13
    s_lshl_b32 s68, s51, 16
    s_add_u32 s78, s78, s68
    s_lshl_b32 s73, s51, 11
    s_waitcnt lgkmcnt(0)
    buffer_load_dwordx4 v[40:43], v38, s[4:7], s80 offen
    s_cmp_lg_u32 s50, 2
    s_cbranch_scc1 L_n2_2
    s_lshl_b32 s68, s2, 11
    v_lshlrev_b32 v254, 5, v0
    buffer_load_dword v255, v254, s[8:11], s68 offen
    s_lshr_b32 s68, s49, 1
    s_lshl_b32 s68, s68, 3
    s_add_u32 s68, s68, s48
    s_lshl_b32 s68, s68, 7
    buffer_load_dword v255, off, s[12:15], s68
L_n2_2:
    buffer_load_dwordx4 v[44:47], v38, s[4:7], s81 offen
    v_and_b32 v24, 15, v0
    v_lshlrev_b32 v24, 4, v24
    v_lshrrev_b32 v25, 5, v0
    v_lshl_add_u32 v25, v25, 8, v24
    v_bfe_u32 v26, v0, 4, 1
    v_lshl_add_u32 v1, v26, 9, v25
    s_lshl_b32 s68, s56, 11
    v_add_u32 v37, s68, v1
    s_lshl_b32 s68, s50, 10
    v_add_u32 v36, s68, v38
    v_mov_b32 v2, 0xdddddddd
    s_lshl_b32 s68, s48, 3
    s_add_u32 s68, s68, s51
    s_lshl_b32 s68, s68, 15
    s_lshl_b32 s69, s52, 2
    s_add_u32 s69, s69, s55
    s_lshl_b32 s69, s69, 1
    s_add_u32 s69, s69, s56
    s_lshl_b32 s69, s69, 10
    s_add_u32 s68, s68, s69
    s_add_u32 s68, s68, 2097152
    v_add_u32 v3, s68, v38
    s_lshl_b32 s68, s48, 2
    s_add_u32 s68, s68, s55
    s_lshl_b32 s68, s68, 1
    s_add_u32 s68, s68, s56
    s_mul_i32 s68, s68, 88064
    s_mul_i32 s69, s49, 3072
    s_add_u32 s68, s68, s69
    s_add_u32 s68, s68, 6291456
    s_cmp_ge_u32 s49, 29
    s_cselect_b32 s68, 1073741824, s68
    v_add_u32 v6, s68, v38
    s_lshl_b32 s68, s48, 2
    s_add_u32 s68, s68, s53
    s_lshl_b32 s68, s68, 1
    s_add_u32 s64, s68, s56
    s_lshl_b32 s69, s64, 15
    s_lshl_b32 s70, s54, 2
    s_add_u32 s70, s70, s55
    s_lshl_b32 s70, s70, 10
    s_add_u32 s69, s69, s70
    s_add_u32 s69, s69, 4194304
    v_add_u32 v5, s69, v38
    s_lshl_b32 s68, s64, 11
    s_lshl_b32 s69, s54, 8
    s_add_u32 s68, s68, s69
    s_add_u32 s68, s68, 65536
    s_cmp_eq_u32 s55, 3
    s_cselect_b32 s68, s68, 1073741824
    v_lshl_add_u32 v7, v0, 2, s68
    v_lshlrev_b32 v24, 2, v26
    v_xor_b32 v24, v24, v0
    v_and_b32 v24, 7, v24
    v_lshlrev_b32 v24, 4, v24
    v_lshrrev_b32 v25, 3, v0
    v_lshl_add_u32 v24, v25, 10, v24
    s_lshl_b32 s68, s54, 7
    v_add_u32 v8, s68, v24
    s_mul_i32 s68, s49, 96
    s_lshl_b32 s69, s50, 6
    v_add_u32 v24, s69, v0
    v_mul_u32_u24 v25, 43691, v24
    v_lshrrev_b32 v25, 18, v25
    v_mul_u32_u24 v27, 6, v25
    v_sub_u32 v24, v24, v27
    v_lshl_add_u32 v24, v24, 4, s68
    v_mul_u32_u24 v27, 2752, v25
    v_add_u32 v9, v27, v24
    v_xor_b32 v25, 4, v25
    v_mul_u32_u24 v27, 2752, v25
    v_add_u32 v117, v27, v24
    s_add_u32 s69, s69, 512
    v_add_u32 v24, s69, v0
    v_mul_u32_u24 v25, 43691, v24
    v_lshrrev_b32 v25, 18, v25
    v_mul_u32_u24 v27, 6, v25
    v_sub_u32 v24, v24, v27
    v_lshl_add_u32 v24, v24, 4, s68
    v_mul_u32_u24 v27, 2752, v25
    v_add_u32 v10, v27, v24
    v_xor_b32 v25, 4, v25
    v_mul_u32_u24 v27, 2752, v25
    v_add_u32 v118, v27, v24
    s_add_u32 s69, s69, 512
    v_add_u32 v24, s69, v0
    v_mul_u32_u24 v25, 43691, v24
    v_lshrrev_b32 v25, 18, v25
    v_mul_u32_u24 v27, 6, v25
    v_sub_u32 v24, v24, v27
    v_lshl_add_u32 v24, v24, 4, s68
    v_mul_u32_u24 v27, 2752, v25
    v_add_u32 v116, v27, v24
    v_xor_b32 v25, 4, v25
    v_mul_u32_u24 v27, 2752, v25
    v_add_u32 v119, v27, v24
    s_add_u32 s69, s69, 512
    v_lshrrev_b32 v24, 2, v0
    v_xor_b32 v25, s55, v24
    v_and_b32 v25, 3, v25
    v_lshlrev_b32 v25, 6, v25
    v_lshl_add_u32 v25, v24, 8, v25
    v_and_b32 v24, 3, v0
    v_lshl_add_u32 v25, v24, 4, v25
    v_add_u32 v39, 65536, v25
    v_bfe_u32 v24, v0, 2, 2
    v_lshrrev_b32 v25, 5, v0
    v_lshl_add_u32 v25, v25, 2, v24
    v_lshlrev_b32 v25, 7, v25
    v_and_b32 v24, 2, v24
    v_xor_b32 v24, v24, v26
    v_xor_b32 v24, s55, v24
    v_lshl_add_u32 v25, v24, 5, v25
    v_and_b32 v24, 3, v0
    v_lshl_add_u32 v25, v24, 3, v25
    s_lshl_b32 s68, s55, 10
    v_add_u32 v11, s68, v25
    v_and_b32 v24, 27, v0
    v_cmp_eq_u32 vcc, 16, v24
    v_mov_b32 v25, 0x3f803f80
    s_nop 0
    v_cndmask_b32 v24, 0, v25, vcc
    v_mov_b32 v108, v24
    v_mov_b32 v109, v24
    v_mov_b32 v110, v24
    v_mov_b32 v111, v24
    v_mov_b32 v112, v24
    v_mov_b32 v113, v24
    v_mov_b32 v114, v24
    v_mov_b32 v115, v24
    v_mov_b32 v72, 0
    v_mov_b32 v73, 0
    v_mov_b32 v74, 0
    v_mov_b32 v75, 0
    v_mov_b32 v76, 0
    v_mov_b32 v77, 0
    v_mov_b32 v78, 0
    v_mov_b32 v79, 0
    v_mov_b32 v80, 0
    v_mov_b32 v81, 0
    v_mov_b32 v82, 0
    v_mov_b32 v83, 0
    v_mov_b32 v84, 0
    v_mov_b32 v85, 0
    v_mov_b32 v86, 0
    v_mov_b32 v87, 0
    v_mov_b32 v88, 0
    v_mov_b32 v89, 0
    v_mov_b32 v90, 0
    v_mov_b32 v91, 0
    v_mov_b32 v92, 0
    v_mov_b32 v93, 0
    v_mov_b32 v94, 0
    v_mov_b32 v95, 0
    v_mov_b32 v96, 0
    v_mov_b32 v97, 0
    v_mov_b32 v98, 0
    v_mov_b32 v99, 0
    v_mov_b32 v100, 0
    v_mov_b32 v101, 0
    v_mov_b32 v102, 0
    v_mov_b32 v103, 0
    v_mov_b32 v24, -1
    v_mov_b32 v25, -1
    v_mov_b32 v26, -1
    v_mov_b32 v27, -1
    s_lshl_b32 s68, s51, 3
    v_xor_b32 v251, s68, v0
    v_lshlrev_b32 v251, 9, v251
    v_add_u32 v251, 131072, v251
    v_and_b32 v247, 7, v0
    v_xor_b32 v247, s63, v247
    v_lshl_add_u32 v251, v247, 4, v251
    v_xor_b32 v252, 16, v251
    v_xor_b32 v253, 256, v251
    v_xor_b32 v254, 272, v251
    v_lshlrev_b32 v247, 5, v0
    v_add_u32 v247, 114688, v247
    s_cmp_ge_u32 s50, 2
    s_cselect_b32 s63, 1.0, 0
    v_bfe_u32 v124, v0, 2, 2
    v_lshrrev_b32 v125, 5, v0
    v_lshl_add_u32 v126, v125, 3, v124
    v_lshlrev_b32 v240, 8, v126
    v_xor_b32 v124, s55, v124
    v_lshl_add_u32 v240, v124, 6, v240
    v_bfe_u32 v124, v0, 4, 1
    v_lshl_add_u32 v240, v124, 5, v240
    v_and_b32 v124, 3, v0
    v_lshl_add_u32 v240, v124, 3, v240
    v_add_u32 v241, 65536, v240
    v_and_b32 v124, 31, v0
    v_xor_b32 v124, v124, v125
    v_lshlrev_b32 v124, 4, v124
    v_lshl_add_u32 v124, v125, 9, v124
    v_add_u32 v242, 131072, v124
    v_xor_b32 v243, 32, v242
    v_xor_b32 v244, 64, v242
    v_xor_b32 v245, 96, v242
    v_lshrrev_b32 v124, 4, v0
    v_and_b32 v125, 15, v0
    v_lshlrev_b32 v13, 4, v125
    v_lshlrev_b32 v125, 3, v125
    v_lshl_add_u32 v125, v124, 8, v125
    v_add_u32 v125, 131072, v125
    s_cmp_lg_u32 s50, 0
    s_cbranch_scc1 L_nw0b
    v_lshlrev_b32 v124, 4, v124
    v_add_u32 v124, 151552, v124
    v_add_u32 v121, 151552, v120
    s_waitcnt vmcnt(8)
    v_and_b32 v127, 0xffff0000, v250
    v_lshlrev_b32 v126, 16, v250
    v_mul_f32 v122, 0xbfb8aa3b, v126
    v_exp_f32 v122, v122
    s_nop 0
    v_add_f32 v122, 1.0, v122
    v_rcp_f32 v122, v122
    s_nop 0
    v_mul_f32 v126, v126, v122
    v_mul_f32 v123, 0xbfb8aa3b, v127
    v_exp_f32 v123, v123
    s_nop 0
    v_add_f32 v123, 1.0, v123
    v_rcp_f32 v123, v123
    s_nop 0
    v_mul_f32 v127, v127, v123
    v_cvt_pk_bf16_f32 v126, v126, v127
    ds_write_b32 v121, v126
    ds_read_b128 v[176:179], v124 offset:0
    ds_read_b128 v[180:183], v124 offset:64
    ds_read_b128 v[184:187], v124 offset:128
    ds_read_b128 v[188:191], v124 offset:192
    s_waitcnt vmcnt(3)
    ds_read_b64_tr_b16 v[192:193], v125 offset:16384
    ds_read_b64_tr_b16 v[194:195], v125 offset:16512
    ds_read_b64_tr_b16 v[196:197], v125 offset:17408
    ds_read_b64_tr_b16 v[198:199], v125 offset:17536
    ds_read_b64_tr_b16 v[200:201], v125 offset:18432
    ds_read_b64_tr_b16 v[202:203], v125 offset:18560
    ds_read_b64_tr_b16 v[204:205], v125 offset:19456
    ds_read_b64_tr_b16 v[206:207], v125 offset:19584
    v_readfirstlane_b32 s57, v249
    s_mul_i32 s57, s57, 0x9e3779b1
    s_add_u32 s57, s57, 0x7f4a7c15
    s_bfe_u32 s58, s57, 0x80000
    s_bfe_u32 s59, s57, 0x80008
    s_bfe_u32 s60, s57, 0x80010
    s_bfe_u32 s61, s57, 0x80018
    v_and_b32 v122, 3, v0
    v_lshlrev_b32 v122, 3, v122
    v_lshrrev_b32 v122, v122, s57
    s_movk_i32 s75, 0xff
    s_waitcnt lgkmcnt(6)
    v_mfma_f32_16x16x32_bf16 v[208:211], v[176:179], v[192:195], 0
    s_waitcnt lgkmcnt(4)
    v_mfma_f32_16x16x32_bf16 v[208:211], v[180:183], v[196:199], v[208:211]
    s_waitcnt lgkmcnt(2)
    v_mfma_f32_16x16x32_bf16 v[208:211], v[184:187], v[200:203], v[208:211]
    s_waitcnt lgkmcnt(0)
    v_mfma_f32_16x16x32_bf16 v[208:211], v[188:191], v[204:207], v[208:211]
    s_waitcnt vmcnt(2)
    s_mov_b64 exec, 0xffff
    s_nop 5
    v_bfi_b32 v208, s75, v122, v208
    buffer_store_dword v208, v120, s[44:47], s72 offen sc1
    s_mov_b64 exec, -1
    s_setprio 0
L_nw0b:
    buffer_load_dwordx4 v[48:51], v38, s[4:7], s82 offen
    buffer_load_dwordx4 v[52:55], v38, s[4:7], s83 offen
    s_barrier
    s_xor_b32 s73, s73, s77
    s_add_u32 m0, s77, 131072
    s_nop 0
    buffer_load_dwordx4 v38, s[12:15], s73 offen  lds
    s_add_u32 m0, s77, 132096
    s_xor_b32 s75, s73, 1024
    buffer_load_dwordx4 v38, s[12:15], s75 offen  lds
    s_add_u32 m0, s77, 0
    s_nop 0
    buffer_load_dwordx4 v246, s[8:11], s78 offen  lds
    s_add_u32 m0, s77, 1024
    s_xor_b32 s75, s78, 4096
    buffer_load_dwordx4 v246, s[8:11], s75 offen  lds
    s_lshl_b32 s77, s55, 12
    s_lshl_b32 s78, s55, 14
    s_lshl_b32 s68, s51, 16
    s_add_u32 s78, s78, s68
    s_and_b32 s68, s71, 1
    s_lshl_b32 s68, s68, 9
    s_cmp_eq_u32 s50, 5
    s_cselect_b32 s68, s68, 1073741824
    buffer_load_dwordx2 v[14:15], v121, s[32:35], s68 offen
    v_lshrrev_b32 v124, 4, v0
    s_lshr_b32 s68, s52, 1
    s_lshl_b32 s68, s68, 4
    v_and_b32 v120, 15, v0
    v_add_u32 v120, s68, v120
    v_xor_b32 v120, v120, v124
    v_lshlrev_b32 v120, 4, v120
    v_lshl_add_u32 v120, v124, 9, v120
    v_add_u32 v120, 131072, v120
    v_xor_b32 v121, 64, v120
    s_bitcmp1_b32 s52, 0
    s_cselect_b32 s68, 3, 8
    s_cselect_b32 s69, 8, 3
    v_and_b32 v123, 1, v124
    v_lshl_add_u32 v13, v123, s68, v13
    v_lshrrev_b32 v123, 1, v124
    v_lshl_add_u32 v13, v123, s69, v13
    v_add_u32 v122, 114688, v36
    s_waitcnt vmcnt(5)
    v_and_b32 v129, 0xffff0000, v40
    v_lshlrev_b32 v128, 16, v40
    v_and_b32 v131, 0xffff0000, v41
    v_lshlrev_b32 v130, 16, v41
    v_and_b32 v133, 0xffff0000, v42
    v_lshlrev_b32 v132, 16, v42
    v_and_b32 v135, 0xffff0000, v43
    v_lshlrev_b32 v134, 16, v43
    v_and_b32 v137, 0xffff0000, v44
    v_lshlrev_b32 v136, 16, v44
    v_and_b32 v139, 0xffff0000, v45
    v_lshlrev_b32 v138, 16, v45
    v_and_b32 v141, 0xffff0000, v46
    v_lshlrev_b32 v140, 16, v46
    v_and_b32 v143, 0xffff0000, v47
    v_lshlrev_b32 v142, 16, v47
    v_and_b32 v145, 0xffff0000, v48
    v_lshlrev_b32 v144, 16, v48
    v_and_b32 v147, 0xffff0000, v49
    v_lshlrev_b32 v146, 16, v49
    v_and_b32 v149, 0xffff0000, v50
    v_lshlrev_b32 v148, 16, v50
    v_and_b32 v151, 0xffff0000, v51
    v_lshlrev_b32 v150, 16, v51
    v_and_b32 v153, 0xffff0000, v52
    v_lshlrev_b32 v152, 16, v52
    v_and_b32 v155, 0xffff0000, v53
    v_lshlrev_b32 v154, 16, v53
    v_and_b32 v157, 0xffff0000, v54
    v_lshlrev_b32 v156, 16, v54
    v_and_b32 v159, 0xffff0000, v55
    v_lshlrev_b32 v158, 16, v55
    v_add_f32 v40, v128, v129
    v_mul_f32 v44, v128, v128
    v_add_f32 v41, v136, v137
    v_mul_f32 v45, v136, v136
    v_add_f32 v42, v144, v145
    v_mul_f32 v46, v144, v144
    v_add_f32 v43, v152, v153
    v_mul_f32 v47, v152, v152
    v_fmac_f32 v44, v129, v129
    v_fmac_f32 v45, v137, v137
    v_fmac_f32 v46, v145, v145
    v_fmac_f32 v47, v153, v153
    v_add_f32 v40, v40, v130
    v_fmac_f32 v44, v130, v130
    v_add_f32 v41, v41, v138
    v_fmac_f32 v45, v138, v138
    v_add_f32 v42, v42, v146
    v_fmac_f32 v46, v146, v146
    v_add_f32 v43, v43, v154
    v_fmac_f32 v47, v154, v154
    v_add_f32 v40, v40, v131
    v_fmac_f32 v44, v131, v131
    v_add_f32 v41, v41, v139
    v_fmac_f32 v45, v139, v139
    v_add_f32 v42, v42, v147
    v_fmac_f32 v46, v147, v147
    v_add_f32 v43, v43, v155
    v_fmac_f32 v47, v155, v155
    v_add_f32 v40, v40, v132
    v_fmac_f32 v44, v132, v132
    v_add_f32 v41, v41, v140
    v_fmac_f32 v45, v140, v140
    v_add_f32 v42, v42, v148
    v_fmac_f32 v46, v148, v148
    v_add_f32 v43, v43, v156
    v_fmac_f32 v47, v156, v156
    v_add_f32 v40, v40, v133
    v_fmac_f32 v44, v133, v133
    v_add_f32 v41, v41, v141
    v_fmac_f32 v45, v141, v141
    v_add_f32 v42, v42, v149
    v_fmac_f32 v46, v149, v149
    v_add_f32 v43, v43, v157
    v_fmac_f32 v47, v157, v157
    v_add_f32 v40, v40, v134
    v_fmac_f32 v44, v134, v134
    v_add_f32 v41, v41, v142
    v_fmac_f32 v45, v142, v142
    v_add_f32 v42, v42, v150
    v_fmac_f32 v46, v150, v150
    v_add_f32 v43, v43, v158
    v_fmac_f32 v47, v158, v158
    v_add_f32 v40, v40, v135
    v_fmac_f32 v44, v135, v135
    v_add_f32 v41, v41, v143
    v_fmac_f32 v45, v143, v143
    v_add_f32 v42, v42, v151
    v_fmac_f32 v46, v151, v151
    v_add_f32 v43, v43, v159
    v_fmac_f32 v47, v159, v159
    v_readfirstlane_b32 s57, v249
    s_mul_i32 s57, s57, 0x9e3779b1
    s_add_u32 s57, s57, 0x7f4a7c15
    s_bfe_u32 s58, s57, 0x80000
    s_bfe_u32 s59, s57, 0x80008
    s_bfe_u32 s60, s57, 0x80010
    s_bfe_u32 s61, s57, 0x80018
    v_permlane32_swap_b32 v40, v41
    v_permlane32_swap_b32 v42, v43
    v_permlane32_swap_b32 v44, v45
    v_permlane32_swap_b32 v46, v47
    v_add_f32 v40, v40, v41
    v_add_f32 v42, v42, v43
    v_add_f32 v44, v44, v45
    v_add_f32 v46, v46, v47
    v_permlane16_swap_b32 v40, v42
    s_nop 0
    v_permlane16_swap_b32 v44, v46
    v_add_f32 v40, v40, v42
    v_add_f32 v44, v44, v46
    s_nop 0
    v_add_f32_dpp v40, v40, v40 row_ror:8 row_mask:0xf bank_mask:0xf
    v_add_f32_dpp v44, v44, v44 row_ror:8 row_mask:0xf bank_mask:0xf
    s_nop 0
    v_add_f32_dpp v40, v40, v40 row_ror:4 row_mask:0xf bank_mask:0xf
    v_add_f32_dpp v44, v44, v44 row_ror:4 row_mask:0xf bank_mask:0xf
    s_nop 0
    v_add_f32_dpp v40, v40, v40 row_ror:2 row_mask:0xf bank_mask:0xf
    v_add_f32_dpp v44, v44, v44 row_ror:2 row_mask:0xf bank_mask:0xf
    s_nop 0
    v_add_f32_dpp v40, v40, v40 row_ror:1 row_mask:0xf bank_mask:0xf
    v_add_f32_dpp v44, v44, v44 row_ror:1 row_mask:0xf bank_mask:0xf
    v_mul_f32 v40, 0xbb000000, v40
    v_mul_f32 v44, 0x3b000000, v44
    v_fma_f32 v44, -v40, v40, v44
    v_max_f32 v44, 0, v44
    v_add_f32 v44, 0x3727c5ac, v44
    v_rsq_f32 v44, v44
    s_nop 0
    v_mul_f32 v40, v40, v44
    v_readlane_b32 s80, v44, 0
    v_readlane_b32 s68, v40, 0
    v_readlane_b32 s81, v44, 32
    v_readlane_b32 s69, v40, 32
    v_readlane_b32 s82, v44, 16
    v_readlane_b32 s70, v40, 16
    v_readlane_b32 s83, v44, 48
    v_readlane_b32 s74, v40, 48
    v_mov_b32 v48, s68
    v_mov_b32 v49, s69
    v_mov_b32 v50, s70
    v_mov_b32 v51, s74
    v_fma_f32 v128, v128, s80, v48
    v_fma_f32 v129, v129, s80, v48
    v_fma_f32 v130, v130, s80, v48
    v_fma_f32 v131, v131, s80, v48
    v_fma_f32 v132, v132, s80, v48
    v_fma_f32 v133, v133, s80, v48
    v_fma_f32 v134, v134, s80, v48
    v_fma_f32 v135, v135, s80, v48
    v_fma_f32 v136, v136, s81, v49
    v_fma_f32 v137, v137, s81, v49
    v_fma_f32 v138, v138, s81, v49
    v_fma_f32 v139, v139, s81, v49
    v_fma_f32 v140, v140, s81, v49
    v_fma_f32 v141, v141, s81, v49
    v_fma_f32 v142, v142, s81, v49
    v_fma_f32 v143, v143, s81, v49
    v_fma_f32 v144, v144, s82, v50
    v_fma_f32 v145, v145, s82, v50
    v_fma_f32 v146, v146, s82, v50
    v_fma_f32 v147, v147, s82, v50
    v_fma_f32 v148, v148, s82, v50
    v_fma_f32 v149, v149, s82, v50
    v_fma_f32 v150, v150, s82, v50
    v_fma_f32 v151, v151, s82, v50
    v_fma_f32 v152, v152, s83, v51
    v_fma_f32 v153, v153, s83, v51
    v_fma_f32 v154, v154, s83, v51
    v_fma_f32 v155, v155, s83, v51
    v_fma_f32 v156, v156, s83, v51
    v_fma_f32 v157, v157, s83, v51
    v_fma_f32 v158, v158, s83, v51
    v_fma_f32 v159, v159, s83, v51
    s_cmp_ge_u32 s50, 4
    s_cbranch_scc1 L_nog_3
    s_mov_b32 s72, 4096
    buffer_load_dwordx4 v[160:163], v36, s[44:47], s72 offen sc1
    s_mov_b32 s72, 8192
    buffer_load_dwordx4 v[164:167], v36, s[44:47], s72 offen sc1
    s_mov_b32 s72, 12288
    buffer_load_dwordx4 v[168:171], v36, s[44:47], s72 offen sc1
    s_mov_b32 s72, 16384
    buffer_load_dwordx4 v[172:175], v36, s[44:47], s72 offen sc1
L_nog_3:
    s_cmp_ge_u32 s50, 4
    s_cbranch_scc1 L_ld2
    s_waitcnt vmcnt(4)
    s_barrier
    s_waitcnt vmcnt(0)
L_ga_chk_4:
    v_xor_b32 v160, s58, v160
    v_xor_b32 v161, s59, v161
    v_xor_b32 v162, s60, v162
    v_xor_b32 v163, s61, v163
    v_xor_b32 v164, s58, v164
    v_xor_b32 v165, s59, v165
    v_xor_b32 v166, s60, v166
    v_xor_b32 v167, s61, v167
    v_xor_b32 v168, s58, v168
    v_xor_b32 v169, s59, v169
    v_xor_b32 v170, s60, v170
    v_xor_b32 v171, s61, v171
    v_xor_b32 v172, s58, v172
    v_xor_b32 v173, s59, v173
    v_xor_b32 v174, s60, v174
    v_xor_b32 v175, s61, v175
    v_or3_b32 v248, v160, v161, v162
    v_or3_b32 v248, v248, v163, v164
    v_or3_b32 v248, v248, v165, v166
    v_or3_b32 v248, v248, v167, v168
    v_or3_b32 v248, v248, v169, v170
    v_or3_b32 v248, v248, v171, v172
    v_or3_b32 v248, v248, v173, v174
    v_or_b32 v248, v248, v175
    v_and_b32 v248, 0xff, v248
    v_cmp_ne_u32 vcc, 0, v248
    s_cbranch_vccnz L_ga_stub_6
L_ga_ok_5:
    v_add_f32 v160, v160, v164
    v_add_f32 v168, v168, v172
    v_add_f32 v161, v161, v165
    v_add_f32 v169, v169, v173
    v_add_f32 v162, v162, v166
    v_add_f32 v170, v170, v174
    v_add_f32 v163, v163, v167
    v_add_f32 v171, v171, v175
    v_add_f32 v160, v160, v168
    v_add_f32 v161, v161, v169
    v_add_f32 v162, v162, v170
    v_add_f32 v163, v163, v171
    v_cvt_pk_bf16_f32 v164, v160, v161
    v_cvt_pk_bf16_f32 v165, v162, v163
    v_and_b32 v161, 0xffff0000, v164
    v_lshlrev_b32 v160, 16, v164
    v_and_b32 v163, 0xffff0000, v165
    v_lshlrev_b32 v162, 16, v165
    v_add_f32 v160, s63, v160
    v_add_f32 v161, s63, v161
    v_add_f32 v162, s63, v162
    v_add_f32 v163, s63, v163
    v_cvt_pk_bf16_f32 v164, v160, v161
    v_cvt_pk_bf16_f32 v165, v162, v163
    v_and_b32 v161, 0xffff0000, v164
    v_lshlrev_b32 v160, 16, v164
    v_and_b32 v163, 0xffff0000, v165
    v_lshlrev_b32 v162, 16, v165
    ds_write_b128 v122, v[160:163]
L_b2:
    s_waitcnt lgkmcnt(0)
    s_barrier
    ds_read_b128 v[56:59], v247
    ds_read_b128 v[64:67], v247 offset:2048
    ds_read_b128 v[60:63], v247 offset:16
    ds_read_b128 v[68:71], v247 offset:2064
    s_waitcnt lgkmcnt(0)
    v_pk_fma_f32 v[128:129], v[128:129], v[64:65], v[56:57]
    v_pk_fma_f32 v[130:131], v[130:131], v[66:67], v[58:59]
    v_pk_fma_f32 v[132:133], v[132:133], v[68:69], v[60:61]
    v_pk_fma_f32 v[134:135], v[134:135], v[70:71], v[62:63]
    v_cvt_pk_bf16_f32 v128, v128, v129
    v_cvt_pk_bf16_f32 v129, v130, v131
    v_cvt_pk_bf16_f32 v130, v132, v133
    v_cvt_pk_bf16_f32 v131, v134, v135
    ds_write_b128 v251, v[128:131]
    v_pk_fma_f32 v[136:137], v[136:137], v[64:65], v[56:57]
    v_pk_fma_f32 v[138:139], v[138:139], v[66:67], v[58:59]
    v_pk_fma_f32 v[140:141], v[140:141], v[68:69], v[60:61]
    v_pk_fma_f32 v[142:143], v[142:143], v[70:71], v[62:63]
    v_cvt_pk_bf16_f32 v136, v136, v137
    v_cvt_pk_bf16_f32 v137, v138, v139
    v_cvt_pk_bf16_f32 v138, v140, v141
    v_cvt_pk_bf16_f32 v139, v142, v143
    ds_write_b128 v252, v[136:139]
    s_waitcnt vmcnt(0) lgkmcnt(0)
    s_barrier
    s_cmp_lg_u32 s50, 4
    s_cbranch_scc1 L_not4c
    s_setprio 3
    ds_read_b128 v[40:43], v120 offset:0
    ds_read_b128 v[44:47], v121 offset:2048
    ds_read_b128 v[48:51], v120 offset:4096
    ds_read_b128 v[52:55], v121 offset:6144
    ds_read_b128 v[128:131], v120 offset:8192
    ds_read_b128 v[132:135], v121 offset:10240
    ds_read_b128 v[136:139], v120 offset:12288
    ds_read_b128 v[140:143], v121 offset:14336
    ds_read_b128 v[160:163], v120 offset:16384
    ds_read_b128 v[164:167], v121 offset:18432
    s_bitcmp1_b32 s52, 0
    s_cbranch_scc1 L_isv
    s_waitcnt lgkmcnt(9)
    v_mfma_f32_16x16x32_bf16 v[168:171], v[176:179], v[40:43], 0
    ds_read_b128 v[40:43], v120 offset:20480
    s_waitcnt lgkmcnt(9)
    v_mfma_f32_16x16x32_bf16 v[172:175], v[180:183], v[44:47], 0
    ds_read_b128 v[44:47], v121 offset:22528
    s_waitcnt lgkmcnt(9)
    v_mfma_f32_16x16x32_bf16 v[168:171], v[184:187], v[48:51], v[168:171]
    ds_read_b128 v[48:51], v120 offset:24576
    s_waitcnt lgkmcnt(9)
    v_mfma_f32_16x16x32_bf16 v[172:175], v[188:191], v[52:55], v[172:175]
    ds_read_b128 v[52:55], v121 offset:26624
    s_waitcnt lgkmcnt(9)
    v_mfma_f32_16x16x32_bf16 v[168:171], v[192:195], v[128:131], v[168:171]
    ds_read_b128 v[128:131], v120 offset:28672
    s_waitcnt lgkmcnt(9)
    v_mfma_f32_16x16x32_bf16 v[172:175], v[196:199], v[132:135], v[172:175]
    ds_read_b128 v[132:135], v121 offset:30720
    s_waitcnt lgkmcnt(9)
    v_mfma_f32_16x16x32_bf16 v[168:171], v[200:203], v[136:139], v[168:171]
    s_waitcnt lgkmcnt(8)
    v_mfma_f32_16x16x32_bf16 v[172:175], v[204:207], v[140:143], v[172:175]
    s_waitcnt lgkmcnt(7)
    v_mfma_f32_16x16x32_bf16 v[168:171], v[208:211], v[160:163], v[168:171]
    s_waitcnt lgkmcnt(6)
    v_mfma_f32_16x16x32_bf16 v[172:175], v[212:215], v[164:167], v[172:175]
    s_waitcnt lgkmcnt(5)
    v_mfma_f32_16x16x32_bf16 v[168:171], v[216:219], v[40:43], v[168:171]
    s_waitcnt lgkmcnt(4)
    v_mfma_f32_16x16x32_bf16 v[172:175], v[220:223], v[44:47], v[172:175]
    s_waitcnt lgkmcnt(3)
    v_mfma_f32_16x16x32_bf16 v[168:171], v[224:227], v[48:51], v[168:171]
    s_waitcnt lgkmcnt(2)
    v_mfma_f32_16x16x32_bf16 v[172:175], v[228:231], v[52:55], v[172:175]
    s_waitcnt lgkmcnt(1)
    v_mfma_f32_16x16x32_bf16 v[168:171], v[232:235], v[128:131], v[168:171]
    s_waitcnt lgkmcnt(0)
    v_mfma_f32_16x16x32_bf16 v[172:175], v[236:239], v[132:135], v[172:175]
    s_nop 7
    v_add_f32 v168, v168, v172
    v_add_f32 v169, v169, v173
    v_add_f32 v170, v170, v174
    v_add_f32 v171, v171, v175
    v_mul_f32 v168, 0x3eb8aa3b, v168
    v_mul_f32 v169, 0x3eb8aa3b, v169
    v_mul_f32 v170, 0x3eb8aa3b, v170
    v_mul_f32 v171, 0x3eb8aa3b, v171
    s_branch L_kvst
L_isv:
    s_waitcnt lgkmcnt(9)
    v_mfma_f32_16x16x32_bf16 v[168:171], v[40:43], v[176:179], 0
    ds_read_b128 v[40:43], v120 offset:20480
    s_waitcnt lgkmcnt(9)
    v_mfma_f32_16x16x32_bf16 v[172:175], v[44:47], v[180:183], 0
    ds_read_b128 v[44:47], v121 offset:22528
    s_waitcnt lgkmcnt(9)
    v_mfma_f32_16x16x32_bf16 v[168:171], v[48:51], v[184:187], v[168:171]
    ds_read_b128 v[48:51], v120 offset:24576
    s_waitcnt lgkmcnt(9)
    v_mfma_f32_16x16x32_bf16 v[172:175], v[52:55], v[188:191], v[172:175]
    ds_read_b128 v[52:55], v121 offset:26624
    s_waitcnt lgkmcnt(9)
    v_mfma_f32_16x16x32_bf16 v[168:171], v[128:131], v[192:195], v[168:171]
    ds_read_b128 v[128:131], v120 offset:28672
    s_waitcnt lgkmcnt(9)
    v_mfma_f32_16x16x32_bf16 v[172:175], v[132:135], v[196:199], v[172:175]
    ds_read_b128 v[132:135], v121 offset:30720
    s_waitcnt lgkmcnt(9)
    v_mfma_f32_16x16x32_bf16 v[168:171], v[136:139], v[200:203], v[168:171]
    s_waitcnt lgkmcnt(8)
    v_mfma_f32_16x16x32_bf16 v[172:175], v[140:143], v[204:207], v[172:175]
    s_waitcnt lgkmcnt(7)
    v_mfma_f32_16x16x32_bf16 v[168:171], v[160:163], v[208:211], v[168:171]
    s_waitcnt lgkmcnt(6)
    v_mfma_f32_16x16x32_bf16 v[172:175], v[164:167], v[212:215], v[172:175]
    s_waitcnt lgkmcnt(5)
    v_mfma_f32_16x16x32_bf16 v[168:171], v[40:43], v[216:219], v[168:171]
    s_waitcnt lgkmcnt(4)
    v_mfma_f32_16x16x32_bf16 v[172:175], v[44:47], v[220:223], v[172:175]
    s_waitcnt lgkmcnt(3)
    v_mfma_f32_16x16x32_bf16 v[168:171], v[48:51], v[224:227], v[168:171]
    s_waitcnt lgkmcnt(2)
    v_mfma_f32_16x16x32_bf16 v[172:175], v[52:55], v[228:231], v[172:175]
    s_waitcnt lgkmcnt(1)
    v_mfma_f32_16x16x32_bf16 v[168:171], v[128:131], v[232:235], v[168:171]
    s_waitcnt lgkmcnt(0)
    v_mfma_f32_16x16x32_bf16 v[172:175], v[132:135], v[236:239], v[172:175]
    s_nop 7
    v_add_f32 v168, v168, v172
    v_add_f32 v169, v169, v173
    v_add_f32 v170, v170, v174
    v_add_f32 v171, v171, v175
L_kvst:
    v_cvt_pk_bf16_f32 v168, v168, v169
    v_cvt_pk_bf16_f32 v169, v170, v171
    buffer_store_dwordx2 v[168:169], v13, s[44:47], s79 offen sc1
L_not4c:
    v_fma_f32 v144, v144, v64, v56
    v_fma_f32 v145, v145, v65, v57
    v_fma_f32 v146, v146, v66, v58
    v_fma_f32 v147, v147, v67, v59
    v_fma_f32 v148, v148, v68, v60
    v_fma_f32 v149, v149, v69, v61
    v_fma_f32 v150, v150, v70, v62
    v_fma_f32 v151, v151, v71, v63
    v_cvt_pk_bf16_f32 v144, v144, v145
    v_cvt_pk_bf16_f32 v145, v146, v147
    v_cvt_pk_bf16_f32 v146, v148, v149
    v_cvt_pk_bf16_f32 v147, v150, v151
    ds_write_b128 v253, v[144:147]
    v_fma_f32 v152, v152, v64, v56
    v_fma_f32 v153, v153, v65, v57
    v_fma_f32 v154, v154, v66, v58
    v_fma_f32 v155, v155, v67, v59
    v_fma_f32 v156, v156, v68, v60
    v_fma_f32 v157, v157, v69, v61
    v_fma_f32 v158, v158, v70, v62
    v_fma_f32 v159, v159, v71, v63
    v_cvt_pk_bf16_f32 v152, v152, v153
    v_cvt_pk_bf16_f32 v153, v154, v155
    v_cvt_pk_bf16_f32 v154, v156, v157
    v_cvt_pk_bf16_f32 v155, v158, v159
    ds_write_b128 v254, v[152:155]
    s_cmp_ge_u32 s50, 4
    s_cbranch_scc1 L_ld3
    s_add_u32 m0, s77, 65536
    s_xor_b32 s75, s78, 262144
    buffer_load_dwordx4 v246, s[8:11], s75 offen  lds
    ds_read_b64_tr_b16 v[176:177], v240 offset:0
    ds_read_b64_tr_b16 v[178:179], v240 offset:1024
    ds_read_b64_tr_b16 v[180:181], v240 offset:4096
    ds_read_b64_tr_b16 v[182:183], v240 offset:5120
    s_add_u32 m0, s77, 66560
    s_xor_b32 s75, s78, 266240
    buffer_load_dwordx4 v246, s[8:11], s75 offen  lds
    ds_read_b64_tr_b16 v[184:185], v240 offset:8192
    ds_read_b64_tr_b16 v[186:187], v240 offset:9216
    ds_read_b64_tr_b16 v[188:189], v240 offset:12288
    ds_read_b64_tr_b16 v[190:191], v240 offset:13312
    s_add_u32 m0, s77, 67584
    s_xor_b32 s75, s78, 270336
    buffer_load_dwordx4 v246, s[8:11], s75 offen  lds
    ds_read_b64_tr_b16 v[192:193], v240 offset:16384
    ds_read_b64_tr_b16 v[194:195], v240 offset:17408
    ds_read_b64_tr_b16 v[196:197], v240 offset:20480
    ds_read_b64_tr_b16 v[198:199], v240 offset:21504
    s_add_u32 m0, s77, 68608
    s_xor_b32 s75, s78, 274432
    buffer_load_dwordx4 v246, s[8:11], s75 offen  lds
    ds_read_b64_tr_b16 v[200:201], v240 offset:24576
    ds_read_b64_tr_b16 v[202:203], v240 offset:25600
    ds_read_b64_tr_b16 v[204:205], v240 offset:28672
    ds_read_b64_tr_b16 v[206:207], v240 offset:29696
    s_add_u32 m0, s77, 81920
    s_xor_b32 s75, s78, 327680
    buffer_load_dwordx4 v246, s[8:11], s75 offen  lds
    ds_read_b64_tr_b16 v[208:209], v240 offset:32768
    ds_read_b64_tr_b16 v[210:211], v240 offset:33792
    ds_read_b64_tr_b16 v[212:213], v240 offset:36864
    ds_read_b64_tr_b16 v[214:215], v240 offset:37888
    s_add_u32 m0, s77, 82944
    s_xor_b32 s75, s78, 331776
    buffer_load_dwordx4 v246, s[8:11], s75 offen  lds
    ds_read_b64_tr_b16 v[216:217], v240 offset:40960
    ds_read_b64_tr_b16 v[218:219], v240 offset:41984
    ds_read_b64_tr_b16 v[220:221], v240 offset:45056
    ds_read_b64_tr_b16 v[222:223], v240 offset:46080
    s_add_u32 m0, s77, 83968
    s_xor_b32 s75, s78, 335872
    buffer_load_dwordx4 v246, s[8:11], s75 offen  lds
    ds_read_b64_tr_b16 v[224:225], v240 offset:49152
    ds_read_b64_tr_b16 v[226:227], v240 offset:50176
    ds_read_b64_tr_b16 v[228:229], v240 offset:53248
    ds_read_b64_tr_b16 v[230:231], v240 offset:54272
    s_add_u32 m0, s77, 84992
    s_xor_b32 s75, s78, 339968
    buffer_load_dwordx4 v246, s[8:11], s75 offen  lds
    ds_read_b64_tr_b16 v[232:233], v240 offset:57344
    ds_read_b64_tr_b16 v[234:235], v240 offset:58368
    ds_read_b64_tr_b16 v[236:237], v240 offset:61440
    ds_read_b64_tr_b16 v[238:239], v240 offset:62464
    s_lshl_b32 s77, s50, 10
    s_bfe_u32 s68, s50, 0x10001
    s_lshl_b32 s76, s68, 16
    s_lshl_b32 s68, s56, 11
    s_add_u32 s76, s76, s68
    s_and_b32 s68, s50, 1
    s_lshl_b32 s68, s68, 10
    s_add_u32 s76, s76, s68
    s_add_u32 s76, s76, 262144
    s_lshl_b32 s68, s52, 14
    s_add_u32 s76, s76, s68
    s_lshl_b32 s68, s53, 1
    s_xor_b32 s65, s68, s54
    s_lshl_b32 s78, s55, 17
    s_lshl_b32 s68, s65, 14
    s_add_u32 s78, s78, s68
    s_lshl_b32 s68, s56, 13
    s_add_u32 s78, s78, s68
    s_lshl_b32 s68, s53, 1
    s_add_u32 s68, s68, s54
    s_and_b32 s68, s68, 7
    s_mul_i32 s68, s68, 11
    s_lshr_b32 s68, s68, 2
    s_lshr_b32 s69, s55, 1
    s_sub_u32 s69, 22, s69
    s_sub_u32 s82, s69, s68
    s_mul_i32 s70, s55, 22
    s_min_u32 s70, s70, 65
    s_add_u32 s70, s70, s68
    s_lshl_b32 s80, s70, 14
    s_lshl_b32 s69, s69, 14
    s_sub_u32 s81, s80, s69
    s_waitcnt lgkmcnt(0)
    s_barrier
    ds_read_b128 v[128:131], v242 offset:0
    ds_read_b128 v[132:135], v243 offset:1024
    ds_read_b128 v[136:139], v244 offset:2048
    ds_read_b128 v[140:143], v245 offset:3072
    s_waitcnt lgkmcnt(3)
    v_mfma_f32_32x32x16_bf16 v[40:55], v[176:179], v[128:131], 0
    ds_read_b128 v[144:147], v242 offset:4096
    s_waitcnt lgkmcnt(3)
    v_mfma_f32_32x32x16_bf16 v[40:55], v[180:183], v[132:135], v[40:55]
    ds_read_b128 v[148:151], v243 offset:5120
    s_waitcnt lgkmcnt(3)
    v_mfma_f32_32x32x16_bf16 v[40:55], v[184:187], v[136:139], v[40:55]
    ds_read_b128 v[152:155], v244 offset:6144
    s_waitcnt lgkmcnt(3)
    v_mfma_f32_32x32x16_bf16 v[40:55], v[188:191], v[140:143], v[40:55]
    ds_read_b128 v[156:159], v245 offset:7168
    s_waitcnt lgkmcnt(3)
    v_mfma_f32_32x32x16_bf16 v[40:55], v[192:195], v[144:147], v[40:55]
    ds_read_b128 v[128:131], v242 offset:8192
    s_waitcnt lgkmcnt(3)
    v_mfma_f32_32x32x16_bf16 v[40:55], v[196:199], v[148:151], v[40:55]
    ds_read_b128 v[132:135], v243 offset:9216
    s_waitcnt lgkmcnt(3)
    v_mfma_f32_32x32x16_bf16 v[40:55], v[200:203], v[152:155], v[40:55]
    ds_read_b128 v[136:139], v244 offset:10240
    s_waitcnt lgkmcnt(3)
    v_mfma_f32_32x32x16_bf16 v[40:55], v[204:207], v[156:159], v[40:55]
    ds_read_b128 v[140:143], v245 offset:11264
    s_waitcnt lgkmcnt(3)
    v_mfma_f32_32x32x16_bf16 v[40:55], v[208:211], v[128:131], v[40:55]
    ds_read_b128 v[144:147], v242 offset:12288
    s_waitcnt lgkmcnt(3)
    v_mfma_f32_32x32x16_bf16 v[40:55], v[212:215], v[132:135], v[40:55]
    ds_read_b128 v[148:151], v243 offset:13312
    s_waitcnt lgkmcnt(3)
    v_mfma_f32_32x32x16_bf16 v[40:55], v[216:219], v[136:139], v[40:55]
    ds_read_b128 v[152:155], v244 offset:14336
    s_waitcnt lgkmcnt(3)
    v_mfma_f32_32x32x16_bf16 v[40:55], v[220:223], v[140:143], v[40:55]
    ds_read_b128 v[156:159], v245 offset:15360
    s_waitcnt vmcnt(0)
    s_barrier
    s_waitcnt lgkmcnt(3)
    v_mfma_f32_32x32x16_bf16 v[40:55], v[224:227], v[144:147], v[40:55]
    ds_read_b64_tr_b16 v[176:177], v241 offset:0
    ds_read_b64_tr_b16 v[178:179], v241 offset:1024
    ds_read_b128 v[128:131], v242 offset:16384
    s_waitcnt lgkmcnt(5)
    v_mfma_f32_32x32x16_bf16 v[40:55], v[228:231], v[148:151], v[40:55]
    ds_read_b64_tr_b16 v[180:181], v241 offset:4096
    ds_read_b64_tr_b16 v[182:183], v241 offset:5120
    ds_read_b128 v[132:135], v243 offset:17408
    s_waitcnt lgkmcnt(7)
    v_mfma_f32_32x32x16_bf16 v[40:55], v[232:235], v[152:155], v[40:55]
    ds_read_b64_tr_b16 v[184:185], v241 offset:8192
    ds_read_b64_tr_b16 v[186:187], v241 offset:9216
    ds_read_b128 v[136:139], v244 offset:18432
    s_waitcnt lgkmcnt(9)
    v_mfma_f32_32x32x16_bf16 v[40:55], v[236:239], v[156:159], v[40:55]
    ds_read_b64_tr_b16 v[188:189], v241 offset:12288
    ds_read_b64_tr_b16 v[190:191], v241 offset:13312
    ds_read_b128 v[140:143], v245 offset:19456
    s_waitcnt lgkmcnt(10)
    s_waitcnt lgkmcnt(9)
    v_mfma_f32_32x32x16_bf16 v[40:55], v[176:179], v[128:131], v[40:55]
    ds_read_b64_tr_b16 v[192:193], v241 offset:16384
    ds_read_b64_tr_b16 v[194:195], v241 offset:17408
    ds_read_b128 v[144:147], v242 offset:20480
    s_waitcnt lgkmcnt(10)
    s_waitcnt lgkmcnt(9)
    v_mfma_f32_32x32x16_bf16 v[40:55], v[180:183], v[132:135], v[40:55]
    ds_read_b64_tr_b16 v[196:197], v241 offset:20480
    ds_read_b64_tr_b16 v[198:199], v241 offset:21504
    ds_read_b128 v[148:151], v243 offset:21504
    s_waitcnt lgkmcnt(10)
    s_waitcnt lgkmcnt(9)
    v_mfma_f32_32x32x16_bf16 v[40:55], v[184:187], v[136:139], v[40:55]
    ds_read_b64_tr_b16 v[200:201], v241 offset:24576
    ds_read_b64_tr_b16 v[202:203], v241 offset:25600
    ds_read_b128 v[152:155], v244 offset:22528
    s_waitcnt lgkmcnt(10)
    s_waitcnt lgkmcnt(9)
    v_mfma_f32_32x32x16_bf16 v[40:55], v[188:191], v[140:143], v[40:55]
    ds_read_b64_tr_b16 v[204:205], v241 offset:28672
    ds_read_b64_tr_b16 v[206:207], v241 offset:29696
    ds_read_b128 v[156:159], v245 offset:23552
    s_waitcnt lgkmcnt(10)
    s_waitcnt lgkmcnt(9)
    v_mfma_f32_32x32x16_bf16 v[40:55], v[192:195], v[144:147], v[40:55]
    ds_read_b64_tr_b16 v[208:209], v241 offset:32768
    ds_read_b64_tr_b16 v[210:211], v241 offset:33792
    ds_read_b128 v[128:131], v242 offset:24576
    s_waitcnt lgkmcnt(10)
    s_waitcnt lgkmcnt(9)
    v_mfma_f32_32x32x16_bf16 v[40:55], v[196:199], v[148:151], v[40:55]
    ds_read_b64_tr_b16 v[212:213], v241 offset:36864
    ds_read_b64_tr_b16 v[214:215], v241 offset:37888
    ds_read_b128 v[132:135], v243 offset:25600
    s_waitcnt lgkmcnt(10)
    s_waitcnt lgkmcnt(9)
    v_mfma_f32_32x32x16_bf16 v[40:55], v[200:203], v[152:155], v[40:55]
    ds_read_b64_tr_b16 v[216:217], v241 offset:40960
    ds_read_b64_tr_b16 v[218:219], v241 offset:41984
    ds_read_b128 v[136:139], v244 offset:26624
    s_waitcnt lgkmcnt(10)
    s_waitcnt lgkmcnt(9)
    v_mfma_f32_32x32x16_bf16 v[40:55], v[204:207], v[156:159], v[40:55]
    ds_read_b64_tr_b16 v[220:221], v241 offset:45056
    ds_read_b64_tr_b16 v[222:223], v241 offset:46080
    ds_read_b128 v[140:143], v245 offset:27648
    s_waitcnt lgkmcnt(10)
    s_waitcnt lgkmcnt(9)
    v_mfma_f32_32x32x16_bf16 v[40:55], v[208:211], v[128:131], v[40:55]
    ds_read_b64_tr_b16 v[224:225], v241 offset:49152
    ds_read_b64_tr_b16 v[226:227], v241 offset:50176
    ds_read_b128 v[144:147], v242 offset:28672
    s_waitcnt lgkmcnt(10)
    s_waitcnt lgkmcnt(9)
    v_mfma_f32_32x32x16_bf16 v[40:55], v[212:215], v[132:135], v[40:55]
    ds_read_b64_tr_b16 v[228:229], v241 offset:53248
    ds_read_b64_tr_b16 v[230:231], v241 offset:54272
    ds_read_b128 v[148:151], v243 offset:29696
    s_waitcnt lgkmcnt(10)
    s_waitcnt lgkmcnt(9)
    v_mfma_f32_32x32x16_bf16 v[40:55], v[216:219], v[136:139], v[40:55]
    ds_read_b64_tr_b16 v[232:233], v241 offset:57344
    ds_read_b64_tr_b16 v[234:235], v241 offset:58368
    ds_read_b128 v[152:155], v244 offset:30720
    s_waitcnt lgkmcnt(10)
    s_waitcnt lgkmcnt(9)
    v_mfma_f32_32x32x16_bf16 v[40:55], v[220:223], v[140:143], v[40:55]
    ds_read_b64_tr_b16 v[236:237], v241 offset:61440
    ds_read_b64_tr_b16 v[238:239], v241 offset:62464
    ds_read_b128 v[156:159], v245 offset:31744
    s_waitcnt lgkmcnt(10)
    s_waitcnt lgkmcnt(9)
    v_mfma_f32_32x32x16_bf16 v[40:55], v[224:227], v[144:147], v[40:55]
    s_waitcnt lgkmcnt(7)
    s_waitcnt lgkmcnt(6)
    v_mfma_f32_32x32x16_bf16 v[40:55], v[228:231], v[148:151], v[40:55]
    s_waitcnt lgkmcnt(4)
    s_waitcnt lgkmcnt(3)
    v_mfma_f32_32x32x16_bf16 v[40:55], v[232:235], v[152:155], v[40:55]
    s_waitcnt lgkmcnt(1)
    s_waitcnt lgkmcnt(0)
    v_mfma_f32_32x32x16_bf16 v[40:55], v[236:239], v[156:159], v[40:55]
    s_nop 11
    v_cvt_pk_bf16_f32 v16, v40, v41
    v_cvt_pk_bf16_f32 v17, v42, v43
    v_cvt_pk_bf16_f32 v18, v44, v45
    v_cvt_pk_bf16_f32 v19, v46, v47
    v_cvt_pk_bf16_f32 v20, v48, v49
    v_cvt_pk_bf16_f32 v21, v50, v51
    v_cvt_pk_bf16_f32 v22, v52, v53
    v_cvt_pk_bf16_f32 v23, v54, v55
    ds_write_b128 v39, v[16:19]
    ds_write_b128 v39, v[20:23] offset:4096
    s_waitcnt lgkmcnt(0)
    s_barrier
    s_branch L_att
L_ld2:
    s_add_u32 m0, s77, 16384
    s_xor_b32 s75, s78, 65536
    buffer_load_dwordx4 v246, s[8:11], s75 offen  lds
    s_add_u32 m0, s77, 17408
    s_xor_b32 s75, s78, 69632
    buffer_load_dwordx4 v246, s[8:11], s75 offen  lds
    s_add_u32 m0, s77, 18432
    s_xor_b32 s75, s78, 73728
    buffer_load_dwordx4 v246, s[8:11], s75 offen  lds
    s_add_u32 m0, s77, 19456
    s_xor_b32 s75, s78, 77824
    buffer_load_dwordx4 v246, s[8:11], s75 offen  lds
    s_waitcnt vmcnt(4)
    s_barrier
    s_cmp_lg_u32 s50, 4
    s_cbranch_scc1 L_n4_7
    ds_read_b64_tr_b16 v[176:177], v125 offset:0
    ds_read_b64_tr_b16 v[178:179], v125 offset:128
    ds_read_b64_tr_b16 v[180:181], v125 offset:1024
    ds_read_b64_tr_b16 v[182:183], v125 offset:1152
    ds_read_b64_tr_b16 v[184:185], v125 offset:2048
    ds_read_b64_tr_b16 v[186:187], v125 offset:2176
    ds_read_b64_tr_b16 v[188:189], v125 offset:3072
    ds_read_b64_tr_b16 v[190:191], v125 offset:3200
    ds_read_b64_tr_b16 v[192:193], v125 offset:4096
    ds_read_b64_tr_b16 v[194:195], v125 offset:4224
    ds_read_b64_tr_b16 v[196:197], v125 offset:5120
    ds_read_b64_tr_b16 v[198:199], v125 offset:5248
    ds_read_b64_tr_b16 v[200:201], v125 offset:6144
    ds_read_b64_tr_b16 v[202:203], v125 offset:6272
    ds_read_b64_tr_b16 v[204:205], v125 offset:7168
    ds_read_b64_tr_b16 v[206:207], v125 offset:7296
    ds_read_b64_tr_b16 v[208:209], v125 offset:8192
    ds_read_b64_tr_b16 v[210:211], v125 offset:8320
    ds_read_b64_tr_b16 v[212:213], v125 offset:9216
    ds_read_b64_tr_b16 v[214:215], v125 offset:9344
    ds_read_b64_tr_b16 v[216:217], v125 offset:10240
    ds_read_b64_tr_b16 v[218:219], v125 offset:10368
    ds_read_b64_tr_b16 v[220:221], v125 offset:11264
    ds_read_b64_tr_b16 v[222:223], v125 offset:11392
    ds_read_b64_tr_b16 v[224:225], v125 offset:12288
    ds_read_b64_tr_b16 v[226:227], v125 offset:12416
    ds_read_b64_tr_b16 v[228:229], v125 offset:13312
    ds_read_b64_tr_b16 v[230:231], v125 offset:13440
    ds_read_b64_tr_b16 v[232:233], v125 offset:14336
    ds_read_b64_tr_b16 v[234:235], v125 offset:14464
    ds_read_b64_tr_b16 v[236:237], v125 offset:15360
    ds_read_b64_tr_b16 v[238:239], v125 offset:15488
L_n4_7:
    s_add_u32 m0, s77, 32768
    s_xor_b32 s75, s78, 131072
    buffer_load_dwordx4 v246, s[8:11], s75 offen  lds
    s_add_u32 m0, s77, 33792
    s_xor_b32 s75, s78, 135168
    buffer_load_dwordx4 v246, s[8:11], s75 offen  lds
    s_add_u32 m0, s77, 34816
    s_xor_b32 s75, s78, 139264
    buffer_load_dwordx4 v246, s[8:11], s75 offen  lds
    s_add_u32 m0, s77, 35840
    s_xor_b32 s75, s78, 143360
    buffer_load_dwordx4 v246, s[8:11], s75 offen  lds
    s_add_u32 m0, s77, 49152
    s_xor_b32 s75, s78, 196608
    buffer_load_dwordx4 v246, s[8:11], s75 offen  lds
    s_add_u32 m0, s77, 50176
    s_xor_b32 s75, s78, 200704
    buffer_load_dwordx4 v246, s[8:11], s75 offen  lds
    s_add_u32 m0, s77, 51200
    s_xor_b32 s75, s78, 204800
    buffer_load_dwordx4 v246, s[8:11], s75 offen  lds
    s_add_u32 m0, s77, 52224
    s_xor_b32 s75, s78, 208896
    buffer_load_dwordx4 v246, s[8:11], s75 offen  lds
    s_branch L_b2
L_ld3:
    s_waitcnt lgkmcnt(0)
    s_setprio 0
    s_barrier
    s_add_u32 m0, s77, 98304
    s_xor_b32 s75, s78, 393216
    buffer_load_dwordx4 v246, s[8:11], s75 offen  lds
    s_add_u32 m0, s77, 99328
    s_xor_b32 s75, s78, 397312
    buffer_load_dwordx4 v246, s[8:11], s75 offen  lds
    s_add_u32 m0, s77, 100352
    s_xor_b32 s75, s78, 401408
    buffer_load_dwordx4 v246, s[8:11], s75 offen  lds
    s_add_u32 m0, s77, 101376
    s_xor_b32 s75, s78, 405504
    buffer_load_dwordx4 v246, s[8:11], s75 offen  lds
    s_add_u32 m0, s77, 114688
    s_xor_b32 s75, s78, 458752
    buffer_load_dwordx4 v246, s[8:11], s75 offen  lds
    s_add_u32 m0, s77, 115712
    s_xor_b32 s75, s78, 462848
    buffer_load_dwordx4 v246, s[8:11], s75 offen  lds
    s_add_u32 m0, s77, 116736
    s_xor_b32 s75, s78, 466944
    buffer_load_dwordx4 v246, s[8:11], s75 offen  lds
    s_add_u32 m0, s77, 117760
    s_xor_b32 s75, s78, 471040
    buffer_load_dwordx4 v246, s[8:11], s75 offen  lds
    s_lshl_b32 s77, s50, 10
    s_bfe_u32 s68, s50, 0x10001
    s_lshl_b32 s76, s68, 16
    s_lshl_b32 s68, s56, 11
    s_add_u32 s76, s76, s68
    s_and_b32 s68, s50, 1
    s_lshl_b32 s68, s68, 10
    s_add_u32 s76, s76, s68
    s_add_u32 s76, s76, 262144
    s_lshl_b32 s68, s52, 14
    s_add_u32 s76, s76, s68
    s_lshl_b32 s68, s53, 1
    s_xor_b32 s65, s68, s54
    s_lshl_b32 s78, s55, 17
    s_lshl_b32 s68, s65, 14
    s_add_u32 s78, s78, s68
    s_lshl_b32 s68, s56, 13
    s_add_u32 s78, s78, s68
    s_lshl_b32 s68, s53, 1
    s_add_u32 s68, s68, s54
    s_and_b32 s68, s68, 7
    s_mul_i32 s68, s68, 11
    s_lshr_b32 s68, s68, 2
    s_lshr_b32 s69, s55, 1
    s_sub_u32 s69, 22, s69
    s_sub_u32 s82, s69, s68
    s_mul_i32 s70, s55, 22
    s_min_u32 s70, s70, 65
    s_add_u32 s70, s70, s68
    s_lshl_b32 s80, s70, 14
    s_lshl_b32 s69, s69, 14
    s_sub_u32 s81, s80, s69
    s_cmp_lg_u32 s50, 5
    s_cbranch_scc1 L_n5_9
    v_and_b32 v121, 0xffff0000, v14
    v_lshlrev_b32 v120, 16, v14
    v_and_b32 v123, 0xffff0000, v15
    v_lshlrev_b32 v122, 16, v15
    v_mul_f32 v14, 0xbfb8aa3b, v120
    v_exp_f32 v14, v14
    s_nop 0
    v_add_f32 v14, 1.0, v14
    v_rcp_f32 v14, v14
    s_nop 0
    v_mul_f32 v120, v120, v14
    v_mul_f32 v14, 0xbfb8aa3b, v121
    v_exp_f32 v14, v14
    s_nop 0
    v_add_f32 v14, 1.0, v14
    v_rcp_f32 v14, v14
    s_nop 0
    v_mul_f32 v121, v121, v14
    v_mul_f32 v14, 0xbfb8aa3b, v122
    v_exp_f32 v14, v14
    s_nop 0
    v_add_f32 v14, 1.0, v14
    v_rcp_f32 v14, v14
    s_nop 0
    v_mul_f32 v122, v122, v14
    v_mul_f32 v14, 0xbfb8aa3b, v123
    v_exp_f32 v14, v14
    s_nop 0
    v_add_f32 v14, 1.0, v14
    v_rcp_f32 v14, v14
    s_nop 0
    v_mul_f32 v123, v123, v14
    v_cvt_pk_bf16_f32 v14, v120, v121
    v_cvt_pk_bf16_f32 v15, v122, v123
L_n5_9:
    s_waitcnt vmcnt(7)
    s_add_u32 m0, s77, -4096
    s_xor_b32 s75, s76, 2048
    buffer_load_dwordx4 v38, s[44:47], s75 offen sc1 lds
    s_add_u32 m0, s77, 0
    s_nop 0
    buffer_load_dwordx4 v38, s[44:47], s76 offen sc1 lds
    s_add_u32 m0, s77, 4096
    s_xor_b32 s75, s76, 6144
    buffer_load_dwordx4 v38, s[44:47], s75 offen sc1 lds
    s_add_u32 m0, s77, 8192
    s_xor_b32 s75, s76, 4096
    buffer_load_dwordx4 v38, s[44:47], s75 offen sc1 lds
    s_add_u32 m0, s77, 12288
    s_xor_b32 s75, s76, 10240
    buffer_load_dwordx4 v38, s[44:47], s75 offen sc1 lds
    s_add_u32 m0, s77, 16384
    s_xor_b32 s75, s76, 8192
    buffer_load_dwordx4 v38, s[44:47], s75 offen sc1 lds
    s_add_u32 m0, s77, 20480
    s_xor_b32 s75, s76, 14336
    buffer_load_dwordx4 v38, s[44:47], s75 offen sc1 lds
    s_add_u32 m0, s77, 24576
    s_xor_b32 s75, s76, 12288
    buffer_load_dwordx4 v38, s[44:47], s75 offen sc1 lds
    s_waitcnt vmcnt(8)
    s_barrier
    v_subrev_u32 v13, 4096, v36
    s_waitcnt vmcnt(0)
L_kv_chk_10:
    ds_read_b32 v236, v13 offset:0
    ds_read_b32 v232, v36 offset:0
    ds_read_b32 v237, v13 offset:8192
    ds_read_b32 v233, v36 offset:8192
    ds_read_b32 v238, v13 offset:16384
    ds_read_b32 v234, v36 offset:16384
    ds_read_b32 v239, v13 offset:24576
    ds_read_b32 v235, v36 offset:24576
    s_waitcnt lgkmcnt(0)
    v_max_u32 v232, v232, v233
    v_max3_u32 v232, v232, v234, v235
    v_max3_u32 v232, v232, v236, v237
    v_max3_u32 v232, v232, v238, v239
    v_cmp_eq_u32 vcc, -1, v232
    s_cbranch_vccnz L_kv_stub_12
L_kv_ok_11:
    s_barrier
    ds_read_b128 v[16:19], v39 offset:4096
    ds_read_b128 v[20:23], v39
    s_add_u32 m0, s77, 32768
    s_xor_b32 s75, s76, 16384
    buffer_load_dwordx4 v38, s[44:47], s75 offen sc1 lds
    s_add_u32 m0, s77, 40960
    s_xor_b32 s75, s76, 20480
    buffer_load_dwordx4 v38, s[44:47], s75 offen sc1 lds
    s_add_u32 m0, s77, 49152
    s_xor_b32 s75, s76, 24576
    buffer_load_dwordx4 v38, s[44:47], s75 offen sc1 lds
    s_add_u32 m0, s77, 57344
    s_xor_b32 s75, s76, 28672
    buffer_load_dwordx4 v38, s[44:47], s75 offen sc1 lds
    s_add_u32 m0, s77, 73728
    s_nop 0
    buffer_load_dwordx4 v8, s[16:19], s78 offen  lds
    s_add_u32 m0, s77, 81920
    s_xor_b32 s75, s78, 16384
    buffer_load_dwordx4 v8, s[16:19], s75 offen  lds
    s_add_u32 m0, s77, 90112
    s_xor_b32 s75, s78, 32768
    buffer_load_dwordx4 v8, s[16:19], s75 offen  lds
L_att:
    s_setprio 3
    ds_read_b128 v[104:107], v37 offset:0
    s_mov_b64 exec, s[66:67]
    ds_read_b128 v[108:111], v37 offset:1024
    s_mov_b64 exec, -1
    s_mov_b64 exec, s[66:67]
    ds_read_b128 v[112:115], v37 offset:1536
    s_mov_b64 exec, -1
    s_waitcnt lgkmcnt(2)
    v_mfma_f32_32x32x16_bf16 v[40:55], v[104:107], v[16:19], 0
    v_add_u32 v39, 98304, v37
    s_nop 10
    v_exp_f32 v40, v40
    v_exp_f32 v41, v41
    v_exp_f32 v42, v42
    v_exp_f32 v43, v43
    v_exp_f32 v44, v44
    v_mfma_f32_32x32x16_bf16 v[56:71], v[104:107], v[20:23], 0
    ds_read_b128 v[104:107], v37 offset:4096
    v_exp_f32 v45, v45
    v_exp_f32 v46, v46
    v_exp_f32 v47, v47
    v_exp_f32 v48, v48
    v_exp_f32 v49, v49
    s_waitcnt lgkmcnt(2)
    v_smfmac_f32_32x32x32_bf16 v[72:87], v[108:111], v[40:47], v2
    s_cmp_lg_u32 s56, 0
    s_cbranch_scc1 L_old_13
    s_add_u32 m0, s77, 32768
    s_xor_b32 s75, s76, 16384
    buffer_load_dwordx4 v38, s[44:47], s75 offen sc1 lds
    s_add_u32 m0, s77, 40960
    s_xor_b32 s75, s76, 20480
    buffer_load_dwordx4 v38, s[44:47], s75 offen sc1 lds
L_old_13:
    v_exp_f32 v50, v50
    v_exp_f32 v51, v51
    v_exp_f32 v52, v52
    v_exp_f32 v53, v53
    v_exp_f32 v54, v54
    v_exp_f32 v55, v55
    v_exp_f32 v56, v56
    v_exp_f32 v57, v57
    s_waitcnt lgkmcnt(1)
    v_smfmac_f32_32x32x32_bf16 v[72:87], v[112:115], v[48:55], v2
    v_exp_f32 v58, v58
    v_exp_f32 v59, v59
    v_exp_f32 v60, v60
    s_waitcnt lgkmcnt(0)
    v_mfma_f32_32x32x16_bf16 v[40:55], v[104:107], v[16:19], 0
    v_exp_f32 v61, v61
    v_exp_f32 v62, v62
    v_exp_f32 v63, v63
    v_exp_f32 v64, v64
    v_exp_f32 v65, v65
    v_smfmac_f32_32x32x32_bf16 v[88:103], v[108:111], v[56:63], v2
    s_mov_b64 exec, s[66:67]
    ds_read_b128 v[108:111], v37 offset:5120
    s_mov_b64 exec, -1
    s_cmp_lg_u32 s56, 0
    s_cbranch_scc1 L_old_14
    s_add_u32 m0, s77, 49152
    s_xor_b32 s75, s76, 24576
    buffer_load_dwordx4 v38, s[44:47], s75 offen sc1 lds
    s_add_u32 m0, s77, 57344
    s_xor_b32 s75, s76, 28672
    buffer_load_dwordx4 v38, s[44:47], s75 offen sc1 lds
L_old_14:
    v_exp_f32 v66, v66
    v_exp_f32 v67, v67
    v_exp_f32 v68, v68
    v_exp_f32 v69, v69
    v_exp_f32 v70, v70
    v_exp_f32 v71, v71
    v_exp_f32 v40, v40
    v_exp_f32 v41, v41
    v_smfmac_f32_32x32x32_bf16 v[88:103], v[112:115], v[64:71], v2
    s_mov_b64 exec, s[66:67]
    ds_read_b128 v[112:115], v37 offset:5632
    s_mov_b64 exec, -1
    v_exp_f32 v42, v42
    v_exp_f32 v43, v43
    v_exp_f32 v44, v44
    v_mfma_f32_32x32x16_bf16 v[56:71], v[104:107], v[20:23], 0
    ds_read_b128 v[104:107], v37 offset:8192
    v_exp_f32 v45, v45
    v_exp_f32 v46, v46
    v_exp_f32 v47, v47
    v_exp_f32 v48, v48
    v_exp_f32 v49, v49
    s_waitcnt lgkmcnt(2)
    v_smfmac_f32_32x32x32_bf16 v[72:87], v[108:111], v[40:47], v2
    s_cmp_lg_u32 s56, 0
    s_cbranch_scc1 L_old_15
    s_add_u32 m0, s77, 73728
    s_nop 0
    buffer_load_dwordx4 v8, s[16:19], s78 offen  lds
    s_add_u32 m0, s77, 81920
    s_xor_b32 s75, s78, 16384
    buffer_load_dwordx4 v8, s[16:19], s75 offen  lds
L_old_15:
    v_exp_f32 v50, v50
    v_exp_f32 v51, v51
    v_exp_f32 v52, v52
    v_exp_f32 v53, v53
    v_exp_f32 v54, v54
    v_exp_f32 v55, v55
    v_exp_f32 v56, v56
    v_exp_f32 v57, v57
    s_waitcnt lgkmcnt(1)
    v_smfmac_f32_32x32x32_bf16 v[72:87], v[112:115], v[48:55], v2
    v_exp_f32 v58, v58
    v_exp_f32 v59, v59
    v_exp_f32 v60, v60
    s_waitcnt lgkmcnt(0)
    v_mfma_f32_32x32x16_bf16 v[40:55], v[104:107], v[16:19], 0
    v_exp_f32 v61, v61
    v_exp_f32 v62, v62
    v_exp_f32 v63, v63
    v_exp_f32 v64, v64
    v_exp_f32 v65, v65
    v_smfmac_f32_32x32x32_bf16 v[88:103], v[108:111], v[56:63], v2
    s_mov_b64 exec, s[66:67]
    ds_read_b128 v[108:111], v37 offset:9216
    s_mov_b64 exec, -1
    s_cmp_lg_u32 s56, 0
    s_cbranch_scc1 L_old_16
    s_add_u32 m0, s77, 90112
    s_xor_b32 s75, s78, 32768
    buffer_load_dwordx4 v8, s[16:19], s75 offen  lds
L_old_16:
    v_exp_f32 v66, v66
    v_exp_f32 v67, v67
    v_exp_f32 v68, v68
    v_exp_f32 v69, v69
    v_exp_f32 v70, v70
    v_exp_f32 v71, v71
    v_exp_f32 v40, v40
    v_exp_f32 v41, v41
    v_smfmac_f32_32x32x32_bf16 v[88:103], v[112:115], v[64:71], v2
    s_mov_b64 exec, s[66:67]
    ds_read_b128 v[112:115], v37 offset:9728
    s_mov_b64 exec, -1
    v_exp_f32 v42, v42
    v_exp_f32 v43, v43
    v_exp_f32 v44, v44
    v_mfma_f32_32x32x16_bf16 v[56:71], v[104:107], v[20:23], 0
    ds_read_b128 v[104:107], v37 offset:12288
    v_exp_f32 v45, v45
    v_exp_f32 v46, v46
    v_exp_f32 v47, v47
    v_exp_f32 v48, v48
    v_exp_f32 v49, v49
    s_waitcnt lgkmcnt(2)
    v_smfmac_f32_32x32x32_bf16 v[72:87], v[108:111], v[40:47], v2
    s_cmp_lg_u32 s56, 0
    s_cbranch_scc1 L_old_17
    s_lshl_b32 s74, s2, 2
    s_add_u32 s74, s74, s55
    v_min_u32 v124, 10, v0
    v_lshlrev_b32 v124, 7, v124
    s_mul_i32 s68, s74, 1376
    buffer_load_dword v125, v124, s[20:23], s68 offen
    buffer_load_dword v125, v124, s[24:27], s68 offen
    buffer_load_dword v125, v124, s[28:31], s68 offen
L_old_17:
    v_exp_f32 v50, v50
    v_exp_f32 v51, v51
    v_exp_f32 v52, v52
    v_exp_f32 v53, v53
    v_exp_f32 v54, v54
    v_exp_f32 v55, v55
    v_exp_f32 v56, v56
    v_exp_f32 v57, v57
    s_waitcnt lgkmcnt(1)
    v_smfmac_f32_32x32x32_bf16 v[72:87], v[112:115], v[48:55], v2
    v_exp_f32 v58, v58
    v_exp_f32 v59, v59
    v_exp_f32 v60, v60
    s_waitcnt lgkmcnt(0)
    v_mfma_f32_32x32x16_bf16 v[40:55], v[104:107], v[16:19], 0
    v_exp_f32 v61, v61
    v_exp_f32 v62, v62
    v_exp_f32 v63, v63
    v_exp_f32 v64, v64
    v_exp_f32 v65, v65
    v_smfmac_f32_32x32x32_bf16 v[88:103], v[108:111], v[56:63], v2
    s_mov_b64 exec, s[66:67]
    ds_read_b128 v[108:111], v37 offset:13312
    s_mov_b64 exec, -1
    s_cmp_lg_u32 s56, 0
    s_cbranch_scc1 L_old_18
    s_lshr_b32 s68, s74, 1
    s_mul_i32 s68, s68, 6144
    s_and_b32 s69, s55, 1
    s_lshl_b32 s69, s69, 11
    s_add_u32 s68, s68, s69
    v_lshlrev_b32 v124, 5, v0
    buffer_load_dword v125, v124, s[36:39], s68 offen offset:2048
    s_lshl_b32 s68, s74, 9
    v_lshlrev_b32 v124, 3, v0
    buffer_load_dword v125, v124, s[16:19], s68 offen
L_old_18:
    v_exp_f32 v66, v66
    v_exp_f32 v67, v67
    v_exp_f32 v68, v68
    v_exp_f32 v69, v69
    v_exp_f32 v70, v70
    v_exp_f32 v71, v71
    v_exp_f32 v40, v40
    v_exp_f32 v41, v41
    v_smfmac_f32_32x32x32_bf16 v[88:103], v[112:115], v[64:71], v2
    s_mov_b64 exec, s[66:67]
    ds_read_b128 v[112:115], v37 offset:13824
    s_mov_b64 exec, -1
    v_exp_f32 v42, v42
    v_exp_f32 v43, v43
    v_exp_f32 v44, v44
    v_mfma_f32_32x32x16_bf16 v[56:71], v[104:107], v[20:23], 0
    ds_read_b128 v[104:107], v37 offset:16384
    v_exp_f32 v45, v45
    v_exp_f32 v46, v46
    v_exp_f32 v47, v47
    v_exp_f32 v48, v48
    v_exp_f32 v49, v49
    s_waitcnt lgkmcnt(2)
    v_smfmac_f32_32x32x32_bf16 v[72:87], v[108:111], v[40:47], v2
    v_exp_f32 v50, v50
    v_exp_f32 v51, v51
    v_exp_f32 v52, v52
    v_exp_f32 v53, v53
    v_exp_f32 v54, v54
    v_exp_f32 v55, v55
    v_exp_f32 v56, v56
    v_exp_f32 v57, v57
    s_waitcnt lgkmcnt(1)
    v_smfmac_f32_32x32x32_bf16 v[72:87], v[112:115], v[48:55], v2
    v_exp_f32 v58, v58
    v_exp_f32 v59, v59
    v_exp_f32 v60, v60
    s_waitcnt lgkmcnt(0)
    v_mfma_f32_32x32x16_bf16 v[40:55], v[104:107], v[16:19], 0
    v_exp_f32 v61, v61
    v_exp_f32 v62, v62
    v_exp_f32 v63, v63
    v_exp_f32 v64, v64
    v_exp_f32 v65, v65
    v_smfmac_f32_32x32x32_bf16 v[88:103], v[108:111], v[56:63], v2
    s_mov_b64 exec, s[66:67]
    ds_read_b128 v[108:111], v37 offset:17408
    s_mov_b64 exec, -1
    v_exp_f32 v66, v66
    v_exp_f32 v67, v67
    v_exp_f32 v68, v68
    v_exp_f32 v69, v69
    v_exp_f32 v70, v70
    v_exp_f32 v71, v71
    v_exp_f32 v40, v40
    v_exp_f32 v41, v41
    v_smfmac_f32_32x32x32_bf16 v[88:103], v[112:115], v[64:71], v2
    s_mov_b64 exec, s[66:67]
    ds_read_b128 v[112:115], v37 offset:17920
    s_mov_b64 exec, -1
    v_exp_f32 v42, v42
    v_exp_f32 v43, v43
    v_exp_f32 v44, v44
    v_mfma_f32_32x32x16_bf16 v[56:71], v[104:107], v[20:23], 0
    ds_read_b128 v[104:107], v37 offset:20480
    v_exp_f32 v45, v45
    v_exp_f32 v46, v46
    v_exp_f32 v47, v47
    v_exp_f32 v48, v48
    v_exp_f32 v49, v49
    s_waitcnt lgkmcnt(2)
    v_smfmac_f32_32x32x32_bf16 v[72:87], v[108:111], v[40:47], v2
    v_exp_f32 v50, v50
    v_exp_f32 v51, v51
    v_exp_f32 v52, v52
    v_exp_f32 v53, v53
    v_exp_f32 v54, v54
    v_exp_f32 v55, v55
    v_exp_f32 v56, v56
    v_exp_f32 v57, v57
    s_waitcnt lgkmcnt(1)
    v_smfmac_f32_32x32x32_bf16 v[72:87], v[112:115], v[48:55], v2
    v_exp_f32 v58, v58
    v_exp_f32 v59, v59
    v_exp_f32 v60, v60
    s_waitcnt lgkmcnt(0)
    v_mfma_f32_32x32x16_bf16 v[40:55], v[104:107], v[16:19], 0
    v_exp_f32 v61, v61
    v_exp_f32 v62, v62
    v_exp_f32 v63, v63
    v_exp_f32 v64, v64
    v_exp_f32 v65, v65
    v_smfmac_f32_32x32x32_bf16 v[88:103], v[108:111], v[56:63], v2
    s_mov_b64 exec, s[66:67]
    ds_read_b128 v[108:111], v37 offset:21504
    s_mov_b64 exec, -1
    s_setprio 2
    v_exp_f32 v66, v66
    v_exp_f32 v67, v67
    v_exp_f32 v68, v68
    v_exp_f32 v69, v69
    v_exp_f32 v70, v70
    v_exp_f32 v71, v71
    v_exp_f32 v40, v40
    v_exp_f32 v41, v41
    v_smfmac_f32_32x32x32_bf16 v[88:103], v[112:115], v[64:71], v2
    s_mov_b64 exec, s[66:67]
    ds_read_b128 v[112:115], v37 offset:22016
    s_mov_b64 exec, -1
    v_exp_f32 v42, v42
    v_exp_f32 v43, v43
    v_exp_f32 v44, v44
    v_mfma_f32_32x32x16_bf16 v[56:71], v[104:107], v[20:23], 0
    ds_read_b128 v[104:107], v37 offset:24576
    v_exp_f32 v45, v45
    v_exp_f32 v46, v46
    v_exp_f32 v47, v47
    v_exp_f32 v48, v48
    v_exp_f32 v49, v49
    s_waitcnt lgkmcnt(2)
    v_smfmac_f32_32x32x32_bf16 v[72:87], v[108:111], v[40:47], v2
    v_exp_f32 v50, v50
    v_exp_f32 v51, v51
    v_exp_f32 v52, v52
    v_exp_f32 v53, v53
    v_exp_f32 v54, v54
    v_exp_f32 v55, v55
    v_exp_f32 v56, v56
    v_exp_f32 v57, v57
    s_waitcnt lgkmcnt(1)
    v_smfmac_f32_32x32x32_bf16 v[72:87], v[112:115], v[48:55], v2
    v_exp_f32 v58, v58
    v_exp_f32 v59, v59
    v_exp_f32 v60, v60
    s_waitcnt lgkmcnt(0)
    v_mfma_f32_32x32x16_bf16 v[40:55], v[104:107], v[16:19], 0
    v_exp_f32 v61, v61
    v_exp_f32 v62, v62
    v_exp_f32 v63, v63
    v_exp_f32 v64, v64
    v_exp_f32 v65, v65
    v_smfmac_f32_32x32x32_bf16 v[88:103], v[108:111], v[56:63], v2
    s_mov_b64 exec, s[66:67]
    ds_read_b128 v[108:111], v37 offset:25600
    s_mov_b64 exec, -1
    s_cmp_lg_u32 s56, 0
    s_cbranch_scc1 L_old_19
    s_waitcnt vmcnt(5)
    s_branch L_old_20
L_old_19:
    s_waitcnt vmcnt(0)
L_old_20:
L_kv_chk_21:
    ds_read_b32 v232, v36 offset:32768
    ds_read_b32 v233, v36 offset:40960
    ds_read_b32 v234, v36 offset:49152
    ds_read_b32 v235, v36 offset:57344
    s_waitcnt lgkmcnt(0)
    v_max_u32 v232, v232, v233
    v_max3_u32 v232, v232, v234, v235
    v_cmp_eq_u32 vcc, -1, v232
    s_cbranch_vccnz L_kv_stub_23
L_kv_ok_22:
    v_exp_f32 v66, v66
    v_exp_f32 v67, v67
    v_exp_f32 v68, v68
    v_exp_f32 v69, v69
    v_exp_f32 v70, v70
    v_exp_f32 v71, v71
    v_exp_f32 v40, v40
    v_exp_f32 v41, v41
    v_smfmac_f32_32x32x32_bf16 v[88:103], v[112:115], v[64:71], v2
    s_mov_b64 exec, s[66:67]
    ds_read_b128 v[112:115], v37 offset:26112
    s_mov_b64 exec, -1
    v_exp_f32 v42, v42
    v_exp_f32 v43, v43
    v_exp_f32 v44, v44
    v_mfma_f32_32x32x16_bf16 v[56:71], v[104:107], v[20:23], 0
    ds_read_b128 v[104:107], v37 offset:28672
    v_exp_f32 v45, v45
    v_exp_f32 v46, v46
    v_exp_f32 v47, v47
    v_exp_f32 v48, v48
    v_exp_f32 v49, v49
    v_smfmac_f32_32x32x32_bf16 v[72:87], v[108:111], v[40:47], v2
    s_add_u32 m0, s77, 98304
    s_xor_b32 s75, s76, 32768
    buffer_load_dwordx4 v38, s[44:47], s75 offen sc1 lds
    s_setprio 1
    v_exp_f32 v50, v50
    v_exp_f32 v51, v51
    v_exp_f32 v52, v52
    v_exp_f32 v53, v53
    v_exp_f32 v54, v54
    v_exp_f32 v55, v55
    v_exp_f32 v56, v56
    v_exp_f32 v57, v57
    s_waitcnt lgkmcnt(1)
    v_smfmac_f32_32x32x32_bf16 v[72:87], v[112:115], v[48:55], v2
    v_exp_f32 v58, v58
    v_exp_f32 v59, v59
    v_exp_f32 v60, v60
    s_waitcnt lgkmcnt(0)
    v_mfma_f32_32x32x16_bf16 v[40:55], v[104:107], v[16:19], 0
    v_exp_f32 v61, v61
    v_exp_f32 v62, v62
    v_exp_f32 v63, v63
    v_exp_f32 v64, v64
    v_exp_f32 v65, v65
    v_smfmac_f32_32x32x32_bf16 v[88:103], v[108:111], v[56:63], v2
    s_mov_b64 exec, s[66:67]
    ds_read_b128 v[108:111], v37 offset:29696
    s_mov_b64 exec, -1
    s_add_u32 m0, s77, 106496
    s_xor_b32 s75, s76, 36864
    buffer_load_dwordx4 v38, s[44:47], s75 offen sc1 lds
    s_setprio 0
    v_exp_f32 v66, v66
    v_exp_f32 v67, v67
    v_exp_f32 v68, v68
    v_exp_f32 v69, v69
    v_exp_f32 v70, v70
    v_exp_f32 v71, v71
    v_exp_f32 v40, v40
    v_exp_f32 v41, v41
    v_smfmac_f32_32x32x32_bf16 v[88:103], v[112:115], v[64:71], v2
    s_mov_b64 exec, s[66:67]
    ds_read_b128 v[112:115], v37 offset:30208
    s_mov_b64 exec, -1
    v_exp_f32 v42, v42
    v_exp_f32 v43, v43
    v_exp_f32 v44, v44
    v_mfma_f32_32x32x16_bf16 v[56:71], v[104:107], v[20:23], 0
    s_waitcnt lgkmcnt(0)
    s_barrier
    s_setprio 3
    ds_read_b128 v[104:107], v37 offset:32768
    v_exp_f32 v45, v45
    v_exp_f32 v46, v46
    v_exp_f32 v47, v47
    v_exp_f32 v48, v48
    v_exp_f32 v49, v49
    v_smfmac_f32_32x32x32_bf16 v[72:87], v[108:111], v[40:47], v2
    v_add_u32 v120, 73728, v11
    v_xor_b32 v121, 64, v120
    ds_read_b64_tr_b16 v[128:129], v120 offset:0
    ds_read_b64_tr_b16 v[130:131], v120 offset:4096
    ds_read_b64_tr_b16 v[132:133], v121 offset:0
    ds_read_b64_tr_b16 v[134:135], v121 offset:4096
    s_add_u32 m0, s77, 114688
    s_xor_b32 s75, s76, 40960
    buffer_load_dwordx4 v38, s[44:47], s75 offen sc1 lds
    s_add_u32 m0, s77, 0
    s_xor_b32 s75, s78, 49152
    buffer_load_dwordx4 v8, s[16:19], s75 offen  lds
    v_exp_f32 v50, v50
    v_exp_f32 v51, v51
    v_exp_f32 v52, v52
    v_exp_f32 v53, v53
    v_exp_f32 v54, v54
    v_exp_f32 v55, v55
    v_exp_f32 v56, v56
    v_exp_f32 v57, v57
    v_smfmac_f32_32x32x32_bf16 v[72:87], v[112:115], v[48:55], v2
    v_exp_f32 v58, v58
    v_exp_f32 v59, v59
    v_exp_f32 v60, v60
    s_waitcnt lgkmcnt(4)
    v_mfma_f32_32x32x16_bf16 v[40:55], v[104:107], v[16:19], 0
    v_exp_f32 v61, v61
    v_exp_f32 v62, v62
    v_exp_f32 v63, v63
    v_exp_f32 v64, v64
    v_exp_f32 v65, v65
    v_smfmac_f32_32x32x32_bf16 v[88:103], v[108:111], v[56:63], v2
    s_mov_b64 exec, s[66:67]
    ds_read_b128 v[108:111], v37 offset:33792
    s_mov_b64 exec, -1
    ds_read_b64_tr_b16 v[136:137], v120 offset:8192
    ds_read_b64_tr_b16 v[138:139], v120 offset:12288
    ds_read_b64_tr_b16 v[140:141], v121 offset:8192
    ds_read_b64_tr_b16 v[142:143], v121 offset:12288
    s_add_u32 m0, s77, 122880
    s_xor_b32 s75, s76, 45056
    buffer_load_dwordx4 v38, s[44:47], s75 offen sc1 lds
    v_exp_f32 v66, v66
    v_exp_f32 v67, v67
    v_exp_f32 v68, v68
    v_exp_f32 v69, v69
    v_exp_f32 v70, v70
    v_exp_f32 v71, v71
    v_exp_f32 v40, v40
    v_exp_f32 v41, v41
    v_smfmac_f32_32x32x32_bf16 v[88:103], v[112:115], v[64:71], v2
    s_mov_b64 exec, s[66:67]
    ds_read_b128 v[112:115], v37 offset:34304
    s_mov_b64 exec, -1
    v_exp_f32 v42, v42
    v_exp_f32 v43, v43
    v_exp_f32 v44, v44
    v_mfma_f32_32x32x16_bf16 v[56:71], v[104:107], v[20:23], 0
    ds_read_b128 v[104:107], v37 offset:36864
    v_exp_f32 v45, v45
    v_exp_f32 v46, v46
    v_exp_f32 v47, v47
    v_exp_f32 v48, v48
    v_exp_f32 v49, v49
    s_waitcnt lgkmcnt(6)
    v_smfmac_f32_32x32x32_bf16 v[72:87], v[108:111], v[40:47], v2
    ds_read_b64_tr_b16 v[144:145], v120 offset:16384
    ds_read_b64_tr_b16 v[146:147], v120 offset:20480
    ds_read_b64_tr_b16 v[148:149], v121 offset:16384
    ds_read_b64_tr_b16 v[150:151], v121 offset:20480
    s_add_u32 m0, s77, 131072
    s_xor_b32 s75, s76, 49152
    buffer_load_dwordx4 v38, s[44:47], s75 offen sc1 lds
    s_add_u32 m0, s77, 8192
    s_xor_b32 s75, s78, 65536
    buffer_load_dwordx4 v8, s[16:19], s75 offen  lds
    v_exp_f32 v50, v50
    v_exp_f32 v51, v51
    v_exp_f32 v52, v52
    v_exp_f32 v53, v53
    v_exp_f32 v54, v54
    v_exp_f32 v55, v55
    v_exp_f32 v56, v56
    v_exp_f32 v57, v57
    s_waitcnt lgkmcnt(5)
    v_smfmac_f32_32x32x32_bf16 v[72:87], v[112:115], v[48:55], v2
    v_exp_f32 v58, v58
    v_exp_f32 v59, v59
    v_exp_f32 v60, v60
    s_waitcnt lgkmcnt(4)
    v_mfma_f32_32x32x16_bf16 v[40:55], v[104:107], v[16:19], 0
    v_exp_f32 v61, v61
    v_exp_f32 v62, v62
    v_exp_f32 v63, v63
    v_exp_f32 v64, v64
    v_exp_f32 v65, v65
    v_smfmac_f32_32x32x32_bf16 v[88:103], v[108:111], v[56:63], v2
    s_mov_b64 exec, s[66:67]
    ds_read_b128 v[108:111], v37 offset:37888
    s_mov_b64 exec, -1
    s_add_u32 m0, s77, 139264
    s_xor_b32 s75, s76, 53248
    buffer_load_dwordx4 v38, s[44:47], s75 offen sc1 lds
    v_exp_f32 v66, v66
    v_exp_f32 v67, v67
    v_exp_f32 v68, v68
    v_exp_f32 v69, v69
    v_exp_f32 v70, v70
    v_exp_f32 v71, v71
    v_exp_f32 v40, v40
    v_exp_f32 v41, v41
    v_smfmac_f32_32x32x32_bf16 v[88:103], v[112:115], v[64:71], v2
    s_mov_b64 exec, s[66:67]
    ds_read_b128 v[112:115], v37 offset:38400
    s_mov_b64 exec, -1
    v_exp_f32 v42, v42
    v_exp_f32 v43, v43
    v_exp_f32 v44, v44
    v_mfma_f32_32x32x16_bf16 v[56:71], v[104:107], v[20:23], 0
    ds_read_b128 v[104:107], v37 offset:40960
    v_exp_f32 v45, v45
    v_exp_f32 v46, v46
    v_exp_f32 v47, v47
    v_exp_f32 v48, v48
    v_exp_f32 v49, v49
    s_waitcnt lgkmcnt(2)
    v_smfmac_f32_32x32x32_bf16 v[72:87], v[108:111], v[40:47], v2
    s_add_u32 m0, s77, 147456
    s_xor_b32 s75, s76, 57344
    buffer_load_dwordx4 v38, s[44:47], s75 offen sc1 lds
    s_add_u32 m0, s77, 16384
    s_xor_b32 s75, s78, 81920
    buffer_load_dwordx4 v8, s[16:19], s75 offen  lds
    v_exp_f32 v50, v50
    v_exp_f32 v51, v51
    v_exp_f32 v52, v52
    v_exp_f32 v53, v53
    v_exp_f32 v54, v54
    v_exp_f32 v55, v55
    v_exp_f32 v56, v56
    v_exp_f32 v57, v57
    s_waitcnt lgkmcnt(1)
    v_smfmac_f32_32x32x32_bf16 v[72:87], v[112:115], v[48:55], v2
    v_exp_f32 v58, v58
    v_exp_f32 v59, v59
    v_exp_f32 v60, v60
    s_waitcnt lgkmcnt(0)
    v_mfma_f32_32x32x16_bf16 v[40:55], v[104:107], v[16:19], 0
    v_exp_f32 v61, v61
    v_exp_f32 v62, v62
    v_exp_f32 v63, v63
    v_exp_f32 v64, v64
    v_exp_f32 v65, v65
    v_smfmac_f32_32x32x32_bf16 v[88:103], v[108:111], v[56:63], v2
    s_mov_b64 exec, s[66:67]
    ds_read_b128 v[108:111], v37 offset:41984
    s_mov_b64 exec, -1
    s_add_u32 m0, s77, 155648
    s_xor_b32 s75, s76, 61440
    buffer_load_dwordx4 v38, s[44:47], s75 offen sc1 lds
    v_exp_f32 v66, v66
    v_exp_f32 v67, v67
    v_exp_f32 v68, v68
    v_exp_f32 v69, v69
    v_exp_f32 v70, v70
    v_exp_f32 v71, v71
    v_exp_f32 v40, v40
    v_exp_f32 v41, v41
    v_smfmac_f32_32x32x32_bf16 v[88:103], v[112:115], v[64:71], v2
    s_mov_b64 exec, s[66:67]
    ds_read_b128 v[112:115], v37 offset:42496
    s_mov_b64 exec, -1
    v_exp_f32 v42, v42
    v_exp_f32 v43, v43
    v_exp_f32 v44, v44
    v_mfma_f32_32x32x16_bf16 v[56:71], v[104:107], v[20:23], 0
    ds_read_b128 v[104:107], v37 offset:45056
    v_exp_f32 v45, v45
    v_exp_f32 v46, v46
    v_exp_f32 v47, v47
    v_exp_f32 v48, v48
    v_exp_f32 v49, v49
    s_waitcnt lgkmcnt(2)
    v_smfmac_f32_32x32x32_bf16 v[72:87], v[108:111], v[40:47], v2
    s_lshl_b32 s68, s48, 3
    s_add_u32 s68, s68, s51
    s_and_b32 s69, s68, 1
    s_lshr_b32 s68, s68, 1
    s_lshl_b32 s68, s68, 2
    s_add_u32 s68, s68, s52
    s_lshl_b32 s70, s69, 3
    s_add_u32 s70, s70, s50
    s_mul_i32 s70, s70, 196608
    s_lshl_b32 s71, s68, 5
    s_add_u32 s70, s70, s71
    s_add_u32 m0, s77, 24576
    s_add_u32 s75, s70, 2048
    buffer_load_dwordx4 v4, s[36:39], s75 offen  lds
    s_lshl_b32 s69, s69, 13
    s_lshl_b32 s68, s68, 6
    s_add_u32 s68, s68, s69
    s_add_u32 s73, s68, 32768
    v_exp_f32 v50, v50
    v_exp_f32 v51, v51
    v_exp_f32 v52, v52
    v_exp_f32 v53, v53
    v_exp_f32 v54, v54
    v_exp_f32 v55, v55
    v_exp_f32 v56, v56
    v_exp_f32 v57, v57
    s_waitcnt lgkmcnt(1)
    v_smfmac_f32_32x32x32_bf16 v[72:87], v[112:115], v[48:55], v2
    v_exp_f32 v58, v58
    v_exp_f32 v59, v59
    v_exp_f32 v60, v60
    s_waitcnt lgkmcnt(0)
    v_mfma_f32_32x32x16_bf16 v[40:55], v[104:107], v[16:19], 0
    v_exp_f32 v61, v61
    v_exp_f32 v62, v62
    v_exp_f32 v63, v63
    v_exp_f32 v64, v64
    v_exp_f32 v65, v65
    v_smfmac_f32_32x32x32_bf16 v[88:103], v[108:111], v[56:63], v2
    s_mov_b64 exec, s[66:67]
    ds_read_b128 v[108:111], v37 offset:46080
    s_mov_b64 exec, -1
    buffer_store_dwordx4 v[24:27], v3, s[44:47], 0 offen sc1
    v_exp_f32 v66, v66
    v_exp_f32 v67, v67
    v_exp_f32 v68, v68
    v_exp_f32 v69, v69
    v_exp_f32 v70, v70
    v_exp_f32 v71, v71
    v_exp_f32 v40, v40
    v_exp_f32 v41, v41
    v_smfmac_f32_32x32x32_bf16 v[88:103], v[112:115], v[64:71], v2
    s_mov_b64 exec, s[66:67]
    ds_read_b128 v[112:115], v37 offset:46592
    s_mov_b64 exec, -1
    v_exp_f32 v42, v42
    v_exp_f32 v43, v43
    v_exp_f32 v44, v44
    v_mfma_f32_32x32x16_bf16 v[56:71], v[104:107], v[20:23], 0
    ds_read_b128 v[104:107], v37 offset:49152
    v_exp_f32 v45, v45
    v_exp_f32 v46, v46
    v_exp_f32 v47, v47
    v_exp_f32 v48, v48
    v_exp_f32 v49, v49
    s_waitcnt lgkmcnt(2)
    v_smfmac_f32_32x32x32_bf16 v[72:87], v[108:111], v[40:47], v2
    buffer_store_dwordx4 v[24:27], v5, s[44:47], 0 offen sc1
    buffer_store_dword v24, v7, s[44:47], 0 offen sc1
    v_exp_f32 v50, v50
    v_exp_f32 v51, v51
    v_exp_f32 v52, v52
    v_exp_f32 v53, v53
    v_exp_f32 v54, v54
    v_exp_f32 v55, v55
    v_exp_f32 v56, v56
    v_exp_f32 v57, v57
    s_waitcnt lgkmcnt(1)
    v_smfmac_f32_32x32x32_bf16 v[72:87], v[112:115], v[48:55], v2
    v_exp_f32 v58, v58
    v_exp_f32 v59, v59
    v_exp_f32 v60, v60
    s_waitcnt lgkmcnt(0)
    v_mfma_f32_32x32x16_bf16 v[40:55], v[104:107], v[16:19], 0
    v_exp_f32 v61, v61
    v_exp_f32 v62, v62
    v_exp_f32 v63, v63
    v_exp_f32 v64, v64
    v_exp_f32 v65, v65
    v_smfmac_f32_32x32x32_bf16 v[88:103], v[108:111], v[56:63], v2
    s_mov_b64 exec, s[66:67]
    ds_read_b128 v[108:111], v37 offset:50176
    s_mov_b64 exec, -1
    s_lshl_b32 s68, s56, 3
    s_add_u32 s68, s68, 6
    s_cmp_gt_u32 s82, s68
    s_cselect_b32 s74, s80, s81
    s_lshl_b32 s68, s68, 14
    s_add_u32 s74, s74, s68
    buffer_load_dwordx4 v[192:195], v8, s[28:31], s74 offen
    v_exp_f32 v66, v66
    v_exp_f32 v67, v67
    v_exp_f32 v68, v68
    v_exp_f32 v69, v69
    v_exp_f32 v70, v70
    v_exp_f32 v71, v71
    v_exp_f32 v40, v40
    v_exp_f32 v41, v41
    v_smfmac_f32_32x32x32_bf16 v[88:103], v[112:115], v[64:71], v2
    s_mov_b64 exec, s[66:67]
    ds_read_b128 v[112:115], v37 offset:50688
    s_mov_b64 exec, -1
    v_exp_f32 v42, v42
    v_exp_f32 v43, v43
    v_exp_f32 v44, v44
    v_mfma_f32_32x32x16_bf16 v[56:71], v[104:107], v[20:23], 0
    ds_read_b128 v[104:107], v37 offset:53248
    v_exp_f32 v45, v45
    v_exp_f32 v46, v46
    v_exp_f32 v47, v47
    v_exp_f32 v48, v48
    v_exp_f32 v49, v49
    s_waitcnt lgkmcnt(2)
    v_smfmac_f32_32x32x32_bf16 v[72:87], v[108:111], v[40:47], v2
    s_add_u32 s74, s74, 8192
    buffer_load_dwordx4 v[196:199], v8, s[28:31], s74 offen
    v_exp_f32 v50, v50
    v_exp_f32 v51, v51
    v_exp_f32 v52, v52
    v_exp_f32 v53, v53
    v_exp_f32 v54, v54
    v_exp_f32 v55, v55
    v_exp_f32 v56, v56
    v_exp_f32 v57, v57
    s_waitcnt lgkmcnt(1)
    v_smfmac_f32_32x32x32_bf16 v[72:87], v[112:115], v[48:55], v2
    v_exp_f32 v58, v58
    v_exp_f32 v59, v59
    v_exp_f32 v60, v60
    s_waitcnt lgkmcnt(0)
    v_mfma_f32_32x32x16_bf16 v[40:55], v[104:107], v[16:19], 0
    v_exp_f32 v61, v61
    v_exp_f32 v62, v62
    v_exp_f32 v63, v63
    v_exp_f32 v64, v64
    v_exp_f32 v65, v65
    v_smfmac_f32_32x32x32_bf16 v[88:103], v[108:111], v[56:63], v2
    s_mov_b64 exec, s[66:67]
    ds_read_b128 v[108:111], v37 offset:54272
    s_mov_b64 exec, -1
    s_lshl_b32 s68, s56, 3
    s_add_u32 s68, s68, 7
    s_cmp_gt_u32 s82, s68
    s_cselect_b32 s74, s80, s81
    s_lshl_b32 s68, s68, 14
    s_add_u32 s74, s74, s68
    buffer_load_dwordx4 v[200:203], v8, s[28:31], s74 offen
    s_setprio 2
    v_exp_f32 v66, v66
    v_exp_f32 v67, v67
    v_exp_f32 v68, v68
    v_exp_f32 v69, v69
    v_exp_f32 v70, v70
    v_exp_f32 v71, v71
    v_exp_f32 v40, v40
    v_exp_f32 v41, v41
    v_smfmac_f32_32x32x32_bf16 v[88:103], v[112:115], v[64:71], v2
    s_mov_b64 exec, s[66:67]
    ds_read_b128 v[112:115], v37 offset:54784
    s_mov_b64 exec, -1
    v_exp_f32 v42, v42
    v_exp_f32 v43, v43
    v_exp_f32 v44, v44
    v_mfma_f32_32x32x16_bf16 v[56:71], v[104:107], v[20:23], 0
    ds_read_b128 v[104:107], v37 offset:57344
    v_exp_f32 v45, v45
    v_exp_f32 v46, v46
    v_exp_f32 v47, v47
    v_exp_f32 v48, v48
    v_exp_f32 v49, v49
    s_waitcnt lgkmcnt(2)
    v_smfmac_f32_32x32x32_bf16 v[72:87], v[108:111], v[40:47], v2
    s_add_u32 s74, s74, 8192
    buffer_load_dwordx4 v[204:207], v8, s[28:31], s74 offen
    v_exp_f32 v50, v50
    v_exp_f32 v51, v51
    v_exp_f32 v52, v52
    v_exp_f32 v53, v53
    v_exp_f32 v54, v54
    v_exp_f32 v55, v55
    v_exp_f32 v56, v56
    v_exp_f32 v57, v57
    s_waitcnt lgkmcnt(1)
    v_smfmac_f32_32x32x32_bf16 v[72:87], v[112:115], v[48:55], v2
    v_exp_f32 v58, v58
    v_exp_f32 v59, v59
    v_exp_f32 v60, v60
    s_waitcnt lgkmcnt(0)
    v_mfma_f32_32x32x16_bf16 v[40:55], v[104:107], v[16:19], 0
    v_exp_f32 v61, v61
    v_exp_f32 v62, v62
    v_exp_f32 v63, v63
    v_exp_f32 v64, v64
    v_exp_f32 v65, v65
    v_smfmac_f32_32x32x32_bf16 v[88:103], v[108:111], v[56:63], v2
    s_mov_b64 exec, s[66:67]
    ds_read_b128 v[108:111], v37 offset:58368
    s_mov_b64 exec, -1
    v_add_u32 v13, 98304, v36
    s_waitcnt vmcnt(8)
L_kv_chk_24:
    ds_read_b32 v232, v13 offset:0
    ds_read_b32 v233, v13 offset:8192
    ds_read_b32 v234, v13 offset:16384
    ds_read_b32 v235, v13 offset:24576
    ds_read_b32 v236, v13 offset:32768
    ds_read_b32 v237, v13 offset:40960
    ds_read_b32 v238, v13 offset:49152
    ds_read_b32 v239, v13 offset:57344
    s_waitcnt lgkmcnt(0)
    v_max_u32 v232, v232, v233
    v_max3_u32 v232, v232, v234, v235
    v_max3_u32 v232, v232, v236, v237
    v_max3_u32 v232, v232, v238, v239
    v_cmp_eq_u32 vcc, -1, v232
    s_cbranch_vccnz L_kv_stub_26
L_kv_ok_25:
    s_lshl_b32 s68, s56, 3
    s_add_u32 s68, s68, 8
    s_cmp_gt_u32 s82, s68
    s_cselect_b32 s74, s80, s81
    s_lshl_b32 s68, s68, 14
    s_add_u32 s74, s74, s68
    buffer_load_dwordx4 v[208:211], v8, s[28:31], s74 offen
    v_exp_f32 v66, v66
    v_exp_f32 v67, v67
    v_exp_f32 v68, v68
    v_exp_f32 v69, v69
    v_exp_f32 v70, v70
    v_exp_f32 v71, v71
    v_exp_f32 v40, v40
    v_exp_f32 v41, v41
    v_smfmac_f32_32x32x32_bf16 v[88:103], v[112:115], v[64:71], v2
    s_mov_b64 exec, s[66:67]
    ds_read_b128 v[112:115], v37 offset:58880
    s_mov_b64 exec, -1
    v_exp_f32 v42, v42
    v_exp_f32 v43, v43
    v_exp_f32 v44, v44
    v_mfma_f32_32x32x16_bf16 v[56:71], v[104:107], v[20:23], 0
    ds_read_b128 v[104:107], v37 offset:61440
    v_exp_f32 v45, v45
    v_exp_f32 v46, v46
    v_exp_f32 v47, v47
    v_exp_f32 v48, v48
    v_exp_f32 v49, v49
    v_smfmac_f32_32x32x32_bf16 v[72:87], v[108:111], v[40:47], v2
    buffer_store_dwordx4 v[24:27], v6, s[44:47], 0 offen sc1
    s_add_u32 s74, s74, 8192
    buffer_load_dwordx4 v[212:215], v8, s[28:31], s74 offen
    s_setprio 1
    v_exp_f32 v50, v50
    v_exp_f32 v51, v51
    v_exp_f32 v52, v52
    v_exp_f32 v53, v53
    v_exp_f32 v54, v54
    v_exp_f32 v55, v55
    v_exp_f32 v56, v56
    v_exp_f32 v57, v57
    s_waitcnt lgkmcnt(1)
    v_smfmac_f32_32x32x32_bf16 v[72:87], v[112:115], v[48:55], v2
    v_exp_f32 v58, v58
    v_exp_f32 v59, v59
    v_exp_f32 v60, v60
    s_waitcnt lgkmcnt(0)
    v_mfma_f32_32x32x16_bf16 v[40:55], v[104:107], v[16:19], 0
    v_exp_f32 v61, v61
    v_exp_f32 v62, v62
    v_exp_f32 v63, v63
    v_exp_f32 v64, v64
    v_exp_f32 v65, v65
    v_smfmac_f32_32x32x32_bf16 v[88:103], v[108:111], v[56:63], v2
    s_mov_b64 exec, s[66:67]
    ds_read_b128 v[108:111], v37 offset:62464
    s_mov_b64 exec, -1
    s_lshl_b32 s68, s56, 3
    s_add_u32 s68, s68, 9
    s_cmp_gt_u32 s82, s68
    s_cselect_b32 s74, s80, s81
    s_lshl_b32 s68, s68, 14
    s_add_u32 s74, s74, s68
    buffer_load_dwordx4 v[216:219], v8, s[28:31], s74 offen
    s_setprio 0
    v_exp_f32 v66, v66
    v_exp_f32 v67, v67
    v_exp_f32 v68, v68
    v_exp_f32 v69, v69
    v_exp_f32 v70, v70
    v_exp_f32 v71, v71
    v_exp_f32 v40, v40
    v_exp_f32 v41, v41
    v_smfmac_f32_32x32x32_bf16 v[88:103], v[112:115], v[64:71], v2
    s_mov_b64 exec, s[66:67]
    ds_read_b128 v[112:115], v37 offset:62976
    s_mov_b64 exec, -1
    v_exp_f32 v42, v42
    v_exp_f32 v43, v43
    v_exp_f32 v44, v44
    v_mfma_f32_32x32x16_bf16 v[56:71], v[104:107], v[20:23], 0
    s_waitcnt vmcnt(8)
    s_waitcnt lgkmcnt(0)
    s_barrier
    s_setprio 3
    ds_read_b128 v[104:107], v39 offset:0
    v_exp_f32 v45, v45
    v_exp_f32 v46, v46
    v_exp_f32 v47, v47
    v_exp_f32 v48, v48
    v_exp_f32 v49, v49
    v_smfmac_f32_32x32x32_bf16 v[72:87], v[108:111], v[40:47], v2
    s_cmp_lg_u32 s50, 5
    s_cbranch_scc1 L_nomb_27
    v_lshrrev_b32 v12, 4, v0
    v_and_b32 v13, 15, v0
    v_lshlrev_b32 v13, 3, v13
    v_lshl_add_u32 v13, v12, 8, v13
    ds_read_b64_tr_b16 v[224:225], v13 offset:24576
    ds_read_b64_tr_b16 v[226:227], v13 offset:24704
    ds_read_b64_tr_b16 v[228:229], v13 offset:25600
    ds_read_b64_tr_b16 v[230:231], v13 offset:25728
    ds_read_b64_tr_b16 v[232:233], v13 offset:26624
    ds_read_b64_tr_b16 v[234:235], v13 offset:26752
    ds_read_b64_tr_b16 v[236:237], v13 offset:27648
    ds_read_b64_tr_b16 v[238:239], v13 offset:27776
    ds_read_b64_tr_b16 v[240:241], v13 offset:28672
    ds_read_b64_tr_b16 v[242:243], v13 offset:28800
    ds_read_b64_tr_b16 v[244:245], v13 offset:29696
    ds_read_b64_tr_b16 v[246:247], v13 offset:29824
    ds_read_b64_tr_b16 v[248:249], v13 offset:30720
    ds_read_b64_tr_b16 v[250:251], v13 offset:30848
    ds_read_b64_tr_b16 v[252:253], v13 offset:31744
    ds_read_b64_tr_b16 v[254:255], v13 offset:31872
    v_lshlrev_b32 v13, 3, v0
    ds_write_b64 v13, v[14:15] offset:24576
    v_lshlrev_b32 v12, 4, v12
    ds_read_b128 v[176:179], v12 offset:24576
    ds_read_b128 v[180:183], v12 offset:24640
    ds_read_b128 v[184:187], v12 offset:24704
    ds_read_b128 v[188:191], v12 offset:24768
    s_waitcnt lgkmcnt(0)
    v_mfma_f32_16x16x32_bf16 v[124:127], v[176:179], v[224:227], 0
    v_mfma_f32_16x16x32_bf16 v[124:127], v[180:183], v[228:231], v[124:127]
    v_mfma_f32_16x16x32_bf16 v[124:127], v[184:187], v[232:235], v[124:127]
    v_mfma_f32_16x16x32_bf16 v[124:127], v[188:191], v[236:239], v[124:127]
    ds_read_b128 v[176:179], v12 offset:24832
    ds_read_b128 v[180:183], v12 offset:24896
    ds_read_b128 v[184:187], v12 offset:24960
    ds_read_b128 v[188:191], v12 offset:25024
    s_waitcnt lgkmcnt(0)
    v_mfma_f32_16x16x32_bf16 v[124:127], v[176:179], v[240:243], v[124:127]
    v_mfma_f32_16x16x32_bf16 v[124:127], v[180:183], v[244:247], v[124:127]
    v_mfma_f32_16x16x32_bf16 v[124:127], v[184:187], v[248:251], v[124:127]
    v_mfma_f32_16x16x32_bf16 v[124:127], v[188:191], v[252:255], v[124:127]
    v_and_b32 v14, 3, v0
    v_lshlrev_b32 v14, 3, v14
    v_lshrrev_b32 v14, v14, s57
    s_movk_i32 s75, 0xff
    v_lshlrev_b32 v15, 2, v0
    s_mov_b64 exec, 0xffff
    s_nop 1
    v_bfi_b32 v124, s75, v14, v124
    buffer_store_dword v124, v15, s[44:47], s73 offen sc1
    s_mov_b64 exec, -1
L_nomb_27:
    v_add_u32 v120, 0, v11
    v_xor_b32 v121, 64, v120
    ds_read_b64_tr_b16 v[152:153], v120 offset:0
    ds_read_b64_tr_b16 v[154:155], v120 offset:4096
    ds_read_b64_tr_b16 v[156:157], v121 offset:0
    ds_read_b64_tr_b16 v[158:159], v121 offset:4096
    s_add_u32 m0, s77, 32768
    s_mov_b32 s75, 704512
    buffer_load_dwordx4 v10, s[20:23], s75 offen  lds
    v_exp_f32 v50, v50
    v_exp_f32 v51, v51
    v_exp_f32 v52, v52
    v_exp_f32 v53, v53
    v_exp_f32 v54, v54
    v_exp_f32 v55, v55
    v_exp_f32 v56, v56
    v_exp_f32 v57, v57
    v_smfmac_f32_32x32x32_bf16 v[72:87], v[112:115], v[48:55], v2
    v_exp_f32 v58, v58
    v_exp_f32 v59, v59
    v_exp_f32 v60, v60
    s_waitcnt lgkmcnt(4)
    v_mfma_f32_32x32x16_bf16 v[40:55], v[104:107], v[16:19], 0
    v_exp_f32 v61, v61
    v_exp_f32 v62, v62
    v_exp_f32 v63, v63
    v_exp_f32 v64, v64
    v_exp_f32 v65, v65
    v_smfmac_f32_32x32x32_bf16 v[88:103], v[108:111], v[56:63], v2
    s_mov_b64 exec, s[66:67]
    ds_read_b128 v[108:111], v39 offset:1024
    s_mov_b64 exec, -1
    ds_read_b64_tr_b16 v[160:161], v120 offset:8192
    ds_read_b64_tr_b16 v[162:163], v120 offset:12288
    ds_read_b64_tr_b16 v[164:165], v121 offset:8192
    ds_read_b64_tr_b16 v[166:167], v121 offset:12288
    s_add_u32 s74, s74, 8192
    buffer_load_dwordx4 v[220:223], v8, s[28:31], s74 offen
    v_exp_f32 v66, v66
    v_exp_f32 v67, v67
    v_exp_f32 v68, v68
    v_exp_f32 v69, v69
    v_exp_f32 v70, v70
    v_exp_f32 v71, v71
    v_exp_f32 v40, v40
    v_exp_f32 v41, v41
    v_smfmac_f32_32x32x32_bf16 v[88:103], v[112:115], v[64:71], v2
    s_mov_b64 exec, s[66:67]
    ds_read_b128 v[112:115], v39 offset:1536
    s_mov_b64 exec, -1
    v_exp_f32 v42, v42
    v_exp_f32 v43, v43
    v_exp_f32 v44, v44
    v_mfma_f32_32x32x16_bf16 v[56:71], v[104:107], v[20:23], 0
    ds_read_b128 v[104:107], v39 offset:4096
    v_exp_f32 v45, v45
    v_exp_f32 v46, v46
    v_exp_f32 v47, v47
    v_exp_f32 v48, v48
    v_exp_f32 v49, v49
    s_waitcnt lgkmcnt(6)
    v_smfmac_f32_32x32x32_bf16 v[72:87], v[108:111], v[40:47], v2
    ds_read_b64_tr_b16 v[168:169], v120 offset:16384
    ds_read_b64_tr_b16 v[170:171], v120 offset:20480
    ds_read_b64_tr_b16 v[172:173], v121 offset:16384
    ds_read_b64_tr_b16 v[174:175], v121 offset:20480
    s_add_u32 m0, s77, 40960
    s_mov_b32 s75, 704512
    buffer_load_dwordx4 v116, s[20:23], s75 offen  lds
    v_exp_f32 v50, v50
    v_exp_f32 v51, v51
    v_exp_f32 v52, v52
    v_exp_f32 v53, v53
    v_exp_f32 v54, v54
    v_exp_f32 v55, v55
    v_exp_f32 v56, v56
    v_exp_f32 v57, v57
    s_waitcnt lgkmcnt(5)
    v_smfmac_f32_32x32x32_bf16 v[72:87], v[112:115], v[48:55], v2
    v_exp_f32 v58, v58
    v_exp_f32 v59, v59
    v_exp_f32 v60, v60
    s_waitcnt lgkmcnt(4)
    v_mfma_f32_32x32x16_bf16 v[40:55], v[104:107], v[16:19], 0
    v_exp_f32 v61, v61
    v_exp_f32 v62, v62
    v_exp_f32 v63, v63
    v_exp_f32 v64, v64
    v_exp_f32 v65, v65
    v_smfmac_f32_32x32x32_bf16 v[88:103], v[108:111], v[56:63], v2
    s_mov_b64 exec, s[66:67]
    ds_read_b128 v[108:111], v39 offset:5120
    s_mov_b64 exec, -1
    s_lshl_b32 s68, s56, 3
    s_add_u32 s68, s68, 10
    s_cmp_gt_u32 s82, s68
    s_cselect_b32 s74, s80, s81
    s_lshl_b32 s68, s68, 14
    s_add_u32 s74, s74, s68
    buffer_load_dwordx4 v[224:227], v8, s[28:31], s74 offen
    v_exp_f32 v66, v66
    v_exp_f32 v67, v67
    v_exp_f32 v68, v68
    v_exp_f32 v69, v69
    v_exp_f32 v70, v70
    v_exp_f32 v71, v71
    v_exp_f32 v40, v40
    v_exp_f32 v41, v41
    v_smfmac_f32_32x32x32_bf16 v[88:103], v[112:115], v[64:71], v2
    s_mov_b64 exec, s[66:67]
    ds_read_b128 v[112:115], v39 offset:5632
    s_mov_b64 exec, -1
    v_exp_f32 v42, v42
    v_exp_f32 v43, v43
    v_exp_f32 v44, v44
    v_mfma_f32_32x32x16_bf16 v[56:71], v[104:107], v[20:23], 0
    ds_read_b128 v[104:107], v39 offset:8192
    v_exp_f32 v45, v45
    v_exp_f32 v46, v46
    v_exp_f32 v47, v47
    v_exp_f32 v48, v48
    v_exp_f32 v49, v49
    s_waitcnt lgkmcnt(2)
    v_smfmac_f32_32x32x32_bf16 v[72:87], v[108:111], v[40:47], v2
    s_add_u32 m0, s77, 49152
    s_mov_b32 s75, 0
    buffer_load_dwordx4 v117, s[24:27], s75 offen  lds
    v_exp_f32 v50, v50
    v_exp_f32 v51, v51
    v_exp_f32 v52, v52
    v_exp_f32 v53, v53
    v_exp_f32 v54, v54
    v_exp_f32 v55, v55
    v_exp_f32 v56, v56
    v_exp_f32 v57, v57
    s_waitcnt lgkmcnt(1)
    v_smfmac_f32_32x32x32_bf16 v[72:87], v[112:115], v[48:55], v2
    v_exp_f32 v58, v58
    v_exp_f32 v59, v59
    v_exp_f32 v60, v60
    s_waitcnt lgkmcnt(0)
    v_mfma_f32_32x32x16_bf16 v[40:55], v[104:107], v[16:19], 0
    v_exp_f32 v61, v61
    v_exp_f32 v62, v62
    v_exp_f32 v63, v63
    v_exp_f32 v64, v64
    v_exp_f32 v65, v65
    v_smfmac_f32_32x32x32_bf16 v[88:103], v[108:111], v[56:63], v2
    s_mov_b64 exec, s[66:67]
    ds_read_b128 v[108:111], v39 offset:9216
    s_mov_b64 exec, -1
    s_add_u32 s74, s74, 8192
    buffer_load_dwordx4 v[228:231], v8, s[28:31], s74 offen
    v_exp_f32 v66, v66
    v_exp_f32 v67, v67
    v_exp_f32 v68, v68
    v_exp_f32 v69, v69
    v_exp_f32 v70, v70
    v_exp_f32 v71, v71
    v_exp_f32 v40, v40
    v_exp_f32 v41, v41
    v_smfmac_f32_32x32x32_bf16 v[88:103], v[112:115], v[64:71], v2
    s_mov_b64 exec, s[66:67]
    ds_read_b128 v[112:115], v39 offset:9728
    s_mov_b64 exec, -1
    v_exp_f32 v42, v42
    v_exp_f32 v43, v43
    v_exp_f32 v44, v44
    v_mfma_f32_32x32x16_bf16 v[56:71], v[104:107], v[20:23], 0
    ds_read_b128 v[104:107], v39 offset:12288
    v_exp_f32 v45, v45
    v_exp_f32 v46, v46
    v_exp_f32 v47, v47
    v_exp_f32 v48, v48
    v_exp_f32 v49, v49
    s_waitcnt lgkmcnt(2)
    v_smfmac_f32_32x32x32_bf16 v[72:87], v[108:111], v[40:47], v2
    s_add_u32 m0, s77, 57344
    s_mov_b32 s75, 0
    buffer_load_dwordx4 v118, s[24:27], s75 offen  lds
    v_exp_f32 v50, v50
    v_exp_f32 v51, v51
    v_exp_f32 v52, v52
    v_exp_f32 v53, v53
    v_exp_f32 v54, v54
    v_exp_f32 v55, v55
    v_exp_f32 v56, v56
    v_exp_f32 v57, v57
    s_waitcnt lgkmcnt(1)
    v_smfmac_f32_32x32x32_bf16 v[72:87], v[112:115], v[48:55], v2
    v_exp_f32 v58, v58
    v_exp_f32 v59, v59
    v_exp_f32 v60, v60
    s_waitcnt lgkmcnt(0)
    v_mfma_f32_32x32x16_bf16 v[40:55], v[104:107], v[16:19], 0
    v_exp_f32 v61, v61
    v_exp_f32 v62, v62
    v_exp_f32 v63, v63
    v_exp_f32 v64, v64
    v_exp_f32 v65, v65
    v_smfmac_f32_32x32x32_bf16 v[88:103], v[108:111], v[56:63], v2
    s_mov_b64 exec, s[66:67]
    ds_read_b128 v[108:111], v39 offset:13312
    s_mov_b64 exec, -1
    s_lshl_b32 s68, s56, 3
    s_add_u32 s68, s68, 11
    s_cmp_gt_u32 s82, s68
    s_cselect_b32 s74, s80, s81
    s_lshl_b32 s68, s68, 14
    s_add_u32 s74, s74, s68
    buffer_load_dwordx4 v[232:235], v8, s[28:31], s74 offen
    v_exp_f32 v66, v66
    v_exp_f32 v67, v67
    v_exp_f32 v68, v68
    v_exp_f32 v69, v69
    v_exp_f32 v70, v70
    v_exp_f32 v71, v71
    v_exp_f32 v40, v40
    v_exp_f32 v41, v41
    v_smfmac_f32_32x32x32_bf16 v[88:103], v[112:115], v[64:71], v2
    s_mov_b64 exec, s[66:67]
    ds_read_b128 v[112:115], v39 offset:13824
    s_mov_b64 exec, -1
    v_exp_f32 v42, v42
    v_exp_f32 v43, v43
    v_exp_f32 v44, v44
    v_mfma_f32_32x32x16_bf16 v[56:71], v[104:107], v[20:23], 0
    ds_read_b128 v[104:107], v39 offset:16384
    v_exp_f32 v45, v45
    v_exp_f32 v46, v46
    v_exp_f32 v47, v47
    v_exp_f32 v48, v48
    v_exp_f32 v49, v49
    s_waitcnt lgkmcnt(2)
    v_smfmac_f32_32x32x32_bf16 v[72:87], v[108:111], v[40:47], v2
    buffer_store_dwordx4 v[24:27], v6, s[44:47], 0 offen offset:1024 sc1
    s_add_u32 m0, s77, 65536
    s_mov_b32 s75, 0
    buffer_load_dwordx4 v119, s[24:27], s75 offen  lds
    v_exp_f32 v50, v50
    v_exp_f32 v51, v51
    v_exp_f32 v52, v52
    v_exp_f32 v53, v53
    v_exp_f32 v54, v54
    v_exp_f32 v55, v55
    v_exp_f32 v56, v56
    v_exp_f32 v57, v57
    s_waitcnt lgkmcnt(1)
    v_smfmac_f32_32x32x32_bf16 v[72:87], v[112:115], v[48:55], v2
    v_exp_f32 v58, v58
    v_exp_f32 v59, v59
    v_exp_f32 v60, v60
    s_waitcnt lgkmcnt(0)
    v_mfma_f32_32x32x16_bf16 v[40:55], v[104:107], v[16:19], 0
    v_exp_f32 v61, v61
    v_exp_f32 v62, v62
    v_exp_f32 v63, v63
    v_exp_f32 v64, v64
    v_exp_f32 v65, v65
    v_smfmac_f32_32x32x32_bf16 v[88:103], v[108:111], v[56:63], v2
    s_mov_b64 exec, s[66:67]
    ds_read_b128 v[108:111], v39 offset:17408
    s_mov_b64 exec, -1
    s_add_u32 s74, s74, 8192
    buffer_load_dwordx4 v[236:239], v8, s[28:31], s74 offen
    v_exp_f32 v66, v66
    v_exp_f32 v67, v67
    v_exp_f32 v68, v68
    v_exp_f32 v69, v69
    v_exp_f32 v70, v70
    v_exp_f32 v71, v71
    v_exp_f32 v40, v40
    v_exp_f32 v41, v41
    v_smfmac_f32_32x32x32_bf16 v[88:103], v[112:115], v[64:71], v2
    s_mov_b64 exec, s[66:67]
    ds_read_b128 v[112:115], v39 offset:17920
    s_mov_b64 exec, -1
    v_exp_f32 v42, v42
    v_exp_f32 v43, v43
    v_exp_f32 v44, v44
    v_mfma_f32_32x32x16_bf16 v[56:71], v[104:107], v[20:23], 0
    ds_read_b128 v[104:107], v39 offset:20480
    v_exp_f32 v45, v45
    v_exp_f32 v46, v46
    v_exp_f32 v47, v47
    v_exp_f32 v48, v48
    v_exp_f32 v49, v49
    s_waitcnt lgkmcnt(2)
    v_smfmac_f32_32x32x32_bf16 v[72:87], v[108:111], v[40:47], v2
    s_add_u32 m0, s77, 73728
    s_mov_b32 s75, 704512
    buffer_load_dwordx4 v117, s[24:27], s75 offen  lds
    v_exp_f32 v50, v50
    v_exp_f32 v51, v51
    v_exp_f32 v52, v52
    v_exp_f32 v53, v53
    v_exp_f32 v54, v54
    v_exp_f32 v55, v55
    v_exp_f32 v56, v56
    v_exp_f32 v57, v57
    s_waitcnt lgkmcnt(1)
    v_smfmac_f32_32x32x32_bf16 v[72:87], v[112:115], v[48:55], v2
    v_exp_f32 v58, v58
    v_exp_f32 v59, v59
    v_exp_f32 v60, v60
    s_waitcnt lgkmcnt(0)
    v_mfma_f32_32x32x16_bf16 v[40:55], v[104:107], v[16:19], 0
    v_exp_f32 v61, v61
    v_exp_f32 v62, v62
    v_exp_f32 v63, v63
    v_exp_f32 v64, v64
    v_exp_f32 v65, v65
    v_smfmac_f32_32x32x32_bf16 v[88:103], v[108:111], v[56:63], v2
    s_mov_b64 exec, s[66:67]
    ds_read_b128 v[108:111], v39 offset:21504
    s_mov_b64 exec, -1
    s_lshl_b32 s68, s56, 3
    s_add_u32 s68, s68, 12
    s_cmp_gt_u32 s82, s68
    s_cselect_b32 s74, s80, s81
    s_lshl_b32 s68, s68, 14
    s_add_u32 s74, s74, s68
    buffer_load_dwordx4 v[240:243], v8, s[28:31], s74 offen
    s_setprio 2
    v_exp_f32 v66, v66
    v_exp_f32 v67, v67
    v_exp_f32 v68, v68
    v_exp_f32 v69, v69
    v_exp_f32 v70, v70
    v_exp_f32 v71, v71
    v_exp_f32 v40, v40
    v_exp_f32 v41, v41
    v_smfmac_f32_32x32x32_bf16 v[88:103], v[112:115], v[64:71], v2
    s_mov_b64 exec, s[66:67]
    ds_read_b128 v[112:115], v39 offset:22016
    s_mov_b64 exec, -1
    v_exp_f32 v42, v42
    v_exp_f32 v43, v43
    v_exp_f32 v44, v44
    v_mfma_f32_32x32x16_bf16 v[56:71], v[104:107], v[20:23], 0
    ds_read_b128 v[104:107], v39 offset:24576
    v_exp_f32 v45, v45
    v_exp_f32 v46, v46
    v_exp_f32 v47, v47
    v_exp_f32 v48, v48
    v_exp_f32 v49, v49
    s_waitcnt lgkmcnt(2)
    v_smfmac_f32_32x32x32_bf16 v[72:87], v[108:111], v[40:47], v2
    s_add_u32 m0, s77, 81920
    s_mov_b32 s75, 704512
    buffer_load_dwordx4 v118, s[24:27], s75 offen  lds
    v_exp_f32 v50, v50
    v_exp_f32 v51, v51
    v_exp_f32 v52, v52
    v_exp_f32 v53, v53
    v_exp_f32 v54, v54
    v_exp_f32 v55, v55
    v_exp_f32 v56, v56
    v_exp_f32 v57, v57
    s_waitcnt lgkmcnt(1)
    v_smfmac_f32_32x32x32_bf16 v[72:87], v[112:115], v[48:55], v2
    v_exp_f32 v58, v58
    v_exp_f32 v59, v59
    v_exp_f32 v60, v60
    s_waitcnt lgkmcnt(0)
    v_mfma_f32_32x32x16_bf16 v[40:55], v[104:107], v[16:19], 0
    v_exp_f32 v61, v61
    v_exp_f32 v62, v62
    v_exp_f32 v63, v63
    v_exp_f32 v64, v64
    v_exp_f32 v65, v65
    v_smfmac_f32_32x32x32_bf16 v[88:103], v[108:111], v[56:63], v2
    s_mov_b64 exec, s[66:67]
    ds_read_b128 v[108:111], v39 offset:25600
    s_mov_b64 exec, -1
    s_add_u32 s74, s74, 8192
    buffer_load_dwordx4 v[244:247], v8, s[28:31], s74 offen
    v_exp_f32 v66, v66
    v_exp_f32 v67, v67
    v_exp_f32 v68, v68
    v_exp_f32 v69, v69
    v_exp_f32 v70, v70
    v_exp_f32 v71, v71
    v_exp_f32 v40, v40
    v_exp_f32 v41, v41
    v_smfmac_f32_32x32x32_bf16 v[88:103], v[112:115], v[64:71], v2
    s_mov_b64 exec, s[66:67]
    ds_read_b128 v[112:115], v39 offset:26112
    s_mov_b64 exec, -1
    v_exp_f32 v42, v42
    v_exp_f32 v43, v43
    v_exp_f32 v44, v44
    v_mfma_f32_32x32x16_bf16 v[56:71], v[104:107], v[20:23], 0
    ds_read_b128 v[104:107], v39 offset:28672
    v_exp_f32 v45, v45
    v_exp_f32 v46, v46
    v_exp_f32 v47, v47
    v_exp_f32 v48, v48
    v_exp_f32 v49, v49
    s_waitcnt lgkmcnt(2)
    v_smfmac_f32_32x32x32_bf16 v[72:87], v[108:111], v[40:47], v2
    s_add_u32 m0, s77, 90112
    s_mov_b32 s75, 704512
    buffer_load_dwordx4 v119, s[24:27], s75 offen  lds
    s_setprio 1
    v_exp_f32 v50, v50
    v_exp_f32 v51, v51
    v_exp_f32 v52, v52
    v_exp_f32 v53, v53
    v_exp_f32 v54, v54
    v_exp_f32 v55, v55
    v_exp_f32 v56, v56
    v_exp_f32 v57, v57
    s_waitcnt lgkmcnt(1)
    v_smfmac_f32_32x32x32_bf16 v[72:87], v[112:115], v[48:55], v2
    v_exp_f32 v58, v58
    v_exp_f32 v59, v59
    v_exp_f32 v60, v60
    s_waitcnt lgkmcnt(0)
    v_mfma_f32_32x32x16_bf16 v[40:55], v[104:107], v[16:19], 0
    v_exp_f32 v61, v61
    v_exp_f32 v62, v62
    v_exp_f32 v63, v63
    v_exp_f32 v64, v64
    v_exp_f32 v65, v65
    v_smfmac_f32_32x32x32_bf16 v[88:103], v[108:111], v[56:63], v2
    s_mov_b64 exec, s[66:67]
    ds_read_b128 v[108:111], v39 offset:29696
    s_mov_b64 exec, -1
    s_cmp_eq_u32 s49, 28
    s_cselect_b32 s72, 1073741824, 0
    buffer_store_dwordx4 v[24:27], v6, s[44:47], s72 offen offset:2048 sc1
    s_setprio 0
    v_exp_f32 v66, v66
    v_exp_f32 v67, v67
    v_exp_f32 v68, v68
    v_exp_f32 v69, v69
    v_exp_f32 v70, v70
    v_exp_f32 v71, v71
    v_exp_f32 v40, v40
    v_exp_f32 v41, v41
    v_smfmac_f32_32x32x32_bf16 v[88:103], v[112:115], v[64:71], v2
    s_mov_b64 exec, s[66:67]
    ds_read_b128 v[112:115], v39 offset:30208
    s_mov_b64 exec, -1
    v_exp_f32 v42, v42
    v_exp_f32 v43, v43
    v_exp_f32 v44, v44
    v_mfma_f32_32x32x16_bf16 v[56:71], v[104:107], v[20:23], 0
    s_waitcnt lgkmcnt(0)
    s_barrier
    s_setprio 3
    ds_read_b128 v[104:107], v39 offset:32768
    v_exp_f32 v45, v45
    v_exp_f32 v46, v46
    v_exp_f32 v47, v47
    v_exp_f32 v48, v48
    v_exp_f32 v49, v49
    v_smfmac_f32_32x32x32_bf16 v[72:87], v[108:111], v[40:47], v2
    s_add_u32 m0, s77, 0
    s_mov_b32 s75, 0
    buffer_load_dwordx4 v9, s[20:23], s75 offen  lds
    v_exp_f32 v50, v50
    v_exp_f32 v51, v51
    v_exp_f32 v52, v52
    v_exp_f32 v53, v53
    v_exp_f32 v54, v54
    v_exp_f32 v55, v55
    v_exp_f32 v56, v56
    v_exp_f32 v57, v57
    v_smfmac_f32_32x32x32_bf16 v[72:87], v[112:115], v[48:55], v2
    v_exp_f32 v58, v58
    v_exp_f32 v59, v59
    v_exp_f32 v60, v60
    s_waitcnt lgkmcnt(0)
    v_mfma_f32_32x32x16_bf16 v[40:55], v[104:107], v[16:19], 0
    v_exp_f32 v61, v61
    v_exp_f32 v62, v62
    v_exp_f32 v63, v63
    v_exp_f32 v64, v64
    v_exp_f32 v65, v65
    v_smfmac_f32_32x32x32_bf16 v[88:103], v[108:111], v[56:63], v2
    s_mov_b64 exec, s[66:67]
    ds_read_b128 v[108:111], v39 offset:33792
    s_mov_b64 exec, -1
    s_add_u32 m0, s77, 114688
    s_xor_b32 s75, s78, 98304
    buffer_load_dwordx4 v8, s[16:19], s75 offen  lds
    v_exp_f32 v66, v66
    v_exp_f32 v67, v67
    v_exp_f32 v68, v68
    v_exp_f32 v69, v69
    v_exp_f32 v70, v70
    v_exp_f32 v71, v71
    v_exp_f32 v40, v40
    v_exp_f32 v41, v41
    v_smfmac_f32_32x32x32_bf16 v[88:103], v[112:115], v[64:71], v2
    s_mov_b64 exec, s[66:67]
    ds_read_b128 v[112:115], v39 offset:34304
    s_mov_b64 exec, -1
    v_exp_f32 v42, v42
    v_exp_f32 v43, v43
    v_exp_f32 v44, v44
    v_mfma_f32_32x32x16_bf16 v[56:71], v[104:107], v[20:23], 0
    ds_read_b128 v[104:107], v39 offset:36864
    v_exp_f32 v45, v45
    v_exp_f32 v46, v46
    v_exp_f32 v47, v47
    v_exp_f32 v48, v48
    v_exp_f32 v49, v49
    s_waitcnt lgkmcnt(2)
    v_smfmac_f32_32x32x32_bf16 v[72:87], v[108:111], v[40:47], v2
    s_add_u32 m0, s77, 8192
    s_mov_b32 s75, 0
    buffer_load_dwordx4 v10, s[20:23], s75 offen  lds
    v_exp_f32 v50, v50
    v_exp_f32 v51, v51
    v_exp_f32 v52, v52
    v_exp_f32 v53, v53
    v_exp_f32 v54, v54
    v_exp_f32 v55, v55
    v_exp_f32 v56, v56
    v_exp_f32 v57, v57
    s_waitcnt lgkmcnt(1)
    v_smfmac_f32_32x32x32_bf16 v[72:87], v[112:115], v[48:55], v2
    v_exp_f32 v58, v58
    v_exp_f32 v59, v59
    v_exp_f32 v60, v60
    s_waitcnt lgkmcnt(0)
    v_mfma_f32_32x32x16_bf16 v[40:55], v[104:107], v[16:19], 0
    v_exp_f32 v61, v61
    v_exp_f32 v62, v62
    v_exp_f32 v63, v63
    v_exp_f32 v64, v64
    v_exp_f32 v65, v65
    v_smfmac_f32_32x32x32_bf16 v[88:103], v[108:111], v[56:63], v2
    s_mov_b64 exec, s[66:67]
    ds_read_b128 v[108:111], v39 offset:37888
    s_mov_b64 exec, -1
    s_add_u32 m0, s77, 122880
    s_xor_b32 s75, s78, 114688
    buffer_load_dwordx4 v8, s[16:19], s75 offen  lds
    v_exp_f32 v66, v66
    v_exp_f32 v67, v67
    v_exp_f32 v68, v68
    v_exp_f32 v69, v69
    v_exp_f32 v70, v70
    v_exp_f32 v71, v71
    v_exp_f32 v40, v40
    v_exp_f32 v41, v41
    v_smfmac_f32_32x32x32_bf16 v[88:103], v[112:115], v[64:71], v2
    s_mov_b64 exec, s[66:67]
    ds_read_b128 v[112:115], v39 offset:38400
    s_mov_b64 exec, -1
    v_exp_f32 v42, v42
    v_exp_f32 v43, v43
    v_exp_f32 v44, v44
    v_mfma_f32_32x32x16_bf16 v[56:71], v[104:107], v[20:23], 0
    ds_read_b128 v[104:107], v39 offset:40960
    v_exp_f32 v45, v45
    v_exp_f32 v46, v46
    v_exp_f32 v47, v47
    v_exp_f32 v48, v48
    v_exp_f32 v49, v49
    s_waitcnt lgkmcnt(2)
    v_smfmac_f32_32x32x32_bf16 v[72:87], v[108:111], v[40:47], v2
    s_add_u32 m0, s77, 16384
    s_mov_b32 s75, 0
    buffer_load_dwordx4 v116, s[20:23], s75 offen  lds
    v_exp_f32 v50, v50
    v_exp_f32 v51, v51
    v_exp_f32 v52, v52
    v_exp_f32 v53, v53
    v_exp_f32 v54, v54
    v_exp_f32 v55, v55
    v_exp_f32 v56, v56
    v_exp_f32 v57, v57
    s_waitcnt lgkmcnt(1)
    v_smfmac_f32_32x32x32_bf16 v[72:87], v[112:115], v[48:55], v2
    v_exp_f32 v58, v58
    v_exp_f32 v59, v59
    v_exp_f32 v60, v60
    s_waitcnt lgkmcnt(0)
    v_mfma_f32_32x32x16_bf16 v[40:55], v[104:107], v[16:19], 0
    v_exp_f32 v61, v61
    v_exp_f32 v62, v62
    v_exp_f32 v63, v63
    v_exp_f32 v64, v64
    v_exp_f32 v65, v65
    v_smfmac_f32_32x32x32_bf16 v[88:103], v[108:111], v[56:63], v2
    s_mov_b64 exec, s[66:67]
    ds_read_b128 v[108:111], v39 offset:41984
    s_mov_b64 exec, -1
    s_cmp_gt_u32 s82, 0
    s_cselect_b32 s75, s80, s81
    s_add_u32 s75, s75, 0
    s_lshl_b32 s68, s56, 13
    s_add_u32 s75, s75, s68
    s_add_u32 m0, s77, 98304
    s_nop 0
    buffer_load_dwordx4 v8, s[28:31], s75 offen  lds
    s_setprio 2
    v_exp_f32 v66, v66
    v_exp_f32 v67, v67
    v_exp_f32 v68, v68
    v_exp_f32 v69, v69
    v_exp_f32 v70, v70
    v_exp_f32 v71, v71
    v_exp_f32 v40, v40
    v_exp_f32 v41, v41
    v_smfmac_f32_32x32x32_bf16 v[88:103], v[112:115], v[64:71], v2
    s_mov_b64 exec, s[66:67]
    ds_read_b128 v[112:115], v39 offset:42496
    s_mov_b64 exec, -1
    v_exp_f32 v42, v42
    v_exp_f32 v43, v43
    v_exp_f32 v44, v44
    v_mfma_f32_32x32x16_bf16 v[56:71], v[104:107], v[20:23], 0
    ds_read_b128 v[104:107], v39 offset:45056
    v_exp_f32 v45, v45
    v_exp_f32 v46, v46
    v_exp_f32 v47, v47
    v_exp_f32 v48, v48
    v_exp_f32 v49, v49
    s_waitcnt lgkmcnt(2)
    v_smfmac_f32_32x32x32_bf16 v[72:87], v[108:111], v[40:47], v2
    s_add_u32 m0, s77, 24576
    s_mov_b32 s75, 704512
    buffer_load_dwordx4 v9, s[20:23], s75 offen  lds
    v_exp_f32 v50, v50
    v_exp_f32 v51, v51
    v_exp_f32 v52, v52
    v_exp_f32 v53, v53
    v_exp_f32 v54, v54
    v_exp_f32 v55, v55
    v_exp_f32 v56, v56
    v_exp_f32 v57, v57
    s_waitcnt lgkmcnt(1)
    v_smfmac_f32_32x32x32_bf16 v[72:87], v[112:115], v[48:55], v2
    v_exp_f32 v58, v58
    v_exp_f32 v59, v59
    v_exp_f32 v60, v60
    s_waitcnt lgkmcnt(0)
    v_mfma_f32_32x32x16_bf16 v[40:55], v[104:107], v[16:19], 0
    v_exp_f32 v61, v61
    v_exp_f32 v62, v62
    v_exp_f32 v63, v63
    v_exp_f32 v64, v64
    v_exp_f32 v65, v65
    v_smfmac_f32_32x32x32_bf16 v[88:103], v[108:111], v[56:63], v2
    s_mov_b64 exec, s[66:67]
    ds_read_b128 v[108:111], v39 offset:46080
    s_mov_b64 exec, -1
    s_cmp_gt_u32 s82, 1
    s_cselect_b32 s75, s80, s81
    s_add_u32 s75, s75, 16384
    s_lshl_b32 s68, s56, 13
    s_add_u32 s75, s75, s68
    s_add_u32 m0, s77, 106496
    s_nop 0
    buffer_load_dwordx4 v8, s[28:31], s75 offen  lds
    v_exp_f32 v66, v66
    v_exp_f32 v67, v67
    v_exp_f32 v68, v68
    v_exp_f32 v69, v69
    v_exp_f32 v70, v70
    v_exp_f32 v71, v71
    v_exp_f32 v40, v40
    v_exp_f32 v41, v41
    v_smfmac_f32_32x32x32_bf16 v[88:103], v[112:115], v[64:71], v2
    s_mov_b64 exec, s[66:67]
    ds_read_b128 v[112:115], v39 offset:46592
    s_mov_b64 exec, -1
    v_exp_f32 v42, v42
    v_exp_f32 v43, v43
    v_exp_f32 v44, v44
    v_mfma_f32_32x32x16_bf16 v[56:71], v[104:107], v[20:23], 0
    ds_read_b128 v[104:107], v39 offset:49152
    v_exp_f32 v45, v45
    v_exp_f32 v46, v46
    v_exp_f32 v47, v47
    v_exp_f32 v48, v48
    v_exp_f32 v49, v49
    s_waitcnt lgkmcnt(2)
    v_smfmac_f32_32x32x32_bf16 v[72:87], v[108:111], v[40:47], v2
    s_mov_b32 s75, 32768
    buffer_load_dwordx4 v[24:27], v36, s[44:47], s75 offen sc1
    s_mov_b32 s75, 40960
    buffer_load_dwordx4 v[28:31], v36, s[44:47], s75 offen sc1
    s_lshl_b32 s68, s64, 15
    s_lshl_b32 s69, s54, 2
    s_add_u32 s69, s69, s55
    s_lshl_b32 s69, s69, 5
    s_add_u32 s69, s69, s68
    v_and_b32 v4, 31, v0
    v_lshl_add_u32 v4, v4, 10, s69
    v_lshrrev_b32 v13, 5, v0
    v_lshl_add_u32 v4, v13, 4, v4
    buffer_load_dwordx4 v[32:35], v4, s[4:7], 0 offen
    s_setprio 1
    v_exp_f32 v50, v50
    v_exp_f32 v51, v51
    v_exp_f32 v52, v52
    v_exp_f32 v53, v53
    v_exp_f32 v54, v54
    v_exp_f32 v55, v55
    v_exp_f32 v56, v56
    v_exp_f32 v57, v57
    s_waitcnt lgkmcnt(1)
    v_smfmac_f32_32x32x32_bf16 v[72:87], v[112:115], v[48:55], v2
    v_exp_f32 v58, v58
    v_exp_f32 v59, v59
    v_exp_f32 v60, v60
    s_waitcnt lgkmcnt(0)
    v_mfma_f32_32x32x16_bf16 v[40:55], v[104:107], v[16:19], 0
    v_exp_f32 v61, v61
    v_exp_f32 v62, v62
    v_exp_f32 v63, v63
    v_exp_f32 v64, v64
    v_exp_f32 v65, v65
    v_smfmac_f32_32x32x32_bf16 v[88:103], v[108:111], v[56:63], v2
    s_mov_b64 exec, s[66:67]
    ds_read_b128 v[108:111], v39 offset:50176
    s_mov_b64 exec, -1
    s_lshl_b32 s68, s56, 3
    s_add_u32 s68, s68, 13
    s_cmp_gt_u32 s82, s68
    s_cselect_b32 s74, s80, s81
    s_lshl_b32 s68, s68, 14
    s_add_u32 s74, s74, s68
    s_cmp_lt_u32 s50, 6
    s_cselect_b32 s74, s74, 1073741824
    buffer_load_dwordx4 v[248:251], v8, s[28:31], s74 offen
    s_setprio 0
    v_exp_f32 v66, v66
    v_exp_f32 v67, v67
    v_exp_f32 v68, v68
    v_exp_f32 v69, v69
    v_exp_f32 v70, v70
    v_exp_f32 v71, v71
    v_exp_f32 v40, v40
    v_exp_f32 v41, v41
    v_smfmac_f32_32x32x32_bf16 v[88:103], v[112:115], v[64:71], v2
    s_mov_b64 exec, s[66:67]
    ds_read_b128 v[112:115], v39 offset:50688
    s_mov_b64 exec, -1
    v_exp_f32 v42, v42
    v_exp_f32 v43, v43
    v_exp_f32 v44, v44
    v_mfma_f32_32x32x16_bf16 v[56:71], v[104:107], v[20:23], 0
    s_waitcnt lgkmcnt(0)
    s_barrier
    s_setprio 3
    ds_read_b128 v[104:107], v39 offset:53248
    v_exp_f32 v45, v45
    v_exp_f32 v46, v46
    v_exp_f32 v47, v47
    v_exp_f32 v48, v48
    v_exp_f32 v49, v49
    v_smfmac_f32_32x32x32_bf16 v[72:87], v[108:111], v[40:47], v2
    s_add_u32 s74, s74, 8192
    buffer_load_dwordx4 v[252:255], v8, s[28:31], s74 offen
    v_exp_f32 v50, v50
    v_exp_f32 v51, v51
    v_exp_f32 v52, v52
    v_exp_f32 v53, v53
    v_exp_f32 v54, v54
    v_exp_f32 v55, v55
    v_exp_f32 v56, v56
    v_exp_f32 v57, v57
    v_smfmac_f32_32x32x32_bf16 v[72:87], v[112:115], v[48:55], v2
    v_exp_f32 v58, v58
    v_exp_f32 v59, v59
    v_exp_f32 v60, v60
    s_waitcnt lgkmcnt(0)
    v_mfma_f32_32x32x16_bf16 v[40:55], v[104:107], v[16:19], 0
    v_exp_f32 v61, v61
    v_exp_f32 v62, v62
    v_exp_f32 v63, v63
    v_exp_f32 v64, v64
    v_exp_f32 v65, v65
    v_smfmac_f32_32x32x32_bf16 v[88:103], v[108:111], v[56:63], v2
    s_mov_b64 exec, s[66:67]
    ds_read_b128 v[108:111], v39 offset:54272
    s_mov_b64 exec, -1
    v_exp_f32 v66, v66
    v_exp_f32 v67, v67
    v_exp_f32 v68, v68
    v_exp_f32 v69, v69
    v_exp_f32 v70, v70
    v_exp_f32 v71, v71
    v_exp_f32 v40, v40
    v_exp_f32 v41, v41
    v_smfmac_f32_32x32x32_bf16 v[88:103], v[112:115], v[64:71], v2
    s_mov_b64 exec, s[66:67]
    ds_read_b128 v[112:115], v39 offset:54784
    s_mov_b64 exec, -1
    v_exp_f32 v42, v42
    v_exp_f32 v43, v43
    v_exp_f32 v44, v44
    v_mfma_f32_32x32x16_bf16 v[56:71], v[104:107], v[20:23], 0
    ds_read_b128 v[104:107], v39 offset:57344
    v_exp_f32 v45, v45
    v_exp_f32 v46, v46
    v_exp_f32 v47, v47
    v_exp_f32 v48, v48
    v_exp_f32 v49, v49
    s_waitcnt lgkmcnt(2)
    v_smfmac_f32_32x32x32_bf16 v[72:87], v[108:111], v[40:47], v2
    v_exp_f32 v50, v50
    v_exp_f32 v51, v51
    v_exp_f32 v52, v52
    v_exp_f32 v53, v53
    v_exp_f32 v54, v54
    v_exp_f32 v55, v55
    v_exp_f32 v56, v56
    v_exp_f32 v57, v57
    s_waitcnt lgkmcnt(1)
    v_smfmac_f32_32x32x32_bf16 v[72:87], v[112:115], v[48:55], v2
    v_exp_f32 v58, v58
    v_exp_f32 v59, v59
    v_exp_f32 v60, v60
    s_waitcnt lgkmcnt(0)
    v_mfma_f32_32x32x16_bf16 v[40:55], v[104:107], v[16:19], 0
    v_exp_f32 v61, v61
    v_exp_f32 v62, v62
    v_exp_f32 v63, v63
    v_exp_f32 v64, v64
    v_exp_f32 v65, v65
    v_smfmac_f32_32x32x32_bf16 v[88:103], v[108:111], v[56:63], v2
    s_mov_b64 exec, s[66:67]
    ds_read_b128 v[108:111], v39 offset:58368
    s_mov_b64 exec, -1
    s_setprio 2
    v_exp_f32 v66, v66
    v_exp_f32 v67, v67
    v_exp_f32 v68, v68
    v_exp_f32 v69, v69
    v_exp_f32 v70, v70
    v_exp_f32 v71, v71
    v_exp_f32 v40, v40
    v_exp_f32 v41, v41
    v_smfmac_f32_32x32x32_bf16 v[88:103], v[112:115], v[64:71], v2
    s_mov_b64 exec, s[66:67]
    ds_read_b128 v[112:115], v39 offset:58880
    s_mov_b64 exec, -1
    v_exp_f32 v42, v42
    v_exp_f32 v43, v43
    v_exp_f32 v44, v44
    v_mfma_f32_32x32x16_bf16 v[56:71], v[104:107], v[20:23], 0
    ds_read_b128 v[104:107], v39 offset:61440
    v_exp_f32 v45, v45
    v_exp_f32 v46, v46
    v_exp_f32 v47, v47
    v_exp_f32 v48, v48
    v_exp_f32 v49, v49
    s_waitcnt lgkmcnt(2)
    v_smfmac_f32_32x32x32_bf16 v[72:87], v[108:111], v[40:47], v2
    v_exp_f32 v50, v50
    v_exp_f32 v51, v51
    v_exp_f32 v52, v52
    v_exp_f32 v53, v53
    v_exp_f32 v54, v54
    v_exp_f32 v55, v55
    v_exp_f32 v56, v56
    v_exp_f32 v57, v57
    s_waitcnt lgkmcnt(1)
    v_smfmac_f32_32x32x32_bf16 v[72:87], v[112:115], v[48:55], v2
    v_exp_f32 v58, v58
    v_exp_f32 v59, v59
    v_exp_f32 v60, v60
    s_waitcnt lgkmcnt(0)
    v_mfma_f32_32x32x16_bf16 v[40:55], v[104:107], v[16:19], 0
    v_exp_f32 v61, v61
    v_exp_f32 v62, v62
    v_exp_f32 v63, v63
    v_exp_f32 v64, v64
    v_exp_f32 v65, v65
    v_smfmac_f32_32x32x32_bf16 v[88:103], v[108:111], v[56:63], v2
    s_mov_b64 exec, s[66:67]
    ds_read_b128 v[108:111], v39 offset:62464
    s_mov_b64 exec, -1
    v_exp_f32 v66, v66
    v_exp_f32 v67, v67
    v_exp_f32 v68, v68
    v_exp_f32 v69, v69
    v_exp_f32 v70, v70
    v_exp_f32 v71, v71
    v_exp_f32 v40, v40
    v_exp_f32 v41, v41
    v_smfmac_f32_32x32x32_bf16 v[88:103], v[112:115], v[64:71], v2
    s_mov_b64 exec, s[66:67]
    ds_read_b128 v[112:115], v39 offset:62976
    s_mov_b64 exec, -1
    v_exp_f32 v42, v42
    v_exp_f32 v43, v43
    v_exp_f32 v44, v44
    v_mfma_f32_32x32x16_bf16 v[56:71], v[104:107], v[20:23], 0
    v_exp_f32 v45, v45
    v_exp_f32 v46, v46
    v_exp_f32 v47, v47
    v_exp_f32 v48, v48
    v_exp_f32 v49, v49
    s_waitcnt lgkmcnt(1)
    v_smfmac_f32_32x32x32_bf16 v[72:87], v[108:111], v[40:47], v2
    s_setprio 1
    v_exp_f32 v50, v50
    v_exp_f32 v51, v51
    v_exp_f32 v52, v52
    v_exp_f32 v53, v53
    v_exp_f32 v54, v54
    v_exp_f32 v55, v55
    v_exp_f32 v56, v56
    v_exp_f32 v57, v57
    s_waitcnt lgkmcnt(0)
    v_smfmac_f32_32x32x32_bf16 v[72:87], v[112:115], v[48:55], v2
    v_exp_f32 v58, v58
    v_exp_f32 v59, v59
    v_exp_f32 v60, v60
    v_exp_f32 v61, v61
    v_exp_f32 v62, v62
    v_exp_f32 v63, v63
    v_exp_f32 v64, v64
    v_exp_f32 v65, v65
    v_smfmac_f32_32x32x32_bf16 v[88:103], v[108:111], v[56:63], v2
    s_setprio 0
    v_exp_f32 v66, v66
    v_exp_f32 v67, v67
    v_exp_f32 v68, v68
    v_exp_f32 v69, v69
    v_exp_f32 v70, v70
    v_exp_f32 v71, v71
    s_nop 1
    v_smfmac_f32_32x32x32_bf16 v[88:103], v[112:115], v[64:71], v2
    s_setprio 0
    s_mul_i32 s68, s50, 2304
    s_add_u32 s68, s68, 131072
    v_lshl_add_u32 v12, v0, 4, s68
    v_lshl_add_u32 v13, v0, 2, s68
    s_xor_b32 s69, s50, 4
    s_mul_i32 s69, s69, 2304
    s_add_u32 s69, s69, 131072
    v_lshl_add_u32 v14, v0, 4, s69
    v_lshl_add_u32 v15, v0, 2, s69
    s_nop 1
    ds_write_b128 v12, v[88:91]
    ds_write_b128 v12, v[92:95] offset:1024
    ds_write_b32 v13, v96 offset:2048
    s_waitcnt vmcnt(0) lgkmcnt(0)
    s_barrier
    ds_read_b32 v48, v15 offset:2048
    ds_read_b128 v[40:43], v14
    ds_read_b128 v[44:47], v14 offset:1024
    s_mov_b32 s68, 0x12800000
    v_mov_b32 v13, 0x7b800000
    s_waitcnt lgkmcnt(2)
    v_add_f32 v80, v80, v48
    v_med3_f32 v12, v80, s68, v13
    v_cmp_neq_f32 s[72:73], v12, v80
    v_rcp_f32 v80, v80
    s_waitcnt lgkmcnt(0)
    v_pk_add_f32 v[72:73], v[72:73], v[40:41]
    v_pk_add_f32 v[74:75], v[74:75], v[42:43]
    v_pk_add_f32 v[76:77], v[76:77], v[44:45]
    v_pk_add_f32 v[78:79], v[78:79], v[46:47]
    v_mul_f32 v72, v72, v80
    v_mul_f32 v73, v73, v80
    v_mul_f32 v74, v74, v80
    v_mul_f32 v75, v75, v80
    v_mul_f32 v76, v76, v80
    v_mul_f32 v77, v77, v80
    v_mul_f32 v78, v78, v80
    v_mul_f32 v79, v79, v80
    v_pk_add_f32 v[40:41], v[72:73], v[74:75]
    v_pk_add_f32 v[42:43], v[76:77], v[78:79]
    v_pk_add_f32 v[40:41], v[40:41], v[42:43]
    v_add_f32 v40, v40, v41
    v_mov_b32 v12, 0x207
    v_cmp_class_f32 vcc, v40, v12
    s_or_b64 vcc, vcc, s[72:73]
    s_cbranch_vccnz L_slow
L_slow_ret:
    v_cvt_pk_bf16_f32 v72, v72, v73
    v_cvt_pk_bf16_f32 v73, v74, v75
    v_cvt_pk_bf16_f32 v74, v76, v77
    v_cvt_pk_bf16_f32 v75, v78, v79
    buffer_store_dwordx4 v[72:75], v3, s[44:47], 0 offen sc1
    s_lshr_b32 s68, s50, 1
    s_cmp_eq_u32 s68, 2
    s_cselect_b32 s63, 1.0, 0
    v_add_u32 v120, 114688, v11
    v_xor_b32 v121, 64, v120
    ds_read_b64_tr_b16 v[176:177], v120 offset:0
    ds_read_b64_tr_b16 v[178:179], v120 offset:4096
    ds_read_b64_tr_b16 v[180:181], v121 offset:0
    ds_read_b64_tr_b16 v[182:183], v121 offset:4096
    ds_read_b64_tr_b16 v[184:185], v120 offset:8192
    ds_read_b64_tr_b16 v[186:187], v120 offset:12288
    ds_read_b64_tr_b16 v[188:189], v121 offset:8192
    ds_read_b64_tr_b16 v[190:191], v121 offset:12288
L_gb_chk_28:
    v_xor_b32 v24, s58, v24
    v_xor_b32 v25, s59, v25
    v_xor_b32 v26, s60, v26
    v_xor_b32 v27, s61, v27
    v_xor_b32 v28, s58, v28
    v_xor_b32 v29, s59, v29
    v_xor_b32 v30, s60, v30
    v_xor_b32 v31, s61, v31
    v_or3_b32 v14, v24, v25, v26
    v_or3_b32 v14, v14, v27, v28
    v_or3_b32 v14, v14, v29, v30
    v_or_b32 v14, v14, v31
    v_and_b32 v14, 0xff, v14
    v_cmp_ne_u32 vcc, 0, v14
    s_cbranch_vccnz L_gb_stub_30
L_gb_ok_29:
    v_add_f32 v24, v24, v28
    v_add_f32 v25, v25, v29
    v_add_f32 v26, v26, v30
    v_add_f32 v27, v27, v31
    v_cvt_pk_bf16_f32 v28, v24, v25
    v_cvt_pk_bf16_f32 v29, v26, v27
    v_and_b32 v25, 0xffff0000, v28
    v_lshlrev_b32 v24, 16, v28
    v_and_b32 v27, 0xffff0000, v29
    v_lshlrev_b32 v26, 16, v29
    v_add_f32 v24, s63, v24
    v_add_f32 v25, s63, v25
    v_add_f32 v26, s63, v26
    v_add_f32 v27, s63, v27
    v_cvt_pk_bf16_f32 v28, v24, v25
    v_cvt_pk_bf16_f32 v29, v26, v27
    v_and_b32 v25, 0xffff0000, v28
    v_lshlrev_b32 v24, 16, v28
    v_and_b32 v27, 0xffff0000, v29
    v_lshlrev_b32 v26, 16, v29
    s_lshl_b32 s68, s68, 8
    s_add_u32 s68, s68, 155648
    v_and_b32 v14, 15, v0
    v_lshl_add_u32 v14, v14, 4, s68
    v_bfe_u32 v15, v36, 8, 3
    v_cmp_eq_u32 vcc, s54, v15
    v_lshlrev_b32 v1, 4, v0
    s_mov_b64 exec, vcc
    ds_write_b128 v14, v[24:27]
    s_mov_b64 exec, -1
    s_sub_u32 s68, s50, 2
    s_cmp_ge_u32 s68, 4
    s_cbranch_scc1 L_no16_31
    s_lshl_b32 s68, s68, 9
    s_add_u32 s68, s68, 156672
    v_lshrrev_b32 v15, 3, v0
    v_lshl_add_u32 v15, v15, 6, s68
    v_and_b32 v14, 3, v0
    v_lshl_add_u32 v15, v14, 4, v15
    v_bfe_u32 v14, v0, 2, 1
    v_lshl_add_u32 v15, v14, 3, v15
    ds_write_b64 v15, v[28:29]
L_no16_31:
    v_permlane32_swap_b32 v32, v34
    v_permlane32_swap_b32 v33, v35
    v_and_b32 v17, 0xffff0000, v32
    v_lshlrev_b32 v16, 16, v32
    v_and_b32 v19, 0xffff0000, v33
    v_lshlrev_b32 v18, 16, v33
    v_and_b32 v21, 0xffff0000, v34
    v_lshlrev_b32 v20, 16, v34
    v_and_b32 v23, 0xffff0000, v35
    v_lshlrev_b32 v22, 16, v35
    s_lshl_b32 s68, s55, 10
    s_add_u32 s68, s68, 131072
    v_add_u32 v12, s68, v1
    s_lshl_b32 s68, s55, 6
    s_add_u32 s68, s68, 155648
    v_lshrrev_b32 v3, 5, v0
    v_lshl_add_u32 v2, v3, 4, s68
    s_lshl_b32 s68, s50, 8
    s_add_u32 s68, s68, 160256
    v_lshl_add_u32 v3, v3, 2, s68
    v_and_b32 v14, 31, v0
    v_lshl_add_u32 v3, v14, 3, v3
    s_lshl_b32 s79, s64, 15
    s_lshl_b32 s68, s55, 3
    s_add_u32 s68, s68, s65
    s_lshl_b32 s68, s68, 10
    s_add_u32 s79, s79, s68
    s_add_u32 s79, s79, 2097152
    s_cmp_lg_u32 s56, 0
    s_cbranch_scc1 L_o_late
    s_setprio 1
    s_waitcnt vmcnt(0) lgkmcnt(0)
    s_sleep 4
    s_barrier
    s_xor_b32 s75, s79, 0
    buffer_load_dwordx4 v[88:91], v1, s[44:47], s75 offen sc1
    s_xor_b32 s75, s79, 1024
    buffer_load_dwordx4 v[92:95], v1, s[44:47], s75 offen sc1
    s_xor_b32 s75, s79, 2048
    buffer_load_dwordx4 v[96:99], v1, s[44:47], s75 offen sc1
    s_xor_b32 s75, s79, 3072
    buffer_load_dwordx4 v[100:103], v1, s[44:47], s75 offen sc1
    s_xor_b32 s75, s79, 4096
    buffer_load_dwordx4 v[104:107], v1, s[44:47], s75 offen sc1
    s_xor_b32 s75, s79, 5120
    buffer_load_dwordx4 v[108:111], v1, s[44:47], s75 offen sc1
    s_xor_b32 s75, s79, 6144
    buffer_load_dwordx4 v[112:115], v1, s[44:47], s75 offen sc1
    s_xor_b32 s75, s79, 7168
    buffer_load_dwordx4 v[116:119], v1, s[44:47], s75 offen sc1
    ds_read_b128 v[72:75], v2 offset:0
    ds_read_b128 v[76:79], v2 offset:32
    ds_read_b128 v[80:83], v2 offset:512
    ds_read_b128 v[84:87], v2 offset:544
    ds_read_b128 v[24:27], v2 offset:768
    ds_read_b128 v[28:31], v2 offset:800
    v_bfe_u32 v14, v0, 4, 1
    v_lshrrev_b32 v15, 5, v0
    v_xor_b32 v36, v14, v15
    v_bfe_u32 v124, v0, 2, 2
    v_lshl_add_u32 v124, v36, 2, v124
    v_lshl_add_u32 v124, v14, 9, v124
    v_mul_u32_u24 v124, 96, v124
    v_and_b32 v14, 3, v0
    v_lshl_add_u32 v124, v14, 3, v124
    s_lshl_b32 s68, s48, 2
    s_add_u32 s68, s68, s55
    s_lshl_b32 s68, s68, 1
    s_add_u32 s68, s68, s56
    s_lshl_b32 s73, s68, 11
    s_add_u32 s73, s73, 65536
    v_and_b32 v14, 31, v0
    v_lshlrev_b32 v14, 3, v14
    v_lshl_add_u32 v126, v15, 10, v14
    s_lshl_b32 s74, s68, 15
    s_add_u32 s74, s74, 4194304
    s_mov_b32 s9, s54
    s_lshl_b32 s68, s9, 12
    s_add_u32 s8, s74, s68
    s_lshr_b32 s68, s9, 2
    s_mul_i32 s10, s68, 24576
    s_sub_u32 s11, 24576, s10
    v_lshlrev_b32 v127, 3, v0
    v_add_u32 v127, 158720, v127
    v_add_u32 v120, 98304, v11
    v_xor_b32 v121, 64, v120
    s_waitcnt vmcnt(6)
    v_max_u32 v14, v88, v92
    v_cmp_eq_u32 vcc, -1, v14
    s_cbranch_vccnz L_o_stub_33
L_o_ok_32:
    v_mfma_f32_32x32x16_bf16 v[56:71], v[132:135], v[88:91], 0
    v_mfma_f32_32x32x16_bf16 v[40:55], v[128:131], v[88:91], 0
    v_mfma_f32_32x32x16_bf16 v[56:71], v[140:143], v[92:95], v[56:71]
    s_waitcnt vmcnt(4)
    v_max_u32 v14, v96, v100
    v_cmp_eq_u32 vcc, -1, v14
    v_mfma_f32_32x32x16_bf16 v[40:55], v[136:139], v[92:95], v[40:55]
    s_cbranch_vccnz L_o_stub_35
L_o_ok_34:
    v_mfma_f32_32x32x16_bf16 v[56:71], v[148:151], v[96:99], v[56:71]
    v_mfma_f32_32x32x16_bf16 v[40:55], v[144:147], v[96:99], v[40:55]
    v_mfma_f32_32x32x16_bf16 v[56:71], v[156:159], v[100:103], v[56:71]
    s_waitcnt vmcnt(2)
    v_max_u32 v14, v104, v108
    v_cmp_eq_u32 vcc, -1, v14
    v_mfma_f32_32x32x16_bf16 v[40:55], v[152:155], v[100:103], v[40:55]
    s_cbranch_vccnz L_o_stub_37
L_o_ok_36:
    v_mfma_f32_32x32x16_bf16 v[56:71], v[164:167], v[104:107], v[56:71]
    v_mfma_f32_32x32x16_bf16 v[40:55], v[160:163], v[104:107], v[40:55]
    v_mfma_f32_32x32x16_bf16 v[56:71], v[172:175], v[108:111], v[56:71]
    s_waitcnt vmcnt(0)
    v_max_u32 v14, v112, v116
    v_cmp_eq_u32 vcc, -1, v14
    v_mfma_f32_32x32x16_bf16 v[40:55], v[168:171], v[108:111], v[40:55]
    s_cbranch_vccnz L_o_stub_39
L_o_ok_38:
    v_mfma_f32_32x32x16_bf16 v[56:71], v[180:183], v[112:115], v[56:71]
    v_mfma_f32_32x32x16_bf16 v[40:55], v[176:179], v[112:115], v[40:55]
    v_mfma_f32_32x32x16_bf16 v[56:71], v[188:191], v[116:119], v[56:71]
    v_mfma_f32_32x32x16_bf16 v[40:55], v[184:187], v[116:119], v[40:55]
    v_xor_b32 v13, 1024, v12
    v_xor_b32 v14, 2048, v12
    v_xor_b32 v15, 3072, v12
    s_nop 7
    ds_write_b128 v12, v[56:59] offset:8192
    ds_write_b128 v12, v[60:63] offset:12288
    ds_write_b128 v12, v[64:67] offset:16384
    ds_write_b128 v12, v[68:71] offset:20480
    ds_write_b128 v12, v[48:51] offset:0
    ds_write_b128 v12, v[52:55] offset:4096
    s_waitcnt lgkmcnt(0)
    s_barrier
    ds_read_b128 v[128:131], v13 offset:0
    ds_read_b128 v[136:139], v14 offset:8192
    ds_read_b128 v[144:147], v15 offset:16384
    ds_read_b128 v[132:135], v13 offset:4096
    ds_read_b128 v[140:143], v14 offset:12288
    ds_read_b128 v[148:151], v15 offset:20480
    s_waitcnt lgkmcnt(5)
    v_add_f32 v40, v40, v128
    v_add_f32 v41, v41, v129
    v_add_f32 v42, v42, v130
    v_add_f32 v43, v43, v131
    s_waitcnt lgkmcnt(3)
    v_add_f32 v136, v136, v144
    v_add_f32 v137, v137, v145
    v_add_f32 v138, v138, v146
    v_add_f32 v139, v139, v147
    v_add_f32 v40, v40, v136
    v_add_f32 v41, v41, v137
    v_add_f32 v42, v42, v138
    v_add_f32 v43, v43, v139
    s_waitcnt lgkmcnt(2)
    v_add_f32 v44, v44, v132
    v_add_f32 v45, v45, v133
    v_add_f32 v46, v46, v134
    v_add_f32 v47, v47, v135
    s_waitcnt lgkmcnt(0)
    v_add_f32 v140, v140, v148
    v_add_f32 v141, v141, v149
    v_add_f32 v142, v142, v150
    v_add_f32 v143, v143, v151
    v_add_f32 v44, v44, v140
    v_add_f32 v45, v45, v141
    v_add_f32 v46, v46, v142
    v_add_f32 v47, v47, v143
    v_fma_f32 v16, v40, v72, v16
    v_fma_f32 v17, v41, v73, v17
    v_fma_f32 v18, v42, v74, v18
    v_fma_f32 v19, v43, v75, v19
    v_fma_f32 v20, v44, v76, v20
    v_fma_f32 v21, v45, v77, v21
    v_fma_f32 v22, v46, v78, v22
    v_fma_f32 v23, v47, v79, v23
    v_mul_f32 v40, v16, v80
    v_mul_f32 v41, v17, v81
    v_mul_f32 v42, v18, v82
    v_mul_f32 v43, v19, v83
    v_mul_f32 v44, v20, v84
    v_mul_f32 v45, v21, v85
    v_mul_f32 v46, v22, v86
    v_mul_f32 v47, v23, v87
    v_cvt_pk_bf16_f32 v40, v40, v41
    v_cvt_pk_bf16_f32 v41, v42, v43
    v_cvt_pk_bf16_f32 v42, v44, v45
    v_cvt_pk_bf16_f32 v43, v46, v47
    buffer_store_dwordx4 v[40:43], v5, s[44:47], 0 offen sc1
    v_add_f32 v88, v16, v17
    v_mul_f32 v89, v16, v16
    v_fmac_f32 v89, v17, v17
    v_add_f32 v88, v88, v18
    v_fmac_f32 v89, v18, v18
    v_add_f32 v88, v88, v19
    v_fmac_f32 v89, v19, v19
    v_add_f32 v88, v88, v20
    v_fmac_f32 v89, v20, v20
    v_add_f32 v88, v88, v21
    v_fmac_f32 v89, v21, v21
    v_add_f32 v88, v88, v22
    v_fmac_f32 v89, v22, v22
    v_add_f32 v88, v88, v23
    v_fmac_f32 v89, v23, v23
    s_nop 1
    v_permlane32_swap_b32 v88, v89
    v_add_f32 v88, v88, v89
    ds_write_b32 v3, v88
    s_or_b32 s68, s2, s50
    s_cmp_lg_u32 s68, 0
    s_cbranch_scc1 L_noep_40
    v_mov_b32 v14, s57
    buffer_store_dword v14, off, s[44:47], 0 sc1
L_noep_40:
    ds_read_b64 v[40:41], v127 offset:0
    ds_read_b64 v[42:43], v127 offset:512
    ds_read_b64 v[44:45], v127 offset:1024
    s_xor_b32 s68, s9, 0
    s_mul_i32 s68, s68, 6144
    v_add_u32 v122, s68, v124
    ds_read_b64_tr_b16 v[88:89], v122 offset:0
    ds_read_b64_tr_b16 v[90:91], v122 offset:768
    ds_read_b64_tr_b16 v[92:93], v122 offset:32
    ds_read_b64_tr_b16 v[94:95], v122 offset:800
    ds_read_b64_tr_b16 v[96:97], v122 offset:64
    ds_read_b64_tr_b16 v[98:99], v122 offset:832
    ds_read_b64_tr_b16 v[100:101], v122 offset:1536
    ds_read_b64_tr_b16 v[102:103], v122 offset:2304
    ds_read_b64_tr_b16 v[104:105], v122 offset:1568
    ds_read_b64_tr_b16 v[106:107], v122 offset:2336
    ds_read_b64_tr_b16 v[108:109], v122 offset:1600
    ds_read_b64_tr_b16 v[110:111], v122 offset:2368
    s_waitcnt lgkmcnt(12)
    v_add_f32 v40, v40, v41
    v_cvt_pk_bf16_f32 v113, v40, 0
    v_lshlrev_b32 v41, 16, v113
    v_sub_f32 v41, v40, v41
    v_cvt_pk_bf16_f32 v112, v40, v41
    v_add_f32 v42, v42, v43
    v_cvt_pk_bf16_f32 v115, v42, 0
    v_lshlrev_b32 v43, 16, v115
    v_sub_f32 v43, v42, v43
    v_cvt_pk_bf16_f32 v114, v42, v43
    v_add_f32 v44, v44, v45
    v_cvt_pk_bf16_f32 v117, v44, 0
    v_lshlrev_b32 v45, 16, v117
    v_sub_f32 v45, v44, v45
    v_cvt_pk_bf16_f32 v116, v44, v45
    s_barrier
    s_barrier
    s_waitcnt vmcnt(0)
    s_sleep 2
    s_cmp_ge_u32 s49, 29
    s_cbranch_scc1 L_g_skipe
    s_xor_b32 s75, s8, 0
    buffer_load_dwordx4 v[128:131], v1, s[44:47], s75 offen offset:0 sc1
    s_xor_b32 s75, s8, 0
    buffer_load_dwordx4 v[132:135], v1, s[44:47], s75 offen offset:1024 sc1
    s_xor_b32 s75, s8, 0
    buffer_load_dwordx4 v[136:139], v1, s[44:47], s75 offen offset:2048 sc1
    s_xor_b32 s75, s8, 0
    buffer_load_dwordx4 v[140:143], v1, s[44:47], s75 offen offset:3072 sc1
    s_xor_b32 s75, s8, 4096
    buffer_load_dwordx4 v[144:147], v1, s[44:47], s75 offen offset:0 sc1
    s_xor_b32 s75, s8, 4096
    buffer_load_dwordx4 v[148:151], v1, s[44:47], s75 offen offset:1024 sc1
    s_xor_b32 s75, s8, 4096
    buffer_load_dwordx4 v[152:155], v1, s[44:47], s75 offen offset:2048 sc1
    s_cmp_lg_u32 s55, 3
    s_cbranch_scc1 L_nost_41
    s_lshl_b32 s68, s56, 10
    s_add_u32 s68, s68, 160256
    v_lshl_add_u32 v14, v0, 2, s68
    ds_read2st64_b32 v[32:33], v14 offset0:0 offset1:1
    ds_read2st64_b32 v[34:35], v14 offset0:2 offset1:3
    s_waitcnt lgkmcnt(0)
    v_add_f32 v32, v32, v34
    v_add_f32 v33, v33, v35
    v_add_f32 v32, v32, v33
    buffer_store_dword v32, v7, s[44:47], 0 offen sc1
L_nost_41:
    s_setprio 1
    s_waitcnt vmcnt(3)
    v_max3_u32 v14, v128, v132, v136
    v_max_u32 v14, v14, v140
    v_cmp_eq_u32 vcc, -1, v14
    s_cbranch_vccnz L_y_stub_43
L_y_ok_42:
    s_waitcnt lgkmcnt(6)
    v_mfma_f32_32x32x16_bf16 v[40:55], v[88:91], v[128:131], 0
    ds_read_b64_tr_b16 v[88:89], v122 offset:3072
    ds_read_b64_tr_b16 v[90:91], v122 offset:3840
    s_xor_b32 s75, s8, 4096
    buffer_load_dwordx4 v[156:159], v1, s[44:47], s75 offen offset:3072 sc1
    v_mfma_f32_32x32x16_bf16 v[56:71], v[92:95], v[128:131], 0
    ds_read_b64_tr_b16 v[92:93], v122 offset:3104
    ds_read_b64_tr_b16 v[94:95], v122 offset:3872
    s_xor_b32 s68, s9, 1
    s_mul_i32 s68, s68, 6144
    v_add_u32 v123, s68, v124
    v_mfma_f32_32x32x16_bf16 v[72:87], v[96:99], v[128:131], 0
    ds_read_b64_tr_b16 v[96:97], v122 offset:3136
    ds_read_b64_tr_b16 v[98:99], v122 offset:3904
    s_xor_b32 s75, s8, 8192
    buffer_load_dwordx4 v[160:163], v1, s[44:47], s75 offen offset:0 sc1
    s_waitcnt lgkmcnt(6)
    v_mfma_f32_32x32x16_bf16 v[40:55], v[100:103], v[132:135], v[40:55]
    ds_read_b64_tr_b16 v[100:101], v122 offset:4608
    ds_read_b64_tr_b16 v[102:103], v122 offset:5376
    s_xor_b32 s75, s8, 8192
    buffer_load_dwordx4 v[164:167], v1, s[44:47], s75 offen offset:1024 sc1
    v_mfma_f32_32x32x16_bf16 v[56:71], v[104:107], v[132:135], v[56:71]
    ds_read_b64_tr_b16 v[104:105], v122 offset:4640
    ds_read_b64_tr_b16 v[106:107], v122 offset:5408
    v_mfma_f32_32x32x16_bf16 v[72:87], v[108:111], v[132:135], v[72:87]
    ds_read_b64_tr_b16 v[108:109], v122 offset:4672
    ds_read_b64_tr_b16 v[110:111], v122 offset:5440
    s_xor_b32 s75, s8, 8192
    buffer_load_dwordx4 v[168:171], v1, s[44:47], s75 offen offset:2048 sc1
    s_waitcnt lgkmcnt(6)
    v_mfma_f32_32x32x16_bf16 v[40:55], v[88:91], v[136:139], v[40:55]
    ds_read_b64_tr_b16 v[88:89], v123 offset:0
    ds_read_b64_tr_b16 v[90:91], v123 offset:768
    s_xor_b32 s75, s8, 8192
    buffer_load_dwordx4 v[172:175], v1, s[44:47], s75 offen offset:3072 sc1
    v_mfma_f32_32x32x16_bf16 v[56:71], v[92:95], v[136:139], v[56:71]
    ds_read_b64_tr_b16 v[92:93], v123 offset:32
    ds_read_b64_tr_b16 v[94:95], v123 offset:800
    v_mfma_f32_32x32x16_bf16 v[72:87], v[96:99], v[136:139], v[72:87]
    ds_read_b64_tr_b16 v[96:97], v123 offset:64
    ds_read_b64_tr_b16 v[98:99], v123 offset:832
    s_waitcnt lgkmcnt(6)
    v_mfma_f32_32x32x16_bf16 v[40:55], v[100:103], v[140:143], v[40:55]
    ds_read_b64_tr_b16 v[100:101], v123 offset:1536
    ds_read_b64_tr_b16 v[102:103], v123 offset:2304
    s_xor_b32 s75, s8, 12288
    buffer_load_dwordx4 v[176:179], v1, s[44:47], s75 offen offset:0 sc1
    v_mfma_f32_32x32x16_bf16 v[56:71], v[104:107], v[140:143], v[56:71]
    ds_read_b64_tr_b16 v[104:105], v123 offset:1568
    ds_read_b64_tr_b16 v[106:107], v123 offset:2336
    s_waitcnt vmcnt(5)
    v_max3_u32 v14, v144, v148, v152
    v_max_u32 v14, v14, v156
    v_cmp_eq_u32 vcc, -1, v14
    v_mfma_f32_32x32x16_bf16 v[72:87], v[108:111], v[140:143], v[72:87]
    ds_read_b64_tr_b16 v[108:109], v123 offset:1600
    ds_read_b64_tr_b16 v[110:111], v123 offset:2368
    s_cbranch_vccnz L_y_stub_45
L_y_ok_44:
    s_waitcnt lgkmcnt(6)
    v_mfma_f32_32x32x16_bf16 v[40:55], v[88:91], v[144:147], v[40:55]
    ds_read_b64_tr_b16 v[88:89], v123 offset:3072
    ds_read_b64_tr_b16 v[90:91], v123 offset:3840
    s_xor_b32 s75, s8, 12288
    buffer_load_dwordx4 v[180:183], v1, s[44:47], s75 offen offset:1024 sc1
    v_mfma_f32_32x32x16_bf16 v[56:71], v[92:95], v[144:147], v[56:71]
    ds_read_b64_tr_b16 v[92:93], v123 offset:3104
    ds_read_b64_tr_b16 v[94:95], v123 offset:3872
    s_xor_b32 s68, s9, 2
    s_mul_i32 s68, s68, 6144
    v_add_u32 v122, s68, v124
    v_mfma_f32_32x32x16_bf16 v[72:87], v[96:99], v[144:147], v[72:87]
    ds_read_b64_tr_b16 v[96:97], v123 offset:3136
    ds_read_b64_tr_b16 v[98:99], v123 offset:3904
    s_waitcnt lgkmcnt(6)
    v_mfma_f32_32x32x16_bf16 v[40:55], v[100:103], v[148:151], v[40:55]
    ds_read_b64_tr_b16 v[100:101], v123 offset:4608
    ds_read_b64_tr_b16 v[102:103], v123 offset:5376
    s_xor_b32 s75, s8, 12288
    buffer_load_dwordx4 v[184:187], v1, s[44:47], s75 offen offset:2048 sc1
    v_mfma_f32_32x32x16_bf16 v[56:71], v[104:107], v[148:151], v[56:71]
    ds_read_b64_tr_b16 v[104:105], v123 offset:4640
    ds_read_b64_tr_b16 v[106:107], v123 offset:5408
    v_mfma_f32_32x32x16_bf16 v[72:87], v[108:111], v[148:151], v[72:87]
    ds_read_b64_tr_b16 v[108:109], v123 offset:4672
    ds_read_b64_tr_b16 v[110:111], v123 offset:5440
    s_waitcnt lgkmcnt(6)
    v_mfma_f32_32x32x16_bf16 v[40:55], v[88:91], v[152:155], v[40:55]
    ds_read_b64_tr_b16 v[88:89], v122 offset:0
    ds_read_b64_tr_b16 v[90:91], v122 offset:768
    s_xor_b32 s75, s8, 12288
    buffer_load_dwordx4 v[188:191], v1, s[44:47], s75 offen offset:3072 sc1
    v_mfma_f32_32x32x16_bf16 v[56:71], v[92:95], v[152:155], v[56:71]
    ds_read_b64_tr_b16 v[92:93], v122 offset:32
    ds_read_b64_tr_b16 v[94:95], v122 offset:800
    v_mfma_f32_32x32x16_bf16 v[72:87], v[96:99], v[152:155], v[72:87]
    ds_read_b64_tr_b16 v[96:97], v122 offset:64
    ds_read_b64_tr_b16 v[98:99], v122 offset:832
    s_waitcnt lgkmcnt(6)
    v_mfma_f32_32x32x16_bf16 v[40:55], v[100:103], v[156:159], v[40:55]
    ds_read_b64_tr_b16 v[100:101], v122 offset:1536
    ds_read_b64_tr_b16 v[102:103], v122 offset:2304
    s_xor_b32 s75, s8, 16384
    buffer_load_dwordx4 v[128:131], v1, s[44:47], s75 offen offset:0 sc1
    v_mfma_f32_32x32x16_bf16 v[56:71], v[104:107], v[156:159], v[56:71]
    ds_read_b64_tr_b16 v[104:105], v122 offset:1568
    ds_read_b64_tr_b16 v[106:107], v122 offset:2336
    s_waitcnt vmcnt(5)
    v_max3_u32 v14, v160, v164, v168
    v_max_u32 v14, v14, v172
    v_cmp_eq_u32 vcc, -1, v14
    v_mfma_f32_32x32x16_bf16 v[72:87], v[108:111], v[156:159], v[72:87]
    ds_read_b64_tr_b16 v[108:109], v122 offset:1600
    ds_read_b64_tr_b16 v[110:111], v122 offset:2368
    s_cbranch_vccnz L_y_stub_47
L_y_ok_46:
    s_waitcnt lgkmcnt(6)
    v_mfma_f32_32x32x16_bf16 v[40:55], v[88:91], v[160:163], v[40:55]
    ds_read_b64_tr_b16 v[88:89], v122 offset:3072
    ds_read_b64_tr_b16 v[90:91], v122 offset:3840
    s_xor_b32 s75, s8, 16384
    buffer_load_dwordx4 v[132:135], v1, s[44:47], s75 offen offset:1024 sc1
    v_mfma_f32_32x32x16_bf16 v[56:71], v[92:95], v[160:163], v[56:71]
    ds_read_b64_tr_b16 v[92:93], v122 offset:3104
    ds_read_b64_tr_b16 v[94:95], v122 offset:3872
    s_xor_b32 s68, s9, 3
    s_mul_i32 s68, s68, 6144
    v_add_u32 v123, s68, v124
    v_mfma_f32_32x32x16_bf16 v[72:87], v[96:99], v[160:163], v[72:87]
    ds_read_b64_tr_b16 v[96:97], v122 offset:3136
    ds_read_b64_tr_b16 v[98:99], v122 offset:3904
    s_waitcnt lgkmcnt(6)
    v_mfma_f32_32x32x16_bf16 v[40:55], v[100:103], v[164:167], v[40:55]
    ds_read_b64_tr_b16 v[100:101], v122 offset:4608
    ds_read_b64_tr_b16 v[102:103], v122 offset:5376
    s_xor_b32 s75, s8, 16384
    buffer_load_dwordx4 v[136:139], v1, s[44:47], s75 offen offset:2048 sc1
    v_mfma_f32_32x32x16_bf16 v[56:71], v[104:107], v[164:167], v[56:71]
    ds_read_b64_tr_b16 v[104:105], v122 offset:4640
    ds_read_b64_tr_b16 v[106:107], v122 offset:5408
    v_mfma_f32_32x32x16_bf16 v[72:87], v[108:111], v[164:167], v[72:87]
    ds_read_b64_tr_b16 v[108:109], v122 offset:4672
    ds_read_b64_tr_b16 v[110:111], v122 offset:5440
    s_waitcnt lgkmcnt(6)
    v_mfma_f32_32x32x16_bf16 v[40:55], v[88:91], v[168:171], v[40:55]
    ds_read_b64_tr_b16 v[88:89], v123 offset:0
    ds_read_b64_tr_b16 v[90:91], v123 offset:768
    s_xor_b32 s75, s8, 16384
    buffer_load_dwordx4 v[140:143], v1, s[44:47], s75 offen offset:3072 sc1
    v_mfma_f32_32x32x16_bf16 v[56:71], v[92:95], v[168:171], v[56:71]
    ds_read_b64_tr_b16 v[92:93], v123 offset:32
    ds_read_b64_tr_b16 v[94:95], v123 offset:800
    v_mfma_f32_32x32x16_bf16 v[72:87], v[96:99], v[168:171], v[72:87]
    ds_read_b64_tr_b16 v[96:97], v123 offset:64
    ds_read_b64_tr_b16 v[98:99], v123 offset:832
    s_waitcnt lgkmcnt(6)
    v_mfma_f32_32x32x16_bf16 v[40:55], v[100:103], v[172:175], v[40:55]
    ds_read_b64_tr_b16 v[100:101], v123 offset:1536
    ds_read_b64_tr_b16 v[102:103], v123 offset:2304
    s_xor_b32 s75, s8, 20480
    buffer_load_dwordx4 v[144:147], v1, s[44:47], s75 offen offset:0 sc1
    v_mfma_f32_32x32x16_bf16 v[56:71], v[104:107], v[172:175], v[56:71]
    ds_read_b64_tr_b16 v[104:105], v123 offset:1568
    ds_read_b64_tr_b16 v[106:107], v123 offset:2336
    s_waitcnt vmcnt(5)
    v_max3_u32 v14, v176, v180, v184
    v_max_u32 v14, v14, v188
    v_cmp_eq_u32 vcc, -1, v14
    v_mfma_f32_32x32x16_bf16 v[72:87], v[108:111], v[172:175], v[72:87]
    ds_read_b64_tr_b16 v[108:109], v123 offset:1600
    ds_read_b64_tr_b16 v[110:111], v123 offset:2368
    s_cbranch_vccnz L_y_stub_49
L_y_ok_48:
    s_waitcnt lgkmcnt(6)
    v_mfma_f32_32x32x16_bf16 v[40:55], v[88:91], v[176:179], v[40:55]
    ds_read_b64_tr_b16 v[88:89], v123 offset:3072
    ds_read_b64_tr_b16 v[90:91], v123 offset:3840
    s_xor_b32 s75, s8, 20480
    buffer_load_dwordx4 v[148:151], v1, s[44:47], s75 offen offset:1024 sc1
    v_mfma_f32_32x32x16_bf16 v[56:71], v[92:95], v[176:179], v[56:71]
    ds_read_b64_tr_b16 v[92:93], v123 offset:3104
    ds_read_b64_tr_b16 v[94:95], v123 offset:3872
    s_xor_b32 s68, s9, 4
    s_mul_i32 s68, s68, 6144
    v_add_u32 v122, s68, v124
    v_mfma_f32_32x32x16_bf16 v[72:87], v[96:99], v[176:179], v[72:87]
    ds_read_b64_tr_b16 v[96:97], v123 offset:3136
    ds_read_b64_tr_b16 v[98:99], v123 offset:3904
    s_waitcnt lgkmcnt(6)
    v_mfma_f32_32x32x16_bf16 v[40:55], v[100:103], v[180:183], v[40:55]
    ds_read_b64_tr_b16 v[100:101], v123 offset:4608
    ds_read_b64_tr_b16 v[102:103], v123 offset:5376
    s_xor_b32 s75, s8, 20480
    buffer_load_dwordx4 v[152:155], v1, s[44:47], s75 offen offset:2048 sc1
    v_mfma_f32_32x32x16_bf16 v[56:71], v[104:107], v[180:183], v[56:71]
    ds_read_b64_tr_b16 v[104:105], v123 offset:4640
    ds_read_b64_tr_b16 v[106:107], v123 offset:5408
    buffer_load_dwordx2 v[32:33], v126, s[44:47], s73 offen offset:0 sc1
    v_mfma_f32_32x32x16_bf16 v[72:87], v[108:111], v[180:183], v[72:87]
    ds_read_b64_tr_b16 v[108:109], v123 offset:4672
    ds_read_b64_tr_b16 v[110:111], v123 offset:5440
    s_waitcnt lgkmcnt(6)
    v_mfma_f32_32x32x16_bf16 v[40:55], v[88:91], v[184:187], v[40:55]
    ds_read_b64_tr_b16 v[88:89], v122 offset:0
    ds_read_b64_tr_b16 v[90:91], v122 offset:768
    s_xor_b32 s75, s8, 20480
    buffer_load_dwordx4 v[156:159], v1, s[44:47], s75 offen offset:3072 sc1
    v_mfma_f32_32x32x16_bf16 v[56:71], v[92:95], v[184:187], v[56:71]
    ds_read_b64_tr_b16 v[92:93], v122 offset:32
    ds_read_b64_tr_b16 v[94:95], v122 offset:800
    buffer_load_dwordx2 v[34:35], v126, s[44:47], s73 offen offset:256 sc1
    v_mfma_f32_32x32x16_bf16 v[72:87], v[96:99], v[184:187], v[72:87]
    ds_read_b64_tr_b16 v[96:97], v122 offset:64
    ds_read_b64_tr_b16 v[98:99], v122 offset:832
    s_waitcnt lgkmcnt(6)
    v_mfma_f32_32x32x16_bf16 v[40:55], v[100:103], v[188:191], v[40:55]
    ds_read_b64_tr_b16 v[100:101], v122 offset:1536
    ds_read_b64_tr_b16 v[102:103], v122 offset:2304
    s_xor_b32 s75, s8, 24576
    buffer_load_dwordx4 v[160:163], v1, s[44:47], s75 offen offset:0 sc1
    v_mfma_f32_32x32x16_bf16 v[56:71], v[104:107], v[188:191], v[56:71]
    ds_read_b64_tr_b16 v[104:105], v122 offset:1568
    ds_read_b64_tr_b16 v[106:107], v122 offset:2336
    s_waitcnt vmcnt(7)
    v_max3_u32 v14, v128, v132, v136
    v_max_u32 v14, v14, v140
    v_cmp_eq_u32 vcc, -1, v14
    v_mfma_f32_32x32x16_bf16 v[72:87], v[108:111], v[188:191], v[72:87]
    ds_read_b64_tr_b16 v[108:109], v122 offset:1600
    ds_read_b64_tr_b16 v[110:111], v122 offset:2368
    s_cbranch_vccnz L_y_stub_51
L_y_ok_50:
    s_waitcnt lgkmcnt(6)
    v_mfma_f32_32x32x16_bf16 v[40:55], v[88:91], v[128:131], v[40:55]
    ds_read_b64_tr_b16 v[88:89], v122 offset:3072
    ds_read_b64_tr_b16 v[90:91], v122 offset:3840
    s_xor_b32 s75, s8, 24576
    buffer_load_dwordx4 v[164:167], v1, s[44:47], s75 offen offset:1024 sc1
    v_mfma_f32_32x32x16_bf16 v[56:71], v[92:95], v[128:131], v[56:71]
    ds_read_b64_tr_b16 v[92:93], v122 offset:3104
    ds_read_b64_tr_b16 v[94:95], v122 offset:3872
    s_xor_b32 s68, s9, 5
    s_mul_i32 s68, s68, 6144
    v_add_u32 v123, s68, v124
    v_mfma_f32_32x32x16_bf16 v[72:87], v[96:99], v[128:131], v[72:87]
    ds_read_b64_tr_b16 v[96:97], v122 offset:3136
    ds_read_b64_tr_b16 v[98:99], v122 offset:3904
    s_waitcnt lgkmcnt(6)
    v_mfma_f32_32x32x16_bf16 v[40:55], v[100:103], v[132:135], v[40:55]
    ds_read_b64_tr_b16 v[100:101], v122 offset:4608
    ds_read_b64_tr_b16 v[102:103], v122 offset:5376
    s_xor_b32 s75, s8, 24576
    buffer_load_dwordx4 v[168:171], v1, s[44:47], s75 offen offset:2048 sc1
    v_mfma_f32_32x32x16_bf16 v[56:71], v[104:107], v[132:135], v[56:71]
    ds_read_b64_tr_b16 v[104:105], v122 offset:4640
    ds_read_b64_tr_b16 v[106:107], v122 offset:5408
    buffer_load_dwordx2 v[36:37], v126, s[44:47], s73 offen offset:512 sc1
    v_mfma_f32_32x32x16_bf16 v[72:87], v[108:111], v[132:135], v[72:87]
    ds_read_b64_tr_b16 v[108:109], v122 offset:4672
    ds_read_b64_tr_b16 v[110:111], v122 offset:5440
    s_waitcnt lgkmcnt(6)
    v_mfma_f32_32x32x16_bf16 v[40:55], v[88:91], v[136:139], v[40:55]
    ds_read_b64_tr_b16 v[88:89], v123 offset:0
    ds_read_b64_tr_b16 v[90:91], v123 offset:768
    s_xor_b32 s75, s8, 24576
    buffer_load_dwordx4 v[172:175], v1, s[44:47], s75 offen offset:3072 sc1
    v_mfma_f32_32x32x16_bf16 v[56:71], v[92:95], v[136:139], v[56:71]
    ds_read_b64_tr_b16 v[92:93], v123 offset:32
    ds_read_b64_tr_b16 v[94:95], v123 offset:800
    buffer_load_dwordx2 v[38:39], v126, s[44:47], s73 offen offset:768 sc1
    v_mfma_f32_32x32x16_bf16 v[72:87], v[96:99], v[136:139], v[72:87]
    ds_read_b64_tr_b16 v[96:97], v123 offset:64
    ds_read_b64_tr_b16 v[98:99], v123 offset:832
    s_waitcnt lgkmcnt(6)
    v_mfma_f32_32x32x16_bf16 v[40:55], v[100:103], v[140:143], v[40:55]
    ds_read_b64_tr_b16 v[100:101], v123 offset:1536
    ds_read_b64_tr_b16 v[102:103], v123 offset:2304
    s_xor_b32 s75, s8, 28672
    buffer_load_dwordx4 v[176:179], v1, s[44:47], s75 offen offset:0 sc1
    v_mfma_f32_32x32x16_bf16 v[56:71], v[104:107], v[140:143], v[56:71]
    ds_read_b64_tr_b16 v[104:105], v123 offset:1568
    ds_read_b64_tr_b16 v[106:107], v123 offset:2336
    s_waitcnt vmcnt(8)
    v_max3_u32 v14, v144, v148, v152
    v_max_u32 v14, v14, v156
    v_cmp_eq_u32 vcc, -1, v14
    v_mfma_f32_32x32x16_bf16 v[72:87], v[108:111], v[140:143], v[72:87]
    ds_read_b64_tr_b16 v[108:109], v123 offset:1600
    ds_read_b64_tr_b16 v[110:111], v123 offset:2368
    s_cbranch_vccnz L_y_stub_53
L_y_ok_52:
    s_waitcnt lgkmcnt(6)
    v_mfma_f32_32x32x16_bf16 v[40:55], v[88:91], v[144:147], v[40:55]
    ds_read_b64_tr_b16 v[88:89], v123 offset:3072
    ds_read_b64_tr_b16 v[90:91], v123 offset:3840
    s_xor_b32 s75, s8, 28672
    buffer_load_dwordx4 v[180:183], v1, s[44:47], s75 offen offset:1024 sc1
    v_mfma_f32_32x32x16_bf16 v[56:71], v[92:95], v[144:147], v[56:71]
    ds_read_b64_tr_b16 v[92:93], v123 offset:3104
    ds_read_b64_tr_b16 v[94:95], v123 offset:3872
    s_xor_b32 s68, s9, 6
    s_mul_i32 s68, s68, 6144
    v_add_u32 v122, s68, v124
    v_mfma_f32_32x32x16_bf16 v[72:87], v[96:99], v[144:147], v[72:87]
    ds_read_b64_tr_b16 v[96:97], v123 offset:3136
    ds_read_b64_tr_b16 v[98:99], v123 offset:3904
    ds_read_b64_tr_b16 v[128:129], v120 offset:0
    ds_read_b64_tr_b16 v[130:131], v120 offset:4096
    s_waitcnt lgkmcnt(8)
    v_mfma_f32_32x32x16_bf16 v[40:55], v[100:103], v[148:151], v[40:55]
    ds_read_b64_tr_b16 v[100:101], v123 offset:4608
    ds_read_b64_tr_b16 v[102:103], v123 offset:5376
    s_xor_b32 s75, s8, 28672
    buffer_load_dwordx4 v[184:187], v1, s[44:47], s75 offen offset:2048 sc1
    v_mfma_f32_32x32x16_bf16 v[56:71], v[104:107], v[148:151], v[56:71]
    ds_read_b64_tr_b16 v[104:105], v123 offset:4640
    ds_read_b64_tr_b16 v[106:107], v123 offset:5408
    v_mfma_f32_32x32x16_bf16 v[72:87], v[108:111], v[148:151], v[72:87]
    ds_read_b64_tr_b16 v[108:109], v123 offset:4672
    ds_read_b64_tr_b16 v[110:111], v123 offset:5440
    ds_read_b64_tr_b16 v[132:133], v121 offset:0
    ds_read_b64_tr_b16 v[134:135], v121 offset:4096
    s_waitcnt lgkmcnt(10)
    v_mfma_f32_32x32x16_bf16 v[40:55], v[88:91], v[152:155], v[40:55]
    ds_read_b64_tr_b16 v[88:89], v122 offset:0
    ds_read_b64_tr_b16 v[90:91], v122 offset:768
    s_xor_b32 s75, s8, 28672
    buffer_load_dwordx4 v[188:191], v1, s[44:47], s75 offen offset:3072 sc1
    s_waitcnt vmcnt(4)
    v_max3_u32 v14, v32, v34, v36
    v_max_u32 v14, v14, v38
    v_cmp_eq_u32 vcc, -1, v14
    v_mfma_f32_32x32x16_bf16 v[56:71], v[92:95], v[152:155], v[56:71]
    ds_read_b64_tr_b16 v[92:93], v122 offset:32
    ds_read_b64_tr_b16 v[94:95], v122 offset:800
    s_cbranch_vccnz L_st_stub_55
L_st_ok_54:
    v_mfma_f32_32x32x16_bf16 v[72:87], v[96:99], v[152:155], v[72:87]
    ds_read_b64_tr_b16 v[96:97], v122 offset:64
    ds_read_b64_tr_b16 v[98:99], v122 offset:832
    ds_read_b64_tr_b16 v[136:137], v120 offset:8192
    ds_read_b64_tr_b16 v[138:139], v120 offset:12288
    s_waitcnt lgkmcnt(10)
    v_mfma_f32_32x32x16_bf16 v[40:55], v[100:103], v[156:159], v[40:55]
    ds_read_b64_tr_b16 v[100:101], v122 offset:1536
    ds_read_b64_tr_b16 v[102:103], v122 offset:2304
    v_mfma_f32_32x32x16_bf16 v[56:71], v[104:107], v[156:159], v[56:71]
    ds_read_b64_tr_b16 v[104:105], v122 offset:1568
    ds_read_b64_tr_b16 v[106:107], v122 offset:2336
    v_max3_u32 v14, v160, v164, v168
    v_max_u32 v14, v14, v172
    v_cmp_eq_u32 vcc, -1, v14
    v_mfma_f32_32x32x16_bf16 v[72:87], v[108:111], v[156:159], v[72:87]
    ds_read_b64_tr_b16 v[108:109], v122 offset:1600
    ds_read_b64_tr_b16 v[110:111], v122 offset:2368
    ds_read_b64_tr_b16 v[140:141], v121 offset:8192
    ds_read_b64_tr_b16 v[142:143], v121 offset:12288
    s_cbranch_vccnz L_y_stub_57
L_y_ok_56:
    s_barrier
    s_waitcnt lgkmcnt(10)
    v_mfma_f32_32x32x16_bf16 v[40:55], v[88:91], v[160:163], v[40:55]
    ds_read_b64_tr_b16 v[88:89], v122 offset:3072
    ds_read_b64_tr_b16 v[90:91], v122 offset:3840
    v_mfma_f32_32x32x16_bf16 v[56:71], v[92:95], v[160:163], v[56:71]
    ds_read_b64_tr_b16 v[92:93], v122 offset:3104
    ds_read_b64_tr_b16 v[94:95], v122 offset:3872
    s_xor_b32 s68, s9, 7
    s_mul_i32 s68, s68, 6144
    v_add_u32 v123, s68, v124
    v_mfma_f32_32x32x16_bf16 v[72:87], v[96:99], v[160:163], v[72:87]
    ds_read_b64_tr_b16 v[96:97], v122 offset:3136
    ds_read_b64_tr_b16 v[98:99], v122 offset:3904
    ds_read_b64_tr_b16 v[144:145], v120 offset:16384
    ds_read_b64_tr_b16 v[146:147], v120 offset:20480
    s_waitcnt lgkmcnt(10)
    v_mfma_f32_32x32x16_bf16 v[40:55], v[100:103], v[164:167], v[40:55]
    ds_read_b64_tr_b16 v[100:101], v122 offset:4608
    ds_read_b64_tr_b16 v[102:103], v122 offset:5376
    v_mfma_f32_32x32x16_bf16 v[56:71], v[104:107], v[164:167], v[56:71]
    ds_read_b64_tr_b16 v[104:105], v122 offset:4640
    ds_read_b64_tr_b16 v[106:107], v122 offset:5408
    v_mfma_f32_32x32x16_bf16 v[72:87], v[108:111], v[164:167], v[72:87]
    ds_read_b64_tr_b16 v[108:109], v122 offset:4672
    ds_read_b64_tr_b16 v[110:111], v122 offset:5440
    ds_read_b64_tr_b16 v[148:149], v121 offset:16384
    ds_read_b64_tr_b16 v[150:151], v121 offset:20480
    s_waitcnt lgkmcnt(10)
    v_mfma_f32_32x32x16_bf16 v[40:55], v[88:91], v[168:171], v[40:55]
    ds_read_b64_tr_b16 v[88:89], v123 offset:0
    ds_read_b64_tr_b16 v[90:91], v123 offset:768
    v_mfma_f32_32x32x16_bf16 v[56:71], v[92:95], v[168:171], v[56:71]
    ds_read_b64_tr_b16 v[92:93], v123 offset:32
    ds_read_b64_tr_b16 v[94:95], v123 offset:800
    v_mfma_f32_32x32x16_bf16 v[72:87], v[96:99], v[168:171], v[72:87]
    ds_read_b64_tr_b16 v[96:97], v123 offset:64
    ds_read_b64_tr_b16 v[98:99], v123 offset:832
    ds_read_b64_tr_b16 v[152:153], v120 offset:24576
    ds_read_b64_tr_b16 v[154:155], v120 offset:28672
    s_waitcnt lgkmcnt(10)
    v_mfma_f32_32x32x16_bf16 v[40:55], v[100:103], v[172:175], v[40:55]
    ds_read_b64_tr_b16 v[100:101], v123 offset:1536
    ds_read_b64_tr_b16 v[102:103], v123 offset:2304
    v_mfma_f32_32x32x16_bf16 v[56:71], v[104:107], v[172:175], v[56:71]
    ds_read_b64_tr_b16 v[104:105], v123 offset:1568
    ds_read_b64_tr_b16 v[106:107], v123 offset:2336
    s_waitcnt vmcnt(0)
    v_max3_u32 v14, v176, v180, v184
    v_max_u32 v14, v14, v188
    v_cmp_eq_u32 vcc, -1, v14
    v_mfma_f32_32x32x16_bf16 v[72:87], v[108:111], v[172:175], v[72:87]
    ds_read_b64_tr_b16 v[108:109], v123 offset:1600
    ds_read_b64_tr_b16 v[110:111], v123 offset:2368
    ds_read_b64_tr_b16 v[156:157], v121 offset:24576
    ds_read_b64_tr_b16 v[158:159], v121 offset:28672
    s_cbranch_vccnz L_y_stub_59
L_y_ok_58:
    s_waitcnt lgkmcnt(10)
    v_mfma_f32_32x32x16_bf16 v[40:55], v[88:91], v[176:179], v[40:55]
    ds_read_b64_tr_b16 v[88:89], v123 offset:3072
    ds_read_b64_tr_b16 v[90:91], v123 offset:3840
    v_mfma_f32_32x32x16_bf16 v[56:71], v[92:95], v[176:179], v[56:71]
    ds_read_b64_tr_b16 v[92:93], v123 offset:3104
    ds_read_b64_tr_b16 v[94:95], v123 offset:3872
    v_mfma_f32_32x32x16_bf16 v[72:87], v[96:99], v[176:179], v[72:87]
    ds_read_b64_tr_b16 v[96:97], v123 offset:3136
    ds_read_b64_tr_b16 v[98:99], v123 offset:3904
    v_add_f32 v32, v32, v34
    v_add_f32 v33, v33, v35
    v_add_f32 v36, v36, v38
    v_add_f32 v37, v37, v39
    s_waitcnt lgkmcnt(8)
    v_mfma_f32_32x32x16_bf16 v[40:55], v[100:103], v[180:183], v[40:55]
    ds_read_b64_tr_b16 v[100:101], v123 offset:4608
    ds_read_b64_tr_b16 v[102:103], v123 offset:5376
    v_add_f32 v32, v32, v36
    v_add_f32 v33, v33, v37
    v_mov_b32 v34, v32
    v_mfma_f32_32x32x16_bf16 v[56:71], v[104:107], v[180:183], v[56:71]
    ds_read_b64_tr_b16 v[104:105], v123 offset:4640
    ds_read_b64_tr_b16 v[106:107], v123 offset:5408
    v_mov_b32 v35, v33
    v_cmp_gt_u32 vcc, 32, v0
    v_mfma_f32_32x32x16_bf16 v[72:87], v[108:111], v[180:183], v[72:87]
    ds_read_b64_tr_b16 v[108:109], v123 offset:4672
    ds_read_b64_tr_b16 v[110:111], v123 offset:5440
    v_permlane32_swap_b32 v32, v34
    v_permlane32_swap_b32 v33, v35
    s_waitcnt lgkmcnt(6)
    v_mfma_f32_32x32x16_bf16 v[40:55], v[88:91], v[184:187], v[40:55]
    v_add_f32 v32, v32, v34
    v_add_f32 v33, v33, v35
    v_mul_f32 v32, 0xbb000000, v32
    v_mul_f32 v33, 0x3b000000, v33
    v_mfma_f32_32x32x16_bf16 v[56:71], v[92:95], v[184:187], v[56:71]
    v_fma_f32 v33, -v32, v32, v33
    v_max_f32 v33, 0, v33
    v_add_f32 v33, 0x3727c5ac, v33
    v_mfma_f32_32x32x16_bf16 v[72:87], v[96:99], v[184:187], v[72:87]
    v_sqrt_f32 v34, v33
    v_rcp_f32 v36, v33
    v_cndmask_b32 v32, v34, v32, vcc
    s_waitcnt lgkmcnt(0)
    v_mfma_f32_32x32x16_bf16 v[40:55], v[100:103], v[188:191], v[40:55]
    v_cvt_pk_bf16_f32 v118, v32, v32
    v_lshlrev_b32 v33, 16, v118
    v_sub_f32 v33, v32, v33
    v_mfma_f32_32x32x16_bf16 v[56:71], v[104:107], v[188:191], v[56:71]
    v_cvt_pk_bf16_f32 v119, v33, 0
    v_mov_b32 v37, v36
    v_mfma_f32_32x32x16_bf16 v[72:87], v[108:111], v[188:191], v[72:87]
    v_mfma_f32_32x32x8_bf16 v[40:55], v[112:113], v[118:119], v[40:55]
    v_mfma_f32_32x32x8_bf16 v[56:71], v[114:115], v[118:119], v[56:71]
    v_mfma_f32_32x32x8_bf16 v[72:87], v[116:117], v[118:119], v[72:87]
    s_cmp_eq_u32 s49, 28
    s_cselect_b32 s72, 1073741824, 0
    s_setprio 0
    s_nop 6
    v_max_f32 v40, 0, v40
    v_max_f32 v41, 0, v41
    v_max_f32 v42, 0, v42
    v_max_f32 v43, 0, v43
    v_max_f32 v44, 0, v44
    v_max_f32 v45, 0, v45
    v_max_f32 v46, 0, v46
    v_max_f32 v47, 0, v47
    v_mul_f32 v48, v48, v36
    v_mul_f32 v49, v49, v37
    v_mul_f32 v50, v50, v36
    v_mul_f32 v51, v51, v37
    v_mul_f32 v52, v52, v36
    v_mul_f32 v53, v53, v37
    v_mul_f32 v54, v54, v36
    v_mul_f32 v55, v55, v37
    v_mul_f32 v40, v40, v48
    v_mul_f32 v41, v41, v49
    v_mul_f32 v42, v42, v50
    v_mul_f32 v43, v43, v51
    v_mul_f32 v44, v44, v52
    v_mul_f32 v45, v45, v53
    v_mul_f32 v46, v46, v54
    v_mul_f32 v47, v47, v55
    v_cvt_pk_bf16_f32 v40, v40, v41
    v_cvt_pk_bf16_f32 v41, v42, v43
    v_cvt_pk_bf16_f32 v42, v44, v45
    v_cvt_pk_bf16_f32 v43, v46, v47
    buffer_store_dwordx4 v[40:43], v6, s[44:47], 0 offen offset:0 sc1
    v_max_f32 v56, 0, v56
    v_max_f32 v57, 0, v57
    v_max_f32 v58, 0, v58
    v_max_f32 v59, 0, v59
    v_max_f32 v60, 0, v60
    v_max_f32 v61, 0, v61
    v_max_f32 v62, 0, v62
    v_max_f32 v63, 0, v63
    v_mul_f32 v64, v64, v36
    v_mul_f32 v65, v65, v37
    v_mul_f32 v66, v66, v36
    v_mul_f32 v67, v67, v37
    v_mul_f32 v68, v68, v36
    v_mul_f32 v69, v69, v37
    v_mul_f32 v70, v70, v36
    v_mul_f32 v71, v71, v37
    v_mul_f32 v56, v56, v64
    v_mul_f32 v57, v57, v65
    v_mul_f32 v58, v58, v66
    v_mul_f32 v59, v59, v67
    v_mul_f32 v60, v60, v68
    v_mul_f32 v61, v61, v69
    v_mul_f32 v62, v62, v70
    v_mul_f32 v63, v63, v71
    v_cvt_pk_bf16_f32 v56, v56, v57
    v_cvt_pk_bf16_f32 v57, v58, v59
    v_cvt_pk_bf16_f32 v58, v60, v61
    v_cvt_pk_bf16_f32 v59, v62, v63
    buffer_store_dwordx4 v[56:59], v6, s[44:47], 0 offen offset:1024 sc1
    v_max_f32 v72, 0, v72
    v_max_f32 v73, 0, v73
    v_max_f32 v74, 0, v74
    v_max_f32 v75, 0, v75
    v_max_f32 v76, 0, v76
    v_max_f32 v77, 0, v77
    v_max_f32 v78, 0, v78
    v_max_f32 v79, 0, v79
    v_mul_f32 v80, v80, v36
    v_mul_f32 v81, v81, v37
    v_mul_f32 v82, v82, v36
    v_mul_f32 v83, v83, v37
    v_mul_f32 v84, v84, v36
    v_mul_f32 v85, v85, v37
    v_mul_f32 v86, v86, v36
    v_mul_f32 v87, v87, v37
    v_mul_f32 v72, v72, v80
    v_mul_f32 v73, v73, v81
    v_mul_f32 v74, v74, v82
    v_mul_f32 v75, v75, v83
    v_mul_f32 v76, v76, v84
    v_mul_f32 v77, v77, v85
    v_mul_f32 v78, v78, v86
    v_mul_f32 v79, v79, v87
    v_cvt_pk_bf16_f32 v72, v72, v73
    v_cvt_pk_bf16_f32 v73, v74, v75
    v_cvt_pk_bf16_f32 v74, v76, v77
    v_cvt_pk_bf16_f32 v75, v78, v79
    buffer_store_dwordx4 v[72:75], v6, s[44:47], s72 offen offset:2048 sc1
L_g_donee:
    s_lshl_b32 s69, s55, 10
    v_add_u32 v36, s69, v1
    s_mul_i32 s79, s64, 88064
    s_add_u32 s79, s79, 6291456
    s_ashr_i32 s68, s81, 4
    s_add_u32 s83, s79, s68
    s_lshr_b32 s68, s80, 4
    s_add_u32 s79, s79, s68
    s_barrier
    s_cmp_lt_u32 s49, 29
    s_cbranch_scc1 L_nopoll_60
L_poll_61:
    s_sleep 4
    buffer_load_dword v40, off, s[44:47], s79 sc1
    s_sub_u32 s62, s62, 1
    s_max_i32 s62, s62, 0
    s_waitcnt vmcnt(0)
    s_cmp_eq_u32 s62, 0
    s_cbranch_scc1 L_nopoll_60
    v_cmp_eq_u32 vcc, -1, v40
    s_cbranch_vccnz L_poll_61
    s_sleep 4
L_nopoll_60:
    s_waitcnt vmcnt(0)
    s_barrier
    s_cmp_gt_u32 s82, 4
    s_cselect_b32 s75, s80, s81
    s_add_u32 s75, s75, 65536
    s_add_u32 m0, s77, 131072
    s_nop 0
    buffer_load_dwordx4 v8, s[28:31], s75 offen  lds
    s_cmp_gt_u32 s82, 4
    s_cselect_b32 s75, s80, s81
    s_add_u32 s75, s75, 73728
    s_add_u32 m0, s77, 135168
    s_nop 0
    buffer_load_dwordx4 v8, s[28:31], s75 offen  lds
    s_cmp_gt_u32 s82, 5
    s_cselect_b32 s75, s80, s81
    s_add_u32 s75, s75, 81920
    s_add_u32 m0, s77, 139264
    s_nop 0
    buffer_load_dwordx4 v8, s[28:31], s75 offen  lds
    s_cmp_gt_u32 s82, 5
    s_cselect_b32 s75, s80, s81
    s_add_u32 s75, s75, 90112
    s_add_u32 m0, s77, 143360
    s_nop 0
    buffer_load_dwordx4 v8, s[28:31], s75 offen  lds
    s_cmp_gt_u32 s82, 0
    s_cselect_b32 s75, s79, s83
    s_add_u32 s75, s75, 0
    buffer_load_dwordx4 v[72:75], v1, s[44:47], s75 offen sc1
    s_cmp_gt_u32 s82, 1
    s_cselect_b32 s75, s79, s83
    s_add_u32 s75, s75, 1024
    buffer_load_dwordx4 v[76:79], v1, s[44:47], s75 offen sc1
    s_cmp_gt_u32 s82, 2
    s_cselect_b32 s75, s79, s83
    s_add_u32 s75, s75, 2048
    buffer_load_dwordx4 v[80:83], v1, s[44:47], s75 offen sc1
    s_cmp_gt_u32 s82, 3
    s_cselect_b32 s75, s79, s83
    s_add_u32 s75, s75, 3072
    buffer_load_dwordx4 v[84:87], v1, s[44:47], s75 offen sc1
    s_cmp_gt_u32 s82, 4
    s_cselect_b32 s75, s79, s83
    s_add_u32 s75, s75, 4096
    buffer_load_dwordx4 v[88:91], v1, s[44:47], s75 offen sc1
    s_cmp_gt_u32 s82, 5
    s_cselect_b32 s75, s79, s83
    s_add_u32 s75, s75, 5120
    buffer_load_dwordx4 v[92:95], v1, s[44:47], s75 offen sc1
    s_waitcnt vmcnt(6)
    s_setprio 2
    s_barrier
    s_waitcnt vmcnt(4)
    v_max_u32 v14, v72, v76
    v_cmp_eq_u32 vcc, -1, v14
    s_cbranch_vccnz L_h_stub_63
L_h_ok_62:
    v_mfma_f32_32x32x16_bf16 v[56:71], v[132:135], v[72:75], 0
    v_add_u32 v3, s10, v36
    ds_write_b128 v3, v[192:195] offset:0
    s_cmp_gt_u32 s82, 6
    s_cselect_b32 s75, s79, s83
    s_add_u32 s75, s75, 6144
    buffer_load_dwordx4 v[96:99], v1, s[44:47], s75 offen sc1
    v_mfma_f32_32x32x16_bf16 v[40:55], v[128:131], v[72:75], 0
    ds_write_b128 v3, v[196:199] offset:4096
    s_cmp_gt_u32 s82, 7
    s_cselect_b32 s75, s79, s83
    s_add_u32 s75, s75, 7168
    buffer_load_dwordx4 v[100:103], v1, s[44:47], s75 offen sc1
    v_mfma_f32_32x32x16_bf16 v[56:71], v[140:143], v[76:79], v[56:71]
    ds_write_b128 v3, v[200:203] offset:8192
    s_cmp_gt_u32 s82, 8
    s_cselect_b32 s75, s79, s83
    s_add_u32 s75, s75, 8192
    buffer_load_dwordx4 v[104:107], v1, s[44:47], s75 offen sc1
    s_waitcnt vmcnt(5)
    v_max_u32 v14, v80, v84
    v_cmp_eq_u32 vcc, -1, v14
    v_mfma_f32_32x32x16_bf16 v[40:55], v[136:139], v[76:79], v[40:55]
    ds_write_b128 v3, v[204:207] offset:12288
    s_cmp_gt_u32 s82, 9
    s_cselect_b32 s75, s79, s83
    s_add_u32 s75, s75, 9216
    buffer_load_dwordx4 v[108:111], v1, s[44:47], s75 offen sc1
    s_cbranch_vccnz L_h_stub_65
L_h_ok_64:
    v_mfma_f32_32x32x16_bf16 v[56:71], v[148:151], v[80:83], v[56:71]
    v_add_u32 v34, 98304, v11
    v_xor_b32 v35, 64, v34
    ds_read_b64_tr_b16 v[132:133], v35 offset:32768
    ds_read_b64_tr_b16 v[134:135], v35 offset:36864
    ds_write_b128 v3, v[208:211] offset:16384
    s_cmp_gt_u32 s82, 10
    s_cselect_b32 s75, s79, s83
    s_add_u32 s75, s75, 10240
    buffer_load_dwordx4 v[112:115], v1, s[44:47], s75 offen sc1
    v_mfma_f32_32x32x16_bf16 v[40:55], v[144:147], v[80:83], v[40:55]
    ds_read_b64_tr_b16 v[128:129], v34 offset:32768
    ds_read_b64_tr_b16 v[130:131], v34 offset:36864
    ds_write_b128 v3, v[212:215] offset:20480
    s_cmp_gt_u32 s82, 11
    s_cselect_b32 s75, s79, s83
    s_add_u32 s75, s75, 11264
    buffer_load_dwordx4 v[116:119], v1, s[44:47], s75 offen sc1
    v_mfma_f32_32x32x16_bf16 v[56:71], v[156:159], v[84:87], v[56:71]
    ds_read_b64_tr_b16 v[140:141], v35 offset:40960
    ds_read_b64_tr_b16 v[142:143], v35 offset:45056
    s_add_u32 s68, s10, 49152
    v_add_u32 v2, s68, v36
    ds_write_b128 v2, v[216:219] offset:0
    s_cmp_gt_u32 s82, 12
    s_cselect_b32 s75, s79, s83
    s_add_u32 s75, s75, 12288
    buffer_load_dwordx4 v[120:123], v1, s[44:47], s75 offen sc1
    s_waitcnt vmcnt(7)
    v_max_u32 v14, v88, v92
    v_cmp_eq_u32 vcc, -1, v14
    v_mfma_f32_32x32x16_bf16 v[40:55], v[152:155], v[84:87], v[40:55]
    ds_read_b64_tr_b16 v[136:137], v34 offset:40960
    ds_read_b64_tr_b16 v[138:139], v34 offset:45056
    ds_write_b128 v2, v[220:223] offset:4096
    s_cmp_gt_u32 s82, 13
    s_cselect_b32 s75, s79, s83
    s_add_u32 s75, s75, 13312
    buffer_load_dwordx4 v[124:127], v1, s[44:47], s75 offen sc1
    s_cbranch_vccnz L_h_stub_67
L_h_ok_66:
    s_waitcnt lgkmcnt(7)
    v_mfma_f32_32x32x16_bf16 v[56:71], v[132:135], v[88:91], v[56:71]
    v_add_u32 v32, s10, v11
    v_xor_b32 v33, 64, v32
    ds_read_b64_tr_b16 v[148:149], v33 offset:0
    ds_read_b64_tr_b16 v[150:151], v33 offset:4096
    ds_write_b128 v2, v[224:227] offset:8192
    v_mfma_f32_32x32x16_bf16 v[40:55], v[128:131], v[88:91], v[40:55]
    ds_read_b64_tr_b16 v[144:145], v32 offset:0
    ds_read_b64_tr_b16 v[146:147], v32 offset:4096
    ds_write_b128 v2, v[228:231] offset:12288
    s_cmp_gt_u32 s82, 14
    s_cselect_b32 s75, s79, s83
    s_add_u32 s75, s75, 14336
    buffer_load_dwordx4 v[160:163], v1, s[44:47], s75 offen sc1
    s_waitcnt lgkmcnt(7)
    v_mfma_f32_32x32x16_bf16 v[56:71], v[140:143], v[92:95], v[56:71]
    ds_read_b64_tr_b16 v[156:157], v33 offset:8192
    ds_read_b64_tr_b16 v[158:159], v33 offset:12288
    ds_write_b128 v2, v[232:235] offset:16384
    s_waitcnt vmcnt(7)
    v_max_u32 v14, v96, v100
    v_cmp_eq_u32 vcc, -1, v14
    v_mfma_f32_32x32x16_bf16 v[40:55], v[136:139], v[92:95], v[40:55]
    ds_read_b64_tr_b16 v[152:153], v32 offset:8192
    ds_read_b64_tr_b16 v[154:155], v32 offset:12288
    ds_write_b128 v2, v[236:239] offset:20480
    s_cmp_gt_u32 s82, 15
    s_cselect_b32 s75, s79, s83
    s_add_u32 s75, s75, 15360
    buffer_load_dwordx4 v[164:167], v1, s[44:47], s75 offen sc1
    s_cbranch_vccnz L_h_stub_69
L_h_ok_68:
    s_waitcnt lgkmcnt(7)
    v_mfma_f32_32x32x16_bf16 v[56:71], v[148:151], v[96:99], v[56:71]
    ds_read_b64_tr_b16 v[132:133], v33 offset:16384
    ds_read_b64_tr_b16 v[134:135], v33 offset:20480
    v_add_u32 v3, s11, v36
    ds_write_b128 v3, v[240:243] offset:0
    v_mfma_f32_32x32x16_bf16 v[40:55], v[144:147], v[96:99], v[40:55]
    ds_read_b64_tr_b16 v[128:129], v32 offset:16384
    ds_read_b64_tr_b16 v[130:131], v32 offset:20480
    ds_write_b128 v3, v[244:247] offset:4096
    s_cmp_gt_u32 s82, 16
    s_cselect_b32 s75, s79, s83
    s_add_u32 s75, s75, 16384
    buffer_load_dwordx4 v[168:171], v1, s[44:47], s75 offen sc1
    s_waitcnt lgkmcnt(7)
    v_mfma_f32_32x32x16_bf16 v[56:71], v[156:159], v[100:103], v[56:71]
    s_add_u32 s68, s10, 49152
    v_add_u32 v34, s68, v11
    v_xor_b32 v35, 64, v34
    ds_read_b64_tr_b16 v[140:141], v35 offset:0
    ds_read_b64_tr_b16 v[142:143], v35 offset:4096
    ds_write_b128 v3, v[248:251] offset:8192
    s_waitcnt vmcnt(7)
    v_max_u32 v14, v104, v108
    v_cmp_eq_u32 vcc, -1, v14
    v_mfma_f32_32x32x16_bf16 v[40:55], v[152:155], v[100:103], v[40:55]
    ds_read_b64_tr_b16 v[136:137], v34 offset:0
    ds_read_b64_tr_b16 v[138:139], v34 offset:4096
    ds_write_b128 v3, v[252:255] offset:12288
    s_cmp_gt_u32 s82, 17
    s_cselect_b32 s75, s79, s83
    s_add_u32 s75, s75, 17408
    buffer_load_dwordx4 v[172:175], v1, s[44:47], s75 offen sc1
    s_cbranch_vccnz L_h_stub_71
L_h_ok_70:
    s_waitcnt lgkmcnt(7)
    v_mfma_f32_32x32x16_bf16 v[56:71], v[132:135], v[104:107], v[56:71]
    ds_read_b64_tr_b16 v[148:149], v35 offset:8192
    ds_read_b64_tr_b16 v[150:151], v35 offset:12288
    v_mfma_f32_32x32x16_bf16 v[40:55], v[128:131], v[104:107], v[40:55]
    ds_read_b64_tr_b16 v[144:145], v34 offset:8192
    ds_read_b64_tr_b16 v[146:147], v34 offset:12288
    s_cmp_gt_u32 s82, 18
    s_cselect_b32 s75, s79, s83
    s_add_u32 s75, s75, 18432
    buffer_load_dwordx4 v[176:179], v1, s[44:47], s75 offen sc1
    s_waitcnt lgkmcnt(5)
    v_mfma_f32_32x32x16_bf16 v[56:71], v[140:143], v[108:111], v[56:71]
    ds_read_b64_tr_b16 v[156:157], v35 offset:16384
    ds_read_b64_tr_b16 v[158:159], v35 offset:20480
    s_waitcnt vmcnt(7)
    v_max_u32 v14, v112, v116
    v_cmp_eq_u32 vcc, -1, v14
    v_mfma_f32_32x32x16_bf16 v[40:55], v[136:139], v[108:111], v[40:55]
    ds_read_b64_tr_b16 v[152:153], v34 offset:16384
    ds_read_b64_tr_b16 v[154:155], v34 offset:20480
    s_cbranch_vccnz L_h_stub_73
L_h_ok_72:
    s_waitcnt lgkmcnt(4)
    v_mfma_f32_32x32x16_bf16 v[56:71], v[148:151], v[112:115], v[56:71]
    v_add_u32 v32, s11, v11
    v_xor_b32 v33, 64, v32
    ds_read_b64_tr_b16 v[132:133], v33 offset:0
    ds_read_b64_tr_b16 v[134:135], v33 offset:4096
    v_mfma_f32_32x32x16_bf16 v[40:55], v[144:147], v[112:115], v[40:55]
    ds_read_b64_tr_b16 v[128:129], v32 offset:0
    ds_read_b64_tr_b16 v[130:131], v32 offset:4096
    s_waitcnt lgkmcnt(4)
    v_mfma_f32_32x32x16_bf16 v[56:71], v[156:159], v[116:119], v[56:71]
    ds_read_b64_tr_b16 v[140:141], v33 offset:8192
    ds_read_b64_tr_b16 v[142:143], v33 offset:12288
    s_waitcnt vmcnt(5)
    v_max_u32 v14, v120, v124
    v_cmp_eq_u32 vcc, -1, v14
    v_mfma_f32_32x32x16_bf16 v[40:55], v[152:155], v[116:119], v[40:55]
    ds_read_b64_tr_b16 v[136:137], v32 offset:8192
    ds_read_b64_tr_b16 v[138:139], v32 offset:12288
    s_cbranch_vccnz L_h_stub_75
L_h_ok_74:
    s_waitcnt lgkmcnt(0)
    s_barrier
    v_mfma_f32_32x32x16_bf16 v[56:71], v[132:135], v[120:123], v[56:71]
    ds_read_b64_tr_b16 v[148:149], v33 offset:16384
    ds_read_b64_tr_b16 v[150:151], v33 offset:20480
    s_cmp_gt_u32 s82, 19
    s_cselect_b32 s75, s79, s83
    s_add_u32 s75, s75, 19456
    buffer_load_dwordx4 v[180:183], v1, s[44:47], s75 offen sc1
    v_mfma_f32_32x32x16_bf16 v[40:55], v[128:131], v[120:123], v[40:55]
    ds_read_b64_tr_b16 v[144:145], v32 offset:16384
    ds_read_b64_tr_b16 v[146:147], v32 offset:20480
    s_cmp_gt_u32 s82, 20
    s_cselect_b32 s75, s79, s83
    s_add_u32 s75, s75, 20480
    buffer_load_dwordx4 v[184:187], v1, s[44:47], s75 offen sc1
    v_mfma_f32_32x32x16_bf16 v[56:71], v[140:143], v[124:127], v[56:71]
    s_add_u32 s68, s11, 49152
    v_add_u32 v34, s68, v11
    v_xor_b32 v35, 64, v34
    ds_read_b64_tr_b16 v[156:157], v35 offset:0
    ds_read_b64_tr_b16 v[158:159], v35 offset:4096
    s_cmp_gt_u32 s82, 21
    s_cselect_b32 s75, s79, s83
    s_add_u32 s75, s75, 21504
    s_cmp_lt_u32 s55, 2
    s_cselect_b32 s75, s75, 1073741824
    buffer_load_dwordx4 v[188:191], v1, s[44:47], s75 offen sc1
    s_waitcnt vmcnt(6)
    v_max_u32 v14, v160, v164
    v_cmp_eq_u32 vcc, -1, v14
    v_mfma_f32_32x32x16_bf16 v[40:55], v[136:139], v[124:127], v[40:55]
    ds_read_b64_tr_b16 v[152:153], v34 offset:0
    ds_read_b64_tr_b16 v[154:155], v34 offset:4096
    s_cbranch_vccnz L_h_stub_77
L_h_ok_76:
    s_waitcnt lgkmcnt(4)
    v_mfma_f32_32x32x16_bf16 v[56:71], v[148:151], v[160:163], v[56:71]
    ds_read_b64_tr_b16 v[132:133], v35 offset:8192
    ds_read_b64_tr_b16 v[134:135], v35 offset:12288
    v_mfma_f32_32x32x16_bf16 v[40:55], v[144:147], v[160:163], v[40:55]
    ds_read_b64_tr_b16 v[128:129], v34 offset:8192
    ds_read_b64_tr_b16 v[130:131], v34 offset:12288
    s_waitcnt lgkmcnt(4)
    v_mfma_f32_32x32x16_bf16 v[56:71], v[156:159], v[164:167], v[56:71]
    ds_read_b64_tr_b16 v[140:141], v35 offset:16384
    ds_read_b64_tr_b16 v[142:143], v35 offset:20480
    s_waitcnt vmcnt(4)
    v_max_u32 v14, v168, v172
    v_cmp_eq_u32 vcc, -1, v14
    v_mfma_f32_32x32x16_bf16 v[40:55], v[152:155], v[164:167], v[40:55]
    ds_read_b64_tr_b16 v[136:137], v34 offset:16384
    ds_read_b64_tr_b16 v[138:139], v34 offset:20480
    s_cbranch_vccnz L_h_stub_79
L_h_ok_78:
    s_waitcnt lgkmcnt(4)
    v_mfma_f32_32x32x16_bf16 v[56:71], v[132:135], v[168:171], v[56:71]
    v_add_u32 v32, 98304, v11
    v_xor_b32 v33, 64, v32
    ds_read_b64_tr_b16 v[148:149], v33 offset:0
    ds_read_b64_tr_b16 v[150:151], v33 offset:4096
    v_mfma_f32_32x32x16_bf16 v[40:55], v[128:131], v[168:171], v[40:55]
    ds_read_b64_tr_b16 v[144:145], v32 offset:0
    ds_read_b64_tr_b16 v[146:147], v32 offset:4096
    s_waitcnt lgkmcnt(4)
    v_mfma_f32_32x32x16_bf16 v[56:71], v[140:143], v[172:175], v[56:71]
    ds_read_b64_tr_b16 v[156:157], v33 offset:8192
    ds_read_b64_tr_b16 v[158:159], v33 offset:12288
    s_waitcnt vmcnt(2)
    v_max_u32 v14, v176, v180
    v_cmp_eq_u32 vcc, -1, v14
    v_mfma_f32_32x32x16_bf16 v[40:55], v[136:139], v[172:175], v[40:55]
    ds_read_b64_tr_b16 v[152:153], v32 offset:8192
    ds_read_b64_tr_b16 v[154:155], v32 offset:12288
    s_cbranch_vccnz L_h_stub_81
L_h_ok_80:
    s_waitcnt lgkmcnt(4)
    v_mfma_f32_32x32x16_bf16 v[56:71], v[148:151], v[176:179], v[56:71]
    ds_read_b64_tr_b16 v[132:133], v33 offset:16384
    ds_read_b64_tr_b16 v[134:135], v33 offset:20480
    v_mfma_f32_32x32x16_bf16 v[40:55], v[144:147], v[176:179], v[40:55]
    ds_read_b64_tr_b16 v[128:129], v32 offset:16384
    ds_read_b64_tr_b16 v[130:131], v32 offset:20480
    s_waitcnt lgkmcnt(4)
    v_mfma_f32_32x32x16_bf16 v[56:71], v[156:159], v[180:183], v[56:71]
    ds_read_b64_tr_b16 v[140:141], v33 offset:24576
    ds_read_b64_tr_b16 v[142:143], v33 offset:28672
    s_waitcnt vmcnt(0)
    v_max_u32 v14, v184, v188
    v_cmp_eq_u32 vcc, -1, v14
    v_mfma_f32_32x32x16_bf16 v[40:55], v[152:155], v[180:183], v[40:55]
    ds_read_b64_tr_b16 v[136:137], v32 offset:24576
    ds_read_b64_tr_b16 v[138:139], v32 offset:28672
    s_cbranch_vccnz L_h_stub_83
L_h_ok_82:
    s_waitcnt lgkmcnt(4)
    v_mfma_f32_32x32x16_bf16 v[56:71], v[132:135], v[184:187], v[56:71]
    v_mfma_f32_32x32x16_bf16 v[40:55], v[128:131], v[184:187], v[40:55]
    s_waitcnt lgkmcnt(0)
    v_mfma_f32_32x32x16_bf16 v[56:71], v[140:143], v[188:191], v[56:71]
    v_mfma_f32_32x32x16_bf16 v[40:55], v[136:139], v[188:191], v[40:55]
    s_setprio 2
    v_xor_b32 v13, 1024, v12
    v_xor_b32 v14, 2048, v12
    v_xor_b32 v15, 3072, v12
    s_nop 6
    ds_write_b128 v12, v[56:59] offset:8192
    ds_write_b128 v12, v[60:63] offset:12288
    ds_write_b128 v12, v[64:67] offset:16384
    ds_write_b128 v12, v[68:71] offset:20480
    ds_write_b128 v12, v[48:51] offset:0
    ds_write_b128 v12, v[52:55] offset:4096
    s_waitcnt lgkmcnt(0)
    s_barrier
    ds_read_b128 v[72:75], v13 offset:0
    ds_read_b128 v[80:83], v14 offset:8192
    ds_read_b128 v[88:91], v15 offset:16384
    ds_read_b128 v[76:79], v13 offset:4096
    ds_read_b128 v[84:87], v14 offset:12288
    ds_read_b128 v[92:95], v15 offset:20480
    s_waitcnt lgkmcnt(5)
    v_add_f32 v40, v40, v72
    v_add_f32 v41, v41, v73
    v_add_f32 v42, v42, v74
    v_add_f32 v43, v43, v75
    s_waitcnt lgkmcnt(3)
    v_add_f32 v80, v80, v88
    v_add_f32 v81, v81, v89
    v_add_f32 v82, v82, v90
    v_add_f32 v83, v83, v91
    v_add_f32 v40, v40, v80
    v_add_f32 v41, v41, v81
    v_add_f32 v42, v42, v82
    v_add_f32 v43, v43, v83
    s_waitcnt lgkmcnt(2)
    v_add_f32 v44, v44, v76
    v_add_f32 v45, v45, v77
    v_add_f32 v46, v46, v78
    v_add_f32 v47, v47, v79
    s_waitcnt lgkmcnt(0)
    v_add_f32 v84, v84, v92
    v_add_f32 v85, v85, v93
    v_add_f32 v86, v86, v94
    v_add_f32 v87, v87, v95
    v_add_f32 v44, v44, v84
    v_add_f32 v45, v45, v85
    v_add_f32 v46, v46, v86
    v_add_f32 v47, v47, v87
    v_fma_f32 v16, v40, v24, v16
    v_fma_f32 v17, v41, v25, v17
    v_fma_f32 v18, v42, v26, v18
    v_fma_f32 v19, v43, v27, v19
    v_fma_f32 v20, v44, v28, v20
    v_fma_f32 v21, v45, v29, v21
    v_fma_f32 v22, v46, v30, v22
    v_fma_f32 v23, v47, v31, v23
    v_cvt_pk_bf16_f32 v16, v16, v17
    v_cvt_pk_bf16_f32 v17, v18, v19
    v_cvt_pk_bf16_f32 v18, v20, v21
    v_cvt_pk_bf16_f32 v19, v22, v23
    s_nop 0
    v_permlane32_swap_b32 v16, v18
    v_permlane32_swap_b32 v17, v19
    s_barrier
    buffer_store_dwordx4 v[16:19], v4, s[40:43], 0 offen
    s_branch L_fin
L_o_late:
    s_and_b32 s68, s55, 1
    s_lshl_b32 s69, s68, 4
    s_lshr_b32 s71, s55, 1
    v_xor_b32 v36, s69, v0
    v_lshrrev_b32 v36, 2, v36
    v_mul_u32_u24 v36, 96, v36
    s_mul_i32 s70, s68, 49152
    s_mul_i32 s72, s71, 24576
    s_add_u32 s70, s70, s72
    v_and_b32 v37, 3, v0
    v_lshl_add_u32 v37, v37, 3, s70
    v_add_u32 v36, v36, v37
    v_and_b32 v37, 48, v0
    v_and_b32 v38, 1, v0
    v_xor_b32 v38, 1, v38
    v_lshl_add_u32 v37, v38, 10, v37
    s_lshl_b32 s72, s71, 9
    s_add_u32 s72, s72, 156672
    v_add_u32 v37, s72, v37
    v_and_b32 v38, 16, v0
    v_and_b32 v39, 15, v0
    v_lshl_add_u32 v39, v38, 1, v39
    v_add_u32 v39, s69, v39
    s_lshl_b32 s70, s71, 2
    s_add_u32 s70, s70, 158720
    v_lshl_add_u32 v39, v39, 3, s70
    s_waitcnt vmcnt(0) lgkmcnt(0)
    s_barrier
    ds_read_b64_tr_b16 v[44:45], v36 offset:0
    ds_read_b64_tr_b16 v[46:47], v36 offset:1536
    ds_read_b64_tr_b16 v[48:49], v36 offset:32
    ds_read_b64_tr_b16 v[50:51], v36 offset:1568
    ds_read_b64_tr_b16 v[52:53], v36 offset:64
    ds_read_b64_tr_b16 v[54:55], v36 offset:1600
    ds_read_b128 v[40:43], v37 offset:0
    ds_read_b64_tr_b16 v[60:61], v36 offset:3072
    ds_read_b64_tr_b16 v[62:63], v36 offset:4608
    ds_read_b64_tr_b16 v[64:65], v36 offset:3104
    ds_read_b64_tr_b16 v[66:67], v36 offset:4640
    ds_read_b64_tr_b16 v[68:69], v36 offset:3136
    ds_read_b64_tr_b16 v[70:71], v36 offset:4672
    ds_read_b128 v[56:59], v37 offset:64
    v_cmp_ne_u32 vcc, 0, v38
    s_waitcnt lgkmcnt(7)
    v_mfma_f32_16x16x32_bf16 v[72:75], v[40:43], v[44:47], 0
    ds_read_b64_tr_b16 v[44:45], v36 offset:6144
    ds_read_b64_tr_b16 v[46:47], v36 offset:7680
    v_mfma_f32_16x16x32_bf16 v[76:79], v[40:43], v[48:51], 0
    ds_read_b64_tr_b16 v[48:49], v36 offset:6176
    ds_read_b64_tr_b16 v[50:51], v36 offset:7712
    v_mfma_f32_16x16x32_bf16 v[80:83], v[40:43], v[52:55], 0
    ds_read_b64_tr_b16 v[52:53], v36 offset:6208
    ds_read_b64_tr_b16 v[54:55], v36 offset:7744
    ds_read_b128 v[40:43], v37 offset:128
    s_waitcnt lgkmcnt(7)
    v_mfma_f32_16x16x32_bf16 v[72:75], v[56:59], v[60:63], v[72:75]
    ds_read_b64_tr_b16 v[60:61], v36 offset:9216
    ds_read_b64_tr_b16 v[62:63], v36 offset:10752
    v_mfma_f32_16x16x32_bf16 v[76:79], v[56:59], v[64:67], v[76:79]
    ds_read_b64_tr_b16 v[64:65], v36 offset:9248
    ds_read_b64_tr_b16 v[66:67], v36 offset:10784
    v_mfma_f32_16x16x32_bf16 v[80:83], v[56:59], v[68:71], v[80:83]
    ds_read_b64_tr_b16 v[68:69], v36 offset:9280
    ds_read_b64_tr_b16 v[70:71], v36 offset:10816
    ds_read_b128 v[56:59], v37 offset:192
    s_waitcnt lgkmcnt(7)
    v_mfma_f32_16x16x32_bf16 v[72:75], v[40:43], v[44:47], v[72:75]
    ds_read_b64_tr_b16 v[44:45], v36 offset:12288
    ds_read_b64_tr_b16 v[46:47], v36 offset:13824
    v_mfma_f32_16x16x32_bf16 v[76:79], v[40:43], v[48:51], v[76:79]
    ds_read_b64_tr_b16 v[48:49], v36 offset:12320
    ds_read_b64_tr_b16 v[50:51], v36 offset:13856
    v_mfma_f32_16x16x32_bf16 v[80:83], v[40:43], v[52:55], v[80:83]
    ds_read_b64_tr_b16 v[52:53], v36 offset:12352
    ds_read_b64_tr_b16 v[54:55], v36 offset:13888
    ds_read_b128 v[40:43], v37 offset:256
    s_waitcnt lgkmcnt(7)
    v_mfma_f32_16x16x32_bf16 v[72:75], v[56:59], v[60:63], v[72:75]
    ds_read_b64_tr_b16 v[60:61], v36 offset:15360
    ds_read_b64_tr_b16 v[62:63], v36 offset:16896
    v_mfma_f32_16x16x32_bf16 v[76:79], v[56:59], v[64:67], v[76:79]
    ds_read_b64_tr_b16 v[64:65], v36 offset:15392
    ds_read_b64_tr_b16 v[66:67], v36 offset:16928
    v_mfma_f32_16x16x32_bf16 v[80:83], v[56:59], v[68:71], v[80:83]
    ds_read_b64_tr_b16 v[68:69], v36 offset:15424
    ds_read_b64_tr_b16 v[70:71], v36 offset:16960
    ds_read_b128 v[56:59], v37 offset:320
    s_waitcnt lgkmcnt(7)
    v_mfma_f32_16x16x32_bf16 v[72:75], v[40:43], v[44:47], v[72:75]
    ds_read_b64_tr_b16 v[44:45], v36 offset:18432
    ds_read_b64_tr_b16 v[46:47], v36 offset:19968
    v_mfma_f32_16x16x32_bf16 v[76:79], v[40:43], v[48:51], v[76:79]
    ds_read_b64_tr_b16 v[48:49], v36 offset:18464
    ds_read_b64_tr_b16 v[50:51], v36 offset:20000
    v_mfma_f32_16x16x32_bf16 v[80:83], v[40:43], v[52:55], v[80:83]
    ds_read_b64_tr_b16 v[52:53], v36 offset:18496
    ds_read_b64_tr_b16 v[54:55], v36 offset:20032
    ds_read_b128 v[40:43], v37 offset:384
    s_waitcnt lgkmcnt(7)
    v_mfma_f32_16x16x32_bf16 v[72:75], v[56:59], v[60:63], v[72:75]
    ds_read_b64_tr_b16 v[60:61], v36 offset:21504
    ds_read_b64_tr_b16 v[62:63], v36 offset:23040
    v_mfma_f32_16x16x32_bf16 v[76:79], v[56:59], v[64:67], v[76:79]
    ds_read_b64_tr_b16 v[64:65], v36 offset:21536
    ds_read_b64_tr_b16 v[66:67], v36 offset:23072
    v_mfma_f32_16x16x32_bf16 v[80:83], v[56:59], v[68:71], v[80:83]
    ds_read_b64_tr_b16 v[68:69], v36 offset:21568
    ds_read_b64_tr_b16 v[70:71], v36 offset:23104
    ds_read_b128 v[56:59], v37 offset:448
    s_waitcnt lgkmcnt(7)
    v_mfma_f32_16x16x32_bf16 v[72:75], v[40:43], v[44:47], v[72:75]
    v_mfma_f32_16x16x32_bf16 v[76:79], v[40:43], v[48:51], v[76:79]
    v_mfma_f32_16x16x32_bf16 v[80:83], v[40:43], v[52:55], v[80:83]
    s_waitcnt lgkmcnt(0)
    v_mfma_f32_16x16x32_bf16 v[72:75], v[56:59], v[60:63], v[72:75]
    v_mfma_f32_16x16x32_bf16 v[76:79], v[56:59], v[64:67], v[76:79]
    v_mfma_f32_16x16x32_bf16 v[80:83], v[56:59], v[68:71], v[80:83]
    s_nop 5
    v_cndmask_b32 v72, v72, v73, vcc
    ds_write_b32 v39, v72 offset:0
    v_cndmask_b32 v76, v76, v77, vcc
    ds_write_b32 v39, v76 offset:512
    v_cndmask_b32 v80, v80, v81, vcc
    ds_write_b32 v39, v80 offset:1024
    ds_read_b128 v[72:75], v2 offset:0
    ds_read_b128 v[76:79], v2 offset:32
    ds_read_b128 v[80:83], v2 offset:512
    ds_read_b128 v[84:87], v2 offset:544
    ds_read_b128 v[24:27], v2 offset:768
    ds_read_b128 v[28:31], v2 offset:800
    s_xor_b32 s75, s79, 0
    buffer_load_dwordx4 v[88:91], v1, s[44:47], s75 offen sc1
    s_xor_b32 s75, s79, 1024
    buffer_load_dwordx4 v[92:95], v1, s[44:47], s75 offen sc1
    s_xor_b32 s75, s79, 2048
    buffer_load_dwordx4 v[96:99], v1, s[44:47], s75 offen sc1
    s_xor_b32 s75, s79, 3072
    buffer_load_dwordx4 v[100:103], v1, s[44:47], s75 offen sc1
    s_xor_b32 s75, s79, 4096
    buffer_load_dwordx4 v[104:107], v1, s[44:47], s75 offen sc1
    s_waitcnt lgkmcnt(0)
    s_barrier
    s_xor_b32 s75, s79, 5120
    buffer_load_dwordx4 v[108:111], v1, s[44:47], s75 offen sc1
    s_xor_b32 s75, s79, 6144
    buffer_load_dwordx4 v[112:115], v1, s[44:47], s75 offen sc1
    s_xor_b32 s75, s79, 7168
    buffer_load_dwordx4 v[116:119], v1, s[44:47], s75 offen sc1
    s_waitcnt vmcnt(6)
    v_max_u32 v14, v88, v92
    v_cmp_eq_u32 vcc, -1, v14
    s_cbranch_vccnz L_o_stub_85
L_o_ok_84:
    v_mfma_f32_32x32x16_bf16 v[56:71], v[132:135], v[88:91], 0
    v_mfma_f32_32x32x16_bf16 v[40:55], v[128:131], v[88:91], 0
    v_mfma_f32_32x32x16_bf16 v[56:71], v[140:143], v[92:95], v[56:71]
    s_waitcnt vmcnt(4)
    v_max_u32 v14, v96, v100
    v_cmp_eq_u32 vcc, -1, v14
    v_mfma_f32_32x32x16_bf16 v[40:55], v[136:139], v[92:95], v[40:55]
    s_cbranch_vccnz L_o_stub_87
L_o_ok_86:
    v_mfma_f32_32x32x16_bf16 v[56:71], v[148:151], v[96:99], v[56:71]
    v_mfma_f32_32x32x16_bf16 v[40:55], v[144:147], v[96:99], v[40:55]
    v_mfma_f32_32x32x16_bf16 v[56:71], v[156:159], v[100:103], v[56:71]
    s_waitcnt vmcnt(2)
    v_max_u32 v14, v104, v108
    v_cmp_eq_u32 vcc, -1, v14
    v_mfma_f32_32x32x16_bf16 v[40:55], v[152:155], v[100:103], v[40:55]
    s_cbranch_vccnz L_o_stub_89
L_o_ok_88:
    v_mfma_f32_32x32x16_bf16 v[56:71], v[164:167], v[104:107], v[56:71]
    v_mfma_f32_32x32x16_bf16 v[40:55], v[160:163], v[104:107], v[40:55]
    s_cmp_gt_u32 s82, 2
    s_cselect_b32 s75, s80, s81
    s_add_u32 s75, s75, 32768
    s_add_u32 m0, s77, 110592
    s_nop 0
    buffer_load_dwordx4 v8, s[28:31], s75 offen  lds
    v_mfma_f32_32x32x16_bf16 v[56:71], v[172:175], v[108:111], v[56:71]
    s_waitcnt vmcnt(1)
    v_max_u32 v14, v112, v116
    v_cmp_eq_u32 vcc, -1, v14
    v_mfma_f32_32x32x16_bf16 v[40:55], v[168:171], v[108:111], v[40:55]
    s_cbranch_vccnz L_o_stub_91
L_o_ok_90:
    s_cmp_gt_u32 s82, 2
    s_cselect_b32 s75, s80, s81
    s_add_u32 s75, s75, 40960
    s_add_u32 m0, s77, 114688
    s_nop 0
    buffer_load_dwordx4 v8, s[28:31], s75 offen  lds
    v_mfma_f32_32x32x16_bf16 v[56:71], v[180:183], v[112:115], v[56:71]
    v_mfma_f32_32x32x16_bf16 v[40:55], v[176:179], v[112:115], v[40:55]
    s_cmp_gt_u32 s82, 3
    s_cselect_b32 s75, s80, s81
    s_add_u32 s75, s75, 49152
    s_add_u32 m0, s77, 118784
    s_nop 0
    buffer_load_dwordx4 v8, s[28:31], s75 offen  lds
    v_mfma_f32_32x32x16_bf16 v[56:71], v[188:191], v[116:119], v[56:71]
    v_mfma_f32_32x32x16_bf16 v[40:55], v[184:187], v[116:119], v[40:55]
    s_cmp_gt_u32 s82, 3
    s_cselect_b32 s75, s80, s81
    s_add_u32 s75, s75, 57344
    s_add_u32 m0, s77, 122880
    s_nop 0
    buffer_load_dwordx4 v8, s[28:31], s75 offen  lds
    s_barrier
    v_xor_b32 v13, 1024, v12
    v_xor_b32 v14, 2048, v12
    v_xor_b32 v15, 3072, v12
    s_nop 0
    ds_write_b128 v12, v[56:59] offset:8192
    ds_write_b128 v12, v[60:63] offset:12288
    ds_write_b128 v12, v[64:67] offset:16384
    ds_write_b128 v12, v[68:71] offset:20480
    ds_write_b128 v12, v[48:51] offset:0
    ds_write_b128 v12, v[52:55] offset:4096
    s_waitcnt lgkmcnt(0)
    s_barrier
    ds_read_b128 v[128:131], v13 offset:0
    ds_read_b128 v[136:139], v14 offset:8192
    ds_read_b128 v[144:147], v15 offset:16384
    ds_read_b128 v[132:135], v13 offset:4096
    ds_read_b128 v[140:143], v14 offset:12288
    ds_read_b128 v[148:151], v15 offset:20480
    s_waitcnt lgkmcnt(5)
    v_add_f32 v40, v40, v128
    v_add_f32 v41, v41, v129
    v_add_f32 v42, v42, v130
    v_add_f32 v43, v43, v131
    s_waitcnt lgkmcnt(3)
    v_add_f32 v136, v136, v144
    v_add_f32 v137, v137, v145
    v_add_f32 v138, v138, v146
    v_add_f32 v139, v139, v147
    v_add_f32 v40, v40, v136
    v_add_f32 v41, v41, v137
    v_add_f32 v42, v42, v138
    v_add_f32 v43, v43, v139
    s_waitcnt lgkmcnt(2)
    v_add_f32 v44, v44, v132
    v_add_f32 v45, v45, v133
    v_add_f32 v46, v46, v134
    v_add_f32 v47, v47, v135
    s_waitcnt lgkmcnt(0)
    v_add_f32 v140, v140, v148
    v_add_f32 v141, v141, v149
    v_add_f32 v142, v142, v150
    v_add_f32 v143, v143, v151
    v_add_f32 v44, v44, v140
    v_add_f32 v45, v45, v141
    v_add_f32 v46, v46, v142
    v_add_f32 v47, v47, v143
    v_fma_f32 v16, v40, v72, v16
    v_fma_f32 v17, v41, v73, v17
    v_fma_f32 v18, v42, v74, v18
    v_fma_f32 v19, v43, v75, v19
    v_fma_f32 v20, v44, v76, v20
    v_fma_f32 v21, v45, v77, v21
    v_fma_f32 v22, v46, v78, v22
    v_fma_f32 v23, v47, v79, v23
    v_mul_f32 v40, v16, v80
    v_mul_f32 v41, v17, v81
    v_mul_f32 v42, v18, v82
    v_mul_f32 v43, v19, v83
    v_mul_f32 v44, v20, v84
    v_mul_f32 v45, v21, v85
    v_mul_f32 v46, v22, v86
    v_mul_f32 v47, v23, v87
    v_cvt_pk_bf16_f32 v40, v40, v41
    v_cvt_pk_bf16_f32 v41, v42, v43
    v_cvt_pk_bf16_f32 v42, v44, v45
    v_cvt_pk_bf16_f32 v43, v46, v47
    buffer_store_dwordx4 v[40:43], v5, s[44:47], 0 offen sc1
    v_add_f32 v88, v16, v17
    v_mul_f32 v89, v16, v16
    v_fmac_f32 v89, v17, v17
    v_add_f32 v88, v88, v18
    v_fmac_f32 v89, v18, v18
    v_add_f32 v88, v88, v19
    v_fmac_f32 v89, v19, v19
    v_add_f32 v88, v88, v20
    v_fmac_f32 v89, v20, v20
    v_add_f32 v88, v88, v21
    v_fmac_f32 v89, v21, v21
    v_add_f32 v88, v88, v22
    v_fmac_f32 v89, v22, v22
    v_add_f32 v88, v88, v23
    v_fmac_f32 v89, v23, v23
    s_nop 1
    v_permlane32_swap_b32 v88, v89
    v_add_f32 v88, v88, v89
    ds_write_b32 v3, v88
    v_bfe_u32 v14, v0, 4, 1
    v_lshrrev_b32 v15, 5, v0
    v_xor_b32 v36, v14, v15
    v_bfe_u32 v124, v0, 2, 2
    v_lshl_add_u32 v124, v36, 2, v124
    v_lshl_add_u32 v124, v14, 9, v124
    v_mul_u32_u24 v124, 96, v124
    v_and_b32 v14, 3, v0
    v_lshl_add_u32 v124, v14, 3, v124
    s_lshl_b32 s68, s48, 2
    s_add_u32 s68, s68, s55
    s_lshl_b32 s68, s68, 1
    s_add_u32 s68, s68, s56
    s_lshl_b32 s73, s68, 11
    s_add_u32 s73, s73, 65536
    v_and_b32 v14, 31, v0
    v_lshlrev_b32 v14, 3, v14
    v_lshl_add_u32 v126, v15, 10, v14
    s_lshl_b32 s74, s68, 15
    s_add_u32 s74, s74, 4194304
    s_mov_b32 s9, s54
    s_lshl_b32 s68, s9, 12
    s_add_u32 s8, s74, s68
    s_lshr_b32 s68, s9, 2
    s_mul_i32 s10, s68, 24576
    s_sub_u32 s11, 24576, s10
    v_lshlrev_b32 v127, 3, v0
    v_add_u32 v127, 158720, v127
    v_add_u32 v120, 98304, v11
    v_xor_b32 v121, 64, v120
    ds_read_b64 v[40:41], v127 offset:0
    ds_read_b64 v[42:43], v127 offset:512
    ds_read_b64 v[44:45], v127 offset:1024
    s_xor_b32 s68, s9, 0
    s_mul_i32 s68, s68, 6144
    v_add_u32 v122, s68, v124
    ds_read_b64_tr_b16 v[88:89], v122 offset:0
    ds_read_b64_tr_b16 v[90:91], v122 offset:768
    ds_read_b64_tr_b16 v[92:93], v122 offset:32
    ds_read_b64_tr_b16 v[94:95], v122 offset:800
    ds_read_b64_tr_b16 v[96:97], v122 offset:64
    ds_read_b64_tr_b16 v[98:99], v122 offset:832
    ds_read_b64_tr_b16 v[100:101], v122 offset:1536
    ds_read_b64_tr_b16 v[102:103], v122 offset:2304
    ds_read_b64_tr_b16 v[104:105], v122 offset:1568
    ds_read_b64_tr_b16 v[106:107], v122 offset:2336
    ds_read_b64_tr_b16 v[108:109], v122 offset:1600
    ds_read_b64_tr_b16 v[110:111], v122 offset:2368
    s_waitcnt lgkmcnt(12)
    v_add_f32 v40, v40, v41
    v_cvt_pk_bf16_f32 v113, v40, 0
    v_lshlrev_b32 v41, 16, v113
    v_sub_f32 v41, v40, v41
    v_cvt_pk_bf16_f32 v112, v40, v41
    v_add_f32 v42, v42, v43
    v_cvt_pk_bf16_f32 v115, v42, 0
    v_lshlrev_b32 v43, 16, v115
    v_sub_f32 v43, v42, v43
    v_cvt_pk_bf16_f32 v114, v42, v43
    v_add_f32 v44, v44, v45
    v_cvt_pk_bf16_f32 v117, v44, 0
    v_lshlrev_b32 v45, 16, v117
    v_sub_f32 v45, v44, v45
    v_cvt_pk_bf16_f32 v116, v44, v45
    s_waitcnt vmcnt(0)
    s_barrier
    s_cmp_ge_u32 s49, 29
    s_cbranch_scc1 L_g_skipl
    s_cmp_lg_u32 s55, 3
    s_cbranch_scc1 L_nost_92
    s_lshl_b32 s68, s56, 10
    s_add_u32 s68, s68, 160256
    v_lshl_add_u32 v14, v0, 2, s68
    ds_read2st64_b32 v[32:33], v14 offset0:0 offset1:1
    ds_read2st64_b32 v[34:35], v14 offset0:2 offset1:3
    s_waitcnt lgkmcnt(0)
    v_add_f32 v32, v32, v34
    v_add_f32 v33, v33, v35
    v_add_f32 v32, v32, v33
    buffer_store_dword v32, v7, s[44:47], 0 offen sc1
L_nost_92:
    s_xor_b32 s75, s8, 0
    buffer_load_dwordx4 v[128:131], v1, s[44:47], s75 offen offset:0 sc1
    s_xor_b32 s75, s8, 0
    buffer_load_dwordx4 v[132:135], v1, s[44:47], s75 offen offset:1024 sc1
    s_xor_b32 s75, s8, 0
    buffer_load_dwordx4 v[136:139], v1, s[44:47], s75 offen offset:2048 sc1
    s_xor_b32 s75, s8, 0
    buffer_load_dwordx4 v[140:143], v1, s[44:47], s75 offen offset:3072 sc1
    s_xor_b32 s75, s8, 4096
    buffer_load_dwordx4 v[144:147], v1, s[44:47], s75 offen offset:0 sc1
    s_xor_b32 s75, s8, 4096
    buffer_load_dwordx4 v[148:151], v1, s[44:47], s75 offen offset:1024 sc1
    s_xor_b32 s75, s8, 4096
    buffer_load_dwordx4 v[152:155], v1, s[44:47], s75 offen offset:2048 sc1
    s_xor_b32 s75, s8, 4096
    buffer_load_dwordx4 v[156:159], v1, s[44:47], s75 offen offset:3072 sc1
    s_xor_b32 s75, s8, 8192
    buffer_load_dwordx4 v[160:163], v1, s[44:47], s75 offen offset:0 sc1
    s_xor_b32 s75, s8, 8192
    buffer_load_dwordx4 v[164:167], v1, s[44:47], s75 offen offset:1024 sc1
    s_xor_b32 s75, s8, 8192
    buffer_load_dwordx4 v[168:171], v1, s[44:47], s75 offen offset:2048 sc1
    s_xor_b32 s75, s8, 8192
    buffer_load_dwordx4 v[172:175], v1, s[44:47], s75 offen offset:3072 sc1
    s_setprio 1
    s_waitcnt vmcnt(8)
    v_max3_u32 v14, v128, v132, v136
    v_max_u32 v14, v14, v140
    v_cmp_eq_u32 vcc, -1, v14
    s_cbranch_vccnz L_y_stub_94
L_y_ok_93:
    s_waitcnt lgkmcnt(6)
    v_mfma_f32_32x32x16_bf16 v[40:55], v[88:91], v[128:131], 0
    ds_read_b64_tr_b16 v[88:89], v122 offset:3072
    ds_read_b64_tr_b16 v[90:91], v122 offset:3840
    s_xor_b32 s75, s8, 12288
    buffer_load_dwordx4 v[176:179], v1, s[44:47], s75 offen offset:0 sc1
    v_mfma_f32_32x32x16_bf16 v[56:71], v[92:95], v[128:131], 0
    ds_read_b64_tr_b16 v[92:93], v122 offset:3104
    ds_read_b64_tr_b16 v[94:95], v122 offset:3872
    s_xor_b32 s68, s9, 1
    s_mul_i32 s68, s68, 6144
    v_add_u32 v123, s68, v124
    v_mfma_f32_32x32x16_bf16 v[72:87], v[96:99], v[128:131], 0
    ds_read_b64_tr_b16 v[96:97], v122 offset:3136
    ds_read_b64_tr_b16 v[98:99], v122 offset:3904
    s_waitcnt lgkmcnt(6)
    v_mfma_f32_32x32x16_bf16 v[40:55], v[100:103], v[132:135], v[40:55]
    ds_read_b64_tr_b16 v[100:101], v122 offset:4608
    ds_read_b64_tr_b16 v[102:103], v122 offset:5376
    s_xor_b32 s75, s8, 12288
    buffer_load_dwordx4 v[180:183], v1, s[44:47], s75 offen offset:1024 sc1
    v_mfma_f32_32x32x16_bf16 v[56:71], v[104:107], v[132:135], v[56:71]
    ds_read_b64_tr_b16 v[104:105], v122 offset:4640
    ds_read_b64_tr_b16 v[106:107], v122 offset:5408
    v_mfma_f32_32x32x16_bf16 v[72:87], v[108:111], v[132:135], v[72:87]
    ds_read_b64_tr_b16 v[108:109], v122 offset:4672
    ds_read_b64_tr_b16 v[110:111], v122 offset:5440
    s_waitcnt lgkmcnt(6)
    v_mfma_f32_32x32x16_bf16 v[40:55], v[88:91], v[136:139], v[40:55]
    ds_read_b64_tr_b16 v[88:89], v123 offset:0
    ds_read_b64_tr_b16 v[90:91], v123 offset:768
    s_xor_b32 s75, s8, 12288
    buffer_load_dwordx4 v[184:187], v1, s[44:47], s75 offen offset:2048 sc1
    v_mfma_f32_32x32x16_bf16 v[56:71], v[92:95], v[136:139], v[56:71]
    ds_read_b64_tr_b16 v[92:93], v123 offset:32
    ds_read_b64_tr_b16 v[94:95], v123 offset:800
    v_mfma_f32_32x32x16_bf16 v[72:87], v[96:99], v[136:139], v[72:87]
    ds_read_b64_tr_b16 v[96:97], v123 offset:64
    ds_read_b64_tr_b16 v[98:99], v123 offset:832
    s_waitcnt lgkmcnt(6)
    v_mfma_f32_32x32x16_bf16 v[40:55], v[100:103], v[140:143], v[40:55]
    ds_read_b64_tr_b16 v[100:101], v123 offset:1536
    ds_read_b64_tr_b16 v[102:103], v123 offset:2304
    s_xor_b32 s75, s8, 12288
    buffer_load_dwordx4 v[188:191], v1, s[44:47], s75 offen offset:3072 sc1
    v_mfma_f32_32x32x16_bf16 v[56:71], v[104:107], v[140:143], v[56:71]
    ds_read_b64_tr_b16 v[104:105], v123 offset:1568
    ds_read_b64_tr_b16 v[106:107], v123 offset:2336
    s_waitcnt vmcnt(8)
    v_max3_u32 v14, v144, v148, v152
    v_max_u32 v14, v14, v156
    v_cmp_eq_u32 vcc, -1, v14
    v_mfma_f32_32x32x16_bf16 v[72:87], v[108:111], v[140:143], v[72:87]
    ds_read_b64_tr_b16 v[108:109], v123 offset:1600
    ds_read_b64_tr_b16 v[110:111], v123 offset:2368
    s_cbranch_vccnz L_y_stub_96
L_y_ok_95:
    s_waitcnt lgkmcnt(6)
    v_mfma_f32_32x32x16_bf16 v[40:55], v[88:91], v[144:147], v[40:55]
    ds_read_b64_tr_b16 v[88:89], v123 offset:3072
    ds_read_b64_tr_b16 v[90:91], v123 offset:3840
    s_xor_b32 s75, s8, 16384
    buffer_load_dwordx4 v[128:131], v1, s[44:47], s75 offen offset:0 sc1
    v_mfma_f32_32x32x16_bf16 v[56:71], v[92:95], v[144:147], v[56:71]
    ds_read_b64_tr_b16 v[92:93], v123 offset:3104
    ds_read_b64_tr_b16 v[94:95], v123 offset:3872
    s_xor_b32 s68, s9, 2
    s_mul_i32 s68, s68, 6144
    v_add_u32 v122, s68, v124
    v_mfma_f32_32x32x16_bf16 v[72:87], v[96:99], v[144:147], v[72:87]
    ds_read_b64_tr_b16 v[96:97], v123 offset:3136
    ds_read_b64_tr_b16 v[98:99], v123 offset:3904
    s_waitcnt lgkmcnt(6)
    v_mfma_f32_32x32x16_bf16 v[40:55], v[100:103], v[148:151], v[40:55]
    ds_read_b64_tr_b16 v[100:101], v123 offset:4608
    ds_read_b64_tr_b16 v[102:103], v123 offset:5376
    s_xor_b32 s75, s8, 16384
    buffer_load_dwordx4 v[132:135], v1, s[44:47], s75 offen offset:1024 sc1
    v_mfma_f32_32x32x16_bf16 v[56:71], v[104:107], v[148:151], v[56:71]
    ds_read_b64_tr_b16 v[104:105], v123 offset:4640
    ds_read_b64_tr_b16 v[106:107], v123 offset:5408
    v_mfma_f32_32x32x16_bf16 v[72:87], v[108:111], v[148:151], v[72:87]
    ds_read_b64_tr_b16 v[108:109], v123 offset:4672
    ds_read_b64_tr_b16 v[110:111], v123 offset:5440
    s_waitcnt lgkmcnt(6)
    v_mfma_f32_32x32x16_bf16 v[40:55], v[88:91], v[152:155], v[40:55]
    ds_read_b64_tr_b16 v[88:89], v122 offset:0
    ds_read_b64_tr_b16 v[90:91], v122 offset:768
    s_xor_b32 s75, s8, 16384
    buffer_load_dwordx4 v[136:139], v1, s[44:47], s75 offen offset:2048 sc1
    v_mfma_f32_32x32x16_bf16 v[56:71], v[92:95], v[152:155], v[56:71]
    ds_read_b64_tr_b16 v[92:93], v122 offset:32
    ds_read_b64_tr_b16 v[94:95], v122 offset:800
    v_mfma_f32_32x32x16_bf16 v[72:87], v[96:99], v[152:155], v[72:87]
    ds_read_b64_tr_b16 v[96:97], v122 offset:64
    ds_read_b64_tr_b16 v[98:99], v122 offset:832
    s_waitcnt lgkmcnt(6)
    v_mfma_f32_32x32x16_bf16 v[40:55], v[100:103], v[156:159], v[40:55]
    ds_read_b64_tr_b16 v[100:101], v122 offset:1536
    ds_read_b64_tr_b16 v[102:103], v122 offset:2304
    s_xor_b32 s75, s8, 16384
    buffer_load_dwordx4 v[140:143], v1, s[44:47], s75 offen offset:3072 sc1
    v_mfma_f32_32x32x16_bf16 v[56:71], v[104:107], v[156:159], v[56:71]
    ds_read_b64_tr_b16 v[104:105], v122 offset:1568
    ds_read_b64_tr_b16 v[106:107], v122 offset:2336
    s_waitcnt vmcnt(8)
    v_max3_u32 v14, v160, v164, v168
    v_max_u32 v14, v14, v172
    v_cmp_eq_u32 vcc, -1, v14
    v_mfma_f32_32x32x16_bf16 v[72:87], v[108:111], v[156:159], v[72:87]
    ds_read_b64_tr_b16 v[108:109], v122 offset:1600
    ds_read_b64_tr_b16 v[110:111], v122 offset:2368
    s_cbranch_vccnz L_y_stub_98
L_y_ok_97:
    s_waitcnt lgkmcnt(6)
    v_mfma_f32_32x32x16_bf16 v[40:55], v[88:91], v[160:163], v[40:55]
    ds_read_b64_tr_b16 v[88:89], v122 offset:3072
    ds_read_b64_tr_b16 v[90:91], v122 offset:3840
    s_xor_b32 s75, s8, 20480
    buffer_load_dwordx4 v[144:147], v1, s[44:47], s75 offen offset:0 sc1
    v_mfma_f32_32x32x16_bf16 v[56:71], v[92:95], v[160:163], v[56:71]
    ds_read_b64_tr_b16 v[92:93], v122 offset:3104
    ds_read_b64_tr_b16 v[94:95], v122 offset:3872
    s_xor_b32 s68, s9, 3
    s_mul_i32 s68, s68, 6144
    v_add_u32 v123, s68, v124
    v_mfma_f32_32x32x16_bf16 v[72:87], v[96:99], v[160:163], v[72:87]
    ds_read_b64_tr_b16 v[96:97], v122 offset:3136
    ds_read_b64_tr_b16 v[98:99], v122 offset:3904
    s_waitcnt lgkmcnt(6)
    v_mfma_f32_32x32x16_bf16 v[40:55], v[100:103], v[164:167], v[40:55]
    ds_read_b64_tr_b16 v[100:101], v122 offset:4608
    ds_read_b64_tr_b16 v[102:103], v122 offset:5376
    s_xor_b32 s75, s8, 20480
    buffer_load_dwordx4 v[148:151], v1, s[44:47], s75 offen offset:1024 sc1
    v_mfma_f32_32x32x16_bf16 v[56:71], v[104:107], v[164:167], v[56:71]
    ds_read_b64_tr_b16 v[104:105], v122 offset:4640
    ds_read_b64_tr_b16 v[106:107], v122 offset:5408
    v_mfma_f32_32x32x16_bf16 v[72:87], v[108:111], v[164:167], v[72:87]
    ds_read_b64_tr_b16 v[108:109], v122 offset:4672
    ds_read_b64_tr_b16 v[110:111], v122 offset:5440
    s_waitcnt lgkmcnt(6)
    v_mfma_f32_32x32x16_bf16 v[40:55], v[88:91], v[168:171], v[40:55]
    ds_read_b64_tr_b16 v[88:89], v123 offset:0
    ds_read_b64_tr_b16 v[90:91], v123 offset:768
    s_xor_b32 s75, s8, 20480
    buffer_load_dwordx4 v[152:155], v1, s[44:47], s75 offen offset:2048 sc1
    v_mfma_f32_32x32x16_bf16 v[56:71], v[92:95], v[168:171], v[56:71]
    ds_read_b64_tr_b16 v[92:93], v123 offset:32
    ds_read_b64_tr_b16 v[94:95], v123 offset:800
    v_mfma_f32_32x32x16_bf16 v[72:87], v[96:99], v[168:171], v[72:87]
    ds_read_b64_tr_b16 v[96:97], v123 offset:64
    ds_read_b64_tr_b16 v[98:99], v123 offset:832
    s_waitcnt lgkmcnt(6)
    v_mfma_f32_32x32x16_bf16 v[40:55], v[100:103], v[172:175], v[40:55]
    ds_read_b64_tr_b16 v[100:101], v123 offset:1536
    ds_read_b64_tr_b16 v[102:103], v123 offset:2304
    s_xor_b32 s75, s8, 20480
    buffer_load_dwordx4 v[156:159], v1, s[44:47], s75 offen offset:3072 sc1
    v_mfma_f32_32x32x16_bf16 v[56:71], v[104:107], v[172:175], v[56:71]
    ds_read_b64_tr_b16 v[104:105], v123 offset:1568
    ds_read_b64_tr_b16 v[106:107], v123 offset:2336
    s_waitcnt vmcnt(8)
    v_max3_u32 v14, v176, v180, v184
    v_max_u32 v14, v14, v188
    v_cmp_eq_u32 vcc, -1, v14
    v_mfma_f32_32x32x16_bf16 v[72:87], v[108:111], v[172:175], v[72:87]
    ds_read_b64_tr_b16 v[108:109], v123 offset:1600
    ds_read_b64_tr_b16 v[110:111], v123 offset:2368
    s_cbranch_vccnz L_y_stub_100
L_y_ok_99:
    s_waitcnt lgkmcnt(6)
    v_mfma_f32_32x32x16_bf16 v[40:55], v[88:91], v[176:179], v[40:55]
    ds_read_b64_tr_b16 v[88:89], v123 offset:3072
    ds_read_b64_tr_b16 v[90:91], v123 offset:3840
    s_xor_b32 s75, s8, 24576
    buffer_load_dwordx4 v[160:163], v1, s[44:47], s75 offen offset:0 sc1
    v_mfma_f32_32x32x16_bf16 v[56:71], v[92:95], v[176:179], v[56:71]
    ds_read_b64_tr_b16 v[92:93], v123 offset:3104
    ds_read_b64_tr_b16 v[94:95], v123 offset:3872
    s_xor_b32 s68, s9, 4
    s_mul_i32 s68, s68, 6144
    v_add_u32 v122, s68, v124
    v_mfma_f32_32x32x16_bf16 v[72:87], v[96:99], v[176:179], v[72:87]
    ds_read_b64_tr_b16 v[96:97], v123 offset:3136
    ds_read_b64_tr_b16 v[98:99], v123 offset:3904
    s_waitcnt lgkmcnt(6)
    v_mfma_f32_32x32x16_bf16 v[40:55], v[100:103], v[180:183], v[40:55]
    ds_read_b64_tr_b16 v[100:101], v123 offset:4608
    ds_read_b64_tr_b16 v[102:103], v123 offset:5376
    s_xor_b32 s75, s8, 24576
    buffer_load_dwordx4 v[164:167], v1, s[44:47], s75 offen offset:1024 sc1
    v_mfma_f32_32x32x16_bf16 v[56:71], v[104:107], v[180:183], v[56:71]
    ds_read_b64_tr_b16 v[104:105], v123 offset:4640
    ds_read_b64_tr_b16 v[106:107], v123 offset:5408
    buffer_load_dwordx2 v[32:33], v126, s[44:47], s73 offen offset:0 sc1
    v_mfma_f32_32x32x16_bf16 v[72:87], v[108:111], v[180:183], v[72:87]
    ds_read_b64_tr_b16 v[108:109], v123 offset:4672
    ds_read_b64_tr_b16 v[110:111], v123 offset:5440
    s_waitcnt lgkmcnt(6)
    v_mfma_f32_32x32x16_bf16 v[40:55], v[88:91], v[184:187], v[40:55]
    ds_read_b64_tr_b16 v[88:89], v122 offset:0
    ds_read_b64_tr_b16 v[90:91], v122 offset:768
    s_xor_b32 s75, s8, 24576
    buffer_load_dwordx4 v[168:171], v1, s[44:47], s75 offen offset:2048 sc1
    v_mfma_f32_32x32x16_bf16 v[56:71], v[92:95], v[184:187], v[56:71]
    ds_read_b64_tr_b16 v[92:93], v122 offset:32
    ds_read_b64_tr_b16 v[94:95], v122 offset:800
    buffer_load_dwordx2 v[34:35], v126, s[44:47], s73 offen offset:256 sc1
    v_mfma_f32_32x32x16_bf16 v[72:87], v[96:99], v[184:187], v[72:87]
    ds_read_b64_tr_b16 v[96:97], v122 offset:64
    ds_read_b64_tr_b16 v[98:99], v122 offset:832
    s_waitcnt lgkmcnt(6)
    v_mfma_f32_32x32x16_bf16 v[40:55], v[100:103], v[188:191], v[40:55]
    ds_read_b64_tr_b16 v[100:101], v122 offset:1536
    ds_read_b64_tr_b16 v[102:103], v122 offset:2304
    s_xor_b32 s75, s8, 24576
    buffer_load_dwordx4 v[172:175], v1, s[44:47], s75 offen offset:3072 sc1
    v_mfma_f32_32x32x16_bf16 v[56:71], v[104:107], v[188:191], v[56:71]
    ds_read_b64_tr_b16 v[104:105], v122 offset:1568
    ds_read_b64_tr_b16 v[106:107], v122 offset:2336
    s_waitcnt vmcnt(10)
    v_max3_u32 v14, v128, v132, v136
    v_max_u32 v14, v14, v140
    v_cmp_eq_u32 vcc, -1, v14
    v_mfma_f32_32x32x16_bf16 v[72:87], v[108:111], v[188:191], v[72:87]
    ds_read_b64_tr_b16 v[108:109], v122 offset:1600
    ds_read_b64_tr_b16 v[110:111], v122 offset:2368
    s_cbranch_vccnz L_y_stub_102
L_y_ok_101:
    s_barrier
    s_waitcnt lgkmcnt(6)
    v_mfma_f32_32x32x16_bf16 v[40:55], v[88:91], v[128:131], v[40:55]
    ds_read_b64_tr_b16 v[88:89], v122 offset:3072
    ds_read_b64_tr_b16 v[90:91], v122 offset:3840
    s_xor_b32 s75, s8, 28672
    buffer_load_dwordx4 v[176:179], v1, s[44:47], s75 offen offset:0 sc1
    v_mfma_f32_32x32x16_bf16 v[56:71], v[92:95], v[128:131], v[56:71]
    ds_read_b64_tr_b16 v[92:93], v122 offset:3104
    ds_read_b64_tr_b16 v[94:95], v122 offset:3872
    s_xor_b32 s68, s9, 5
    s_mul_i32 s68, s68, 6144
    v_add_u32 v123, s68, v124
    v_mfma_f32_32x32x16_bf16 v[72:87], v[96:99], v[128:131], v[72:87]
    ds_read_b64_tr_b16 v[96:97], v122 offset:3136
    ds_read_b64_tr_b16 v[98:99], v122 offset:3904
    s_waitcnt lgkmcnt(6)
    v_mfma_f32_32x32x16_bf16 v[40:55], v[100:103], v[132:135], v[40:55]
    ds_read_b64_tr_b16 v[100:101], v122 offset:4608
    ds_read_b64_tr_b16 v[102:103], v122 offset:5376
    s_xor_b32 s75, s8, 28672
    buffer_load_dwordx4 v[180:183], v1, s[44:47], s75 offen offset:1024 sc1
    v_mfma_f32_32x32x16_bf16 v[56:71], v[104:107], v[132:135], v[56:71]
    ds_read_b64_tr_b16 v[104:105], v122 offset:4640
    ds_read_b64_tr_b16 v[106:107], v122 offset:5408
    buffer_load_dwordx2 v[36:37], v126, s[44:47], s73 offen offset:512 sc1
    v_mfma_f32_32x32x16_bf16 v[72:87], v[108:111], v[132:135], v[72:87]
    ds_read_b64_tr_b16 v[108:109], v122 offset:4672
    ds_read_b64_tr_b16 v[110:111], v122 offset:5440
    s_waitcnt lgkmcnt(6)
    v_mfma_f32_32x32x16_bf16 v[40:55], v[88:91], v[136:139], v[40:55]
    ds_read_b64_tr_b16 v[88:89], v123 offset:0
    ds_read_b64_tr_b16 v[90:91], v123 offset:768
    s_xor_b32 s75, s8, 28672
    buffer_load_dwordx4 v[184:187], v1, s[44:47], s75 offen offset:2048 sc1
    v_mfma_f32_32x32x16_bf16 v[56:71], v[92:95], v[136:139], v[56:71]
    ds_read_b64_tr_b16 v[92:93], v123 offset:32
    ds_read_b64_tr_b16 v[94:95], v123 offset:800
    buffer_load_dwordx2 v[38:39], v126, s[44:47], s73 offen offset:768 sc1
    v_mfma_f32_32x32x16_bf16 v[72:87], v[96:99], v[136:139], v[72:87]
    ds_read_b64_tr_b16 v[96:97], v123 offset:64
    ds_read_b64_tr_b16 v[98:99], v123 offset:832
    s_waitcnt lgkmcnt(6)
    v_mfma_f32_32x32x16_bf16 v[40:55], v[100:103], v[140:143], v[40:55]
    ds_read_b64_tr_b16 v[100:101], v123 offset:1536
    ds_read_b64_tr_b16 v[102:103], v123 offset:2304
    s_xor_b32 s75, s8, 28672
    buffer_load_dwordx4 v[188:191], v1, s[44:47], s75 offen offset:3072 sc1
    v_mfma_f32_32x32x16_bf16 v[56:71], v[104:107], v[140:143], v[56:71]
    ds_read_b64_tr_b16 v[104:105], v123 offset:1568
    ds_read_b64_tr_b16 v[106:107], v123 offset:2336
    s_waitcnt vmcnt(12)
    v_max3_u32 v14, v144, v148, v152
    v_max_u32 v14, v14, v156
    v_cmp_eq_u32 vcc, -1, v14
    v_mfma_f32_32x32x16_bf16 v[72:87], v[108:111], v[140:143], v[72:87]
    ds_read_b64_tr_b16 v[108:109], v123 offset:1600
    ds_read_b64_tr_b16 v[110:111], v123 offset:2368
    s_cbranch_vccnz L_y_stub_104
L_y_ok_103:
    s_waitcnt lgkmcnt(6)
    v_mfma_f32_32x32x16_bf16 v[40:55], v[88:91], v[144:147], v[40:55]
    ds_read_b64_tr_b16 v[88:89], v123 offset:3072
    ds_read_b64_tr_b16 v[90:91], v123 offset:3840
    v_mfma_f32_32x32x16_bf16 v[56:71], v[92:95], v[144:147], v[56:71]
    ds_read_b64_tr_b16 v[92:93], v123 offset:3104
    ds_read_b64_tr_b16 v[94:95], v123 offset:3872
    s_xor_b32 s68, s9, 6
    s_mul_i32 s68, s68, 6144
    v_add_u32 v122, s68, v124
    v_mfma_f32_32x32x16_bf16 v[72:87], v[96:99], v[144:147], v[72:87]
    ds_read_b64_tr_b16 v[96:97], v123 offset:3136
    ds_read_b64_tr_b16 v[98:99], v123 offset:3904
    ds_read_b64_tr_b16 v[128:129], v120 offset:0
    ds_read_b64_tr_b16 v[130:131], v120 offset:4096
    s_waitcnt lgkmcnt(8)
    v_mfma_f32_32x32x16_bf16 v[40:55], v[100:103], v[148:151], v[40:55]
    ds_read_b64_tr_b16 v[100:101], v123 offset:4608
    ds_read_b64_tr_b16 v[102:103], v123 offset:5376
    v_mfma_f32_32x32x16_bf16 v[56:71], v[104:107], v[148:151], v[56:71]
    ds_read_b64_tr_b16 v[104:105], v123 offset:4640
    ds_read_b64_tr_b16 v[106:107], v123 offset:5408
    v_mfma_f32_32x32x16_bf16 v[72:87], v[108:111], v[148:151], v[72:87]
    ds_read_b64_tr_b16 v[108:109], v123 offset:4672
    ds_read_b64_tr_b16 v[110:111], v123 offset:5440
    ds_read_b64_tr_b16 v[132:133], v121 offset:0
    ds_read_b64_tr_b16 v[134:135], v121 offset:4096
    s_barrier
    s_waitcnt lgkmcnt(10)
    v_mfma_f32_32x32x16_bf16 v[40:55], v[88:91], v[152:155], v[40:55]
    ds_read_b64_tr_b16 v[88:89], v122 offset:0
    ds_read_b64_tr_b16 v[90:91], v122 offset:768
    s_waitcnt vmcnt(1)
    v_max3_u32 v14, v32, v34, v36
    v_max_u32 v14, v14, v38
    v_cmp_eq_u32 vcc, -1, v14
    v_mfma_f32_32x32x16_bf16 v[56:71], v[92:95], v[152:155], v[56:71]
    ds_read_b64_tr_b16 v[92:93], v122 offset:32
    ds_read_b64_tr_b16 v[94:95], v122 offset:800
    s_cbranch_vccnz L_st_stub_106
L_st_ok_105:
    v_mfma_f32_32x32x16_bf16 v[72:87], v[96:99], v[152:155], v[72:87]
    ds_read_b64_tr_b16 v[96:97], v122 offset:64
    ds_read_b64_tr_b16 v[98:99], v122 offset:832
    ds_read_b64_tr_b16 v[136:137], v120 offset:8192
    ds_read_b64_tr_b16 v[138:139], v120 offset:12288
    s_waitcnt lgkmcnt(10)
    v_mfma_f32_32x32x16_bf16 v[40:55], v[100:103], v[156:159], v[40:55]
    ds_read_b64_tr_b16 v[100:101], v122 offset:1536
    ds_read_b64_tr_b16 v[102:103], v122 offset:2304
    v_mfma_f32_32x32x16_bf16 v[56:71], v[104:107], v[156:159], v[56:71]
    ds_read_b64_tr_b16 v[104:105], v122 offset:1568
    ds_read_b64_tr_b16 v[106:107], v122 offset:2336
    v_max3_u32 v14, v160, v164, v168
    v_max_u32 v14, v14, v172
    v_cmp_eq_u32 vcc, -1, v14
    v_mfma_f32_32x32x16_bf16 v[72:87], v[108:111], v[156:159], v[72:87]
    ds_read_b64_tr_b16 v[108:109], v122 offset:1600
    ds_read_b64_tr_b16 v[110:111], v122 offset:2368
    ds_read_b64_tr_b16 v[140:141], v121 offset:8192
    ds_read_b64_tr_b16 v[142:143], v121 offset:12288
    s_cbranch_vccnz L_y_stub_108
L_y_ok_107:
    s_waitcnt lgkmcnt(10)
    v_mfma_f32_32x32x16_bf16 v[40:55], v[88:91], v[160:163], v[40:55]
    ds_read_b64_tr_b16 v[88:89], v122 offset:3072
    ds_read_b64_tr_b16 v[90:91], v122 offset:3840
    v_mfma_f32_32x32x16_bf16 v[56:71], v[92:95], v[160:163], v[56:71]
    ds_read_b64_tr_b16 v[92:93], v122 offset:3104
    ds_read_b64_tr_b16 v[94:95], v122 offset:3872
    s_xor_b32 s68, s9, 7
    s_mul_i32 s68, s68, 6144
    v_add_u32 v123, s68, v124
    v_mfma_f32_32x32x16_bf16 v[72:87], v[96:99], v[160:163], v[72:87]
    ds_read_b64_tr_b16 v[96:97], v122 offset:3136
    ds_read_b64_tr_b16 v[98:99], v122 offset:3904
    ds_read_b64_tr_b16 v[144:145], v120 offset:16384
    ds_read_b64_tr_b16 v[146:147], v120 offset:20480
    s_waitcnt lgkmcnt(10)
    v_mfma_f32_32x32x16_bf16 v[40:55], v[100:103], v[164:167], v[40:55]
    ds_read_b64_tr_b16 v[100:101], v122 offset:4608
    ds_read_b64_tr_b16 v[102:103], v122 offset:5376
    v_mfma_f32_32x32x16_bf16 v[56:71], v[104:107], v[164:167], v[56:71]
    ds_read_b64_tr_b16 v[104:105], v122 offset:4640
    ds_read_b64_tr_b16 v[106:107], v122 offset:5408
    v_mfma_f32_32x32x16_bf16 v[72:87], v[108:111], v[164:167], v[72:87]
    ds_read_b64_tr_b16 v[108:109], v122 offset:4672
    ds_read_b64_tr_b16 v[110:111], v122 offset:5440
    ds_read_b64_tr_b16 v[148:149], v121 offset:16384
    ds_read_b64_tr_b16 v[150:151], v121 offset:20480
    s_waitcnt lgkmcnt(10)
    v_mfma_f32_32x32x16_bf16 v[40:55], v[88:91], v[168:171], v[40:55]
    ds_read_b64_tr_b16 v[88:89], v123 offset:0
    ds_read_b64_tr_b16 v[90:91], v123 offset:768
    v_mfma_f32_32x32x16_bf16 v[56:71], v[92:95], v[168:171], v[56:71]
    ds_read_b64_tr_b16 v[92:93], v123 offset:32
    ds_read_b64_tr_b16 v[94:95], v123 offset:800
    v_mfma_f32_32x32x16_bf16 v[72:87], v[96:99], v[168:171], v[72:87]
    ds_read_b64_tr_b16 v[96:97], v123 offset:64
    ds_read_b64_tr_b16 v[98:99], v123 offset:832
    ds_read_b64_tr_b16 v[152:153], v120 offset:24576
    ds_read_b64_tr_b16 v[154:155], v120 offset:28672
    s_waitcnt lgkmcnt(10)
    v_mfma_f32_32x32x16_bf16 v[40:55], v[100:103], v[172:175], v[40:55]
    ds_read_b64_tr_b16 v[100:101], v123 offset:1536
    ds_read_b64_tr_b16 v[102:103], v123 offset:2304
    v_mfma_f32_32x32x16_bf16 v[56:71], v[104:107], v[172:175], v[56:71]
    ds_read_b64_tr_b16 v[104:105], v123 offset:1568
    ds_read_b64_tr_b16 v[106:107], v123 offset:2336
    s_waitcnt vmcnt(0)
    v_max3_u32 v14, v176, v180, v184
    v_max_u32 v14, v14, v188
    v_cmp_eq_u32 vcc, -1, v14
    v_mfma_f32_32x32x16_bf16 v[72:87], v[108:111], v[172:175], v[72:87]
    ds_read_b64_tr_b16 v[108:109], v123 offset:1600
    ds_read_b64_tr_b16 v[110:111], v123 offset:2368
    ds_read_b64_tr_b16 v[156:157], v121 offset:24576
    ds_read_b64_tr_b16 v[158:159], v121 offset:28672
    s_cbranch_vccnz L_y_stub_110
L_y_ok_109:
    s_waitcnt lgkmcnt(10)
    v_mfma_f32_32x32x16_bf16 v[40:55], v[88:91], v[176:179], v[40:55]
    ds_read_b64_tr_b16 v[88:89], v123 offset:3072
    ds_read_b64_tr_b16 v[90:91], v123 offset:3840
    v_mfma_f32_32x32x16_bf16 v[56:71], v[92:95], v[176:179], v[56:71]
    ds_read_b64_tr_b16 v[92:93], v123 offset:3104
    ds_read_b64_tr_b16 v[94:95], v123 offset:3872
    v_mfma_f32_32x32x16_bf16 v[72:87], v[96:99], v[176:179], v[72:87]
    ds_read_b64_tr_b16 v[96:97], v123 offset:3136
    ds_read_b64_tr_b16 v[98:99], v123 offset:3904
    v_add_f32 v32, v32, v34
    v_add_f32 v33, v33, v35
    v_add_f32 v36, v36, v38
    v_add_f32 v37, v37, v39
    s_waitcnt lgkmcnt(8)
    v_mfma_f32_32x32x16_bf16 v[40:55], v[100:103], v[180:183], v[40:55]
    ds_read_b64_tr_b16 v[100:101], v123 offset:4608
    ds_read_b64_tr_b16 v[102:103], v123 offset:5376
    v_add_f32 v32, v32, v36
    v_add_f32 v33, v33, v37
    v_mov_b32 v34, v32
    v_mfma_f32_32x32x16_bf16 v[56:71], v[104:107], v[180:183], v[56:71]
    ds_read_b64_tr_b16 v[104:105], v123 offset:4640
    ds_read_b64_tr_b16 v[106:107], v123 offset:5408
    v_mov_b32 v35, v33
    v_cmp_gt_u32 vcc, 32, v0
    v_mfma_f32_32x32x16_bf16 v[72:87], v[108:111], v[180:183], v[72:87]
    ds_read_b64_tr_b16 v[108:109], v123 offset:4672
    ds_read_b64_tr_b16 v[110:111], v123 offset:5440
    v_permlane32_swap_b32 v32, v34
    v_permlane32_swap_b32 v33, v35
    s_waitcnt lgkmcnt(6)
    v_mfma_f32_32x32x16_bf16 v[40:55], v[88:91], v[184:187], v[40:55]
    v_add_f32 v32, v32, v34
    v_add_f32 v33, v33, v35
    v_mul_f32 v32, 0xbb000000, v32
    v_mul_f32 v33, 0x3b000000, v33
    v_mfma_f32_32x32x16_bf16 v[56:71], v[92:95], v[184:187], v[56:71]
    v_fma_f32 v33, -v32, v32, v33
    v_max_f32 v33, 0, v33
    v_add_f32 v33, 0x3727c5ac, v33
    v_mfma_f32_32x32x16_bf16 v[72:87], v[96:99], v[184:187], v[72:87]
    v_sqrt_f32 v34, v33
    v_rcp_f32 v36, v33
    v_cndmask_b32 v32, v34, v32, vcc
    s_waitcnt lgkmcnt(0)
    v_mfma_f32_32x32x16_bf16 v[40:55], v[100:103], v[188:191], v[40:55]
    v_cvt_pk_bf16_f32 v118, v32, v32
    v_lshlrev_b32 v33, 16, v118
    v_sub_f32 v33, v32, v33
    v_mfma_f32_32x32x16_bf16 v[56:71], v[104:107], v[188:191], v[56:71]
    v_cvt_pk_bf16_f32 v119, v33, 0
    v_mov_b32 v37, v36
    v_mfma_f32_32x32x16_bf16 v[72:87], v[108:111], v[188:191], v[72:87]
    v_mfma_f32_32x32x8_bf16 v[40:55], v[112:113], v[118:119], v[40:55]
    v_mfma_f32_32x32x8_bf16 v[56:71], v[114:115], v[118:119], v[56:71]
    v_mfma_f32_32x32x8_bf16 v[72:87], v[116:117], v[118:119], v[72:87]
    s_cmp_eq_u32 s49, 28
    s_cselect_b32 s72, 1073741824, 0
    s_barrier
    s_nop 6
    v_max_f32 v40, 0, v40
    v_max_f32 v41, 0, v41
    v_max_f32 v42, 0, v42
    v_max_f32 v43, 0, v43
    v_max_f32 v44, 0, v44
    v_max_f32 v45, 0, v45
    v_max_f32 v46, 0, v46
    v_max_f32 v47, 0, v47
    v_mul_f32 v48, v48, v36
    v_mul_f32 v49, v49, v37
    v_mul_f32 v50, v50, v36
    v_mul_f32 v51, v51, v37
    v_mul_f32 v52, v52, v36
    v_mul_f32 v53, v53, v37
    v_mul_f32 v54, v54, v36
    v_mul_f32 v55, v55, v37
    v_mul_f32 v40, v40, v48
    v_mul_f32 v41, v41, v49
    v_mul_f32 v42, v42, v50
    v_mul_f32 v43, v43, v51
    v_mul_f32 v44, v44, v52
    v_mul_f32 v45, v45, v53
    v_mul_f32 v46, v46, v54
    v_mul_f32 v47, v47, v55
    v_cvt_pk_bf16_f32 v40, v40, v41
    v_cvt_pk_bf16_f32 v41, v42, v43
    v_cvt_pk_bf16_f32 v42, v44, v45
    v_cvt_pk_bf16_f32 v43, v46, v47
    v_max_f32 v56, 0, v56
    v_max_f32 v57, 0, v57
    v_max_f32 v58, 0, v58
    v_max_f32 v59, 0, v59
    v_max_f32 v60, 0, v60
    v_max_f32 v61, 0, v61
    v_max_f32 v62, 0, v62
    v_max_f32 v63, 0, v63
    v_mul_f32 v64, v64, v36
    v_mul_f32 v65, v65, v37
    v_mul_f32 v66, v66, v36
    v_mul_f32 v67, v67, v37
    v_mul_f32 v68, v68, v36
    v_mul_f32 v69, v69, v37
    v_mul_f32 v70, v70, v36
    v_mul_f32 v71, v71, v37
    v_mul_f32 v56, v56, v64
    v_mul_f32 v57, v57, v65
    v_mul_f32 v58, v58, v66
    v_mul_f32 v59, v59, v67
    v_mul_f32 v60, v60, v68
    v_mul_f32 v61, v61, v69
    v_mul_f32 v62, v62, v70
    v_mul_f32 v63, v63, v71
    v_cvt_pk_bf16_f32 v56, v56, v57
    v_cvt_pk_bf16_f32 v57, v58, v59
    v_cvt_pk_bf16_f32 v58, v60, v61
    v_cvt_pk_bf16_f32 v59, v62, v63
    v_max_f32 v72, 0, v72
    v_max_f32 v73, 0, v73
    v_max_f32 v74, 0, v74
    v_max_f32 v75, 0, v75
    v_max_f32 v76, 0, v76
    v_max_f32 v77, 0, v77
    v_max_f32 v78, 0, v78
    v_max_f32 v79, 0, v79
    v_mul_f32 v80, v80, v36
    v_mul_f32 v81, v81, v37
    v_mul_f32 v82, v82, v36
    v_mul_f32 v83, v83, v37
    v_mul_f32 v84, v84, v36
    v_mul_f32 v85, v85, v37
    v_mul_f32 v86, v86, v36
    v_mul_f32 v87, v87, v37
    v_mul_f32 v72, v72, v80
    v_mul_f32 v73, v73, v81
    v_mul_f32 v74, v74, v82
    v_mul_f32 v75, v75, v83
    v_mul_f32 v76, v76, v84
    v_mul_f32 v77, v77, v85
    v_mul_f32 v78, v78, v86
    v_mul_f32 v79, v79, v87
    v_cvt_pk_bf16_f32 v72, v72, v73
    v_cvt_pk_bf16_f32 v73, v74, v75
    v_cvt_pk_bf16_f32 v74, v76, v77
    v_cvt_pk_bf16_f32 v75, v78, v79
    buffer_store_dwordx4 v[40:43], v6, s[44:47], 0 offen offset:0 sc1
    buffer_store_dwordx4 v[56:59], v6, s[44:47], 0 offen offset:1024 sc1
    buffer_store_dwordx4 v[72:75], v6, s[44:47], s72 offen offset:2048 sc1
L_g_donel:
    s_lshl_b32 s69, s55, 10
    v_add_u32 v36, s69, v1
    s_mul_i32 s79, s64, 88064
    s_add_u32 s79, s79, 6291456
    s_ashr_i32 s68, s81, 4
    s_add_u32 s83, s79, s68
    s_lshr_b32 s68, s80, 4
    s_add_u32 s79, s79, s68
    v_add_u32 v12, s10, v36
    v_add_u32 v3, s11, v36
    ds_write_b128 v3, v[192:195] offset:16384
    ds_write_b128 v3, v[196:199] offset:20480
    s_add_u32 s68, s11, 49152
    v_add_u32 v2, s68, v36
    ds_write_b128 v2, v[200:203] offset:0
    ds_write_b128 v2, v[204:207] offset:4096
    ds_write_b128 v2, v[208:211] offset:8192
    ds_write_b128 v2, v[212:215] offset:12288
    ds_write_b128 v2, v[216:219] offset:16384
    ds_write_b128 v2, v[220:223] offset:20480
    v_add_u32 v3, 98304, v36
    ds_write_b128 v3, v[224:227] offset:0
    ds_write_b128 v3, v[228:231] offset:4096
    ds_write_b128 v3, v[232:235] offset:8192
    ds_write_b128 v3, v[236:239] offset:12288
    s_cmp_lt_u32 s49, 29
    s_cbranch_scc1 L_nopoll_111
L_poll_112:
    s_sleep 4
    buffer_load_dword v40, off, s[44:47], s79 sc1
    s_sub_u32 s62, s62, 1
    s_max_i32 s62, s62, 0
    s_waitcnt vmcnt(0)
    s_cmp_eq_u32 s62, 0
    s_cbranch_scc1 L_nopoll_111
    v_cmp_eq_u32 vcc, -1, v40
    s_cbranch_vccnz L_poll_112
    s_sleep 4
L_nopoll_111:
    s_waitcnt vmcnt(0)
    s_cmp_gt_u32 s82, 0
    s_cselect_b32 s75, s79, s83
    s_add_u32 s75, s75, 0
    buffer_load_dwordx4 v[72:75], v1, s[44:47], s75 offen sc1
    s_cmp_gt_u32 s82, 1
    s_cselect_b32 s75, s79, s83
    s_add_u32 s75, s75, 1024
    buffer_load_dwordx4 v[76:79], v1, s[44:47], s75 offen sc1
    s_cmp_gt_u32 s82, 2
    s_cselect_b32 s75, s79, s83
    s_add_u32 s75, s75, 2048
    buffer_load_dwordx4 v[80:83], v1, s[44:47], s75 offen sc1
    s_cmp_gt_u32 s82, 3
    s_cselect_b32 s75, s79, s83
    s_add_u32 s75, s75, 3072
    buffer_load_dwordx4 v[84:87], v1, s[44:47], s75 offen sc1
    s_cmp_gt_u32 s82, 4
    s_cselect_b32 s75, s79, s83
    s_add_u32 s75, s75, 4096
    buffer_load_dwordx4 v[88:91], v1, s[44:47], s75 offen sc1
    s_cmp_gt_u32 s82, 5
    s_cselect_b32 s75, s79, s83
    s_add_u32 s75, s75, 5120
    buffer_load_dwordx4 v[92:95], v1, s[44:47], s75 offen sc1
    s_cmp_gt_u32 s82, 6
    s_cselect_b32 s75, s79, s83
    s_add_u32 s75, s75, 6144
    buffer_load_dwordx4 v[96:99], v1, s[44:47], s75 offen sc1
    s_cmp_gt_u32 s82, 7
    s_cselect_b32 s75, s79, s83
    s_add_u32 s75, s75, 7168
    buffer_load_dwordx4 v[100:103], v1, s[44:47], s75 offen sc1
    ds_write_b128 v3, v[240:243] offset:16384
    ds_write_b128 v3, v[244:247] offset:20480
    ds_write_b128 v3, v[248:251] offset:24576
    ds_write_b128 v3, v[252:255] offset:28672
    v_add_u32 v34, 98304, v11
    v_xor_b32 v35, 64, v34
    ds_read_b64_tr_b16 v[192:193], v34 offset:32768
    ds_read_b64_tr_b16 v[194:195], v34 offset:36864
    ds_read_b64_tr_b16 v[196:197], v35 offset:32768
    ds_read_b64_tr_b16 v[198:199], v35 offset:36864
    ds_read_b64_tr_b16 v[200:201], v34 offset:40960
    ds_read_b64_tr_b16 v[202:203], v34 offset:45056
    ds_read_b64_tr_b16 v[204:205], v35 offset:40960
    ds_read_b64_tr_b16 v[206:207], v35 offset:45056
    s_waitcnt lgkmcnt(0)
    s_barrier
    s_waitcnt vmcnt(6)
    v_max_u32 v14, v72, v76
    v_cmp_eq_u32 vcc, -1, v14
    s_cbranch_vccnz L_h_stub_114
L_h_ok_113:
    v_mfma_f32_32x32x16_bf16 v[56:71], v[132:135], v[72:75], 0
    v_mfma_f32_32x32x16_bf16 v[40:55], v[128:131], v[72:75], 0
    s_cmp_gt_u32 s82, 8
    s_cselect_b32 s75, s79, s83
    s_add_u32 s75, s75, 8192
    buffer_load_dwordx4 v[104:107], v1, s[44:47], s75 offen sc1
    v_mfma_f32_32x32x16_bf16 v[56:71], v[140:143], v[76:79], v[56:71]
    s_waitcnt vmcnt(5)
    v_max_u32 v14, v80, v84
    v_cmp_eq_u32 vcc, -1, v14
    v_mfma_f32_32x32x16_bf16 v[40:55], v[136:139], v[76:79], v[40:55]
    s_cmp_gt_u32 s82, 9
    s_cselect_b32 s75, s79, s83
    s_add_u32 s75, s75, 9216
    buffer_load_dwordx4 v[108:111], v1, s[44:47], s75 offen sc1
    s_cbranch_vccnz L_h_stub_116
L_h_ok_115:
    v_mfma_f32_32x32x16_bf16 v[56:71], v[148:151], v[80:83], v[56:71]
    v_add_u32 v32, s10, v11
    v_xor_b32 v33, 64, v32
    ds_read_b64_tr_b16 v[132:133], v33 offset:0
    ds_read_b64_tr_b16 v[134:135], v33 offset:4096
    v_mfma_f32_32x32x16_bf16 v[40:55], v[144:147], v[80:83], v[40:55]
    ds_read_b64_tr_b16 v[128:129], v32 offset:0
    ds_read_b64_tr_b16 v[130:131], v32 offset:4096
    s_cmp_gt_u32 s82, 10
    s_cselect_b32 s75, s79, s83
    s_add_u32 s75, s75, 10240
    buffer_load_dwordx4 v[112:115], v1, s[44:47], s75 offen sc1
    v_mfma_f32_32x32x16_bf16 v[56:71], v[156:159], v[84:87], v[56:71]
    ds_read_b64_tr_b16 v[140:141], v33 offset:8192
    ds_read_b64_tr_b16 v[142:143], v33 offset:12288
    s_waitcnt vmcnt(5)
    v_max_u32 v14, v88, v92
    v_cmp_eq_u32 vcc, -1, v14
    v_mfma_f32_32x32x16_bf16 v[40:55], v[152:155], v[84:87], v[40:55]
    ds_read_b64_tr_b16 v[136:137], v32 offset:8192
    ds_read_b64_tr_b16 v[138:139], v32 offset:12288
    s_cmp_gt_u32 s82, 11
    s_cselect_b32 s75, s79, s83
    s_add_u32 s75, s75, 11264
    buffer_load_dwordx4 v[116:119], v1, s[44:47], s75 offen sc1
    s_cbranch_vccnz L_h_stub_118
L_h_ok_117:
    v_mfma_f32_32x32x16_bf16 v[56:71], v[196:199], v[88:91], v[56:71]
    ds_read_b64_tr_b16 v[148:149], v33 offset:16384
    ds_read_b64_tr_b16 v[150:151], v33 offset:20480
    v_mfma_f32_32x32x16_bf16 v[40:55], v[192:195], v[88:91], v[40:55]
    ds_read_b64_tr_b16 v[144:145], v32 offset:16384
    ds_read_b64_tr_b16 v[146:147], v32 offset:20480
    s_cmp_gt_u32 s82, 12
    s_cselect_b32 s75, s79, s83
    s_add_u32 s75, s75, 12288
    buffer_load_dwordx4 v[120:123], v1, s[44:47], s75 offen sc1
    v_mfma_f32_32x32x16_bf16 v[56:71], v[204:207], v[92:95], v[56:71]
    s_add_u32 s68, s10, 49152
    v_add_u32 v34, s68, v11
    v_xor_b32 v35, 64, v34
    ds_read_b64_tr_b16 v[156:157], v35 offset:0
    ds_read_b64_tr_b16 v[158:159], v35 offset:4096
    s_waitcnt vmcnt(5)
    v_max_u32 v14, v96, v100
    v_cmp_eq_u32 vcc, -1, v14
    v_mfma_f32_32x32x16_bf16 v[40:55], v[200:203], v[92:95], v[40:55]
    ds_read_b64_tr_b16 v[152:153], v34 offset:0
    ds_read_b64_tr_b16 v[154:155], v34 offset:4096
    s_cmp_gt_u32 s82, 13
    s_cselect_b32 s75, s79, s83
    s_add_u32 s75, s75, 13312
    buffer_load_dwordx4 v[124:127], v1, s[44:47], s75 offen sc1
    s_cbranch_vccnz L_h_stub_120
L_h_ok_119:
    s_waitcnt lgkmcnt(12)
    v_mfma_f32_32x32x16_bf16 v[56:71], v[132:135], v[96:99], v[56:71]
    ds_read_b64_tr_b16 v[196:197], v35 offset:8192
    ds_read_b64_tr_b16 v[198:199], v35 offset:12288
    v_mfma_f32_32x32x16_bf16 v[40:55], v[128:131], v[96:99], v[40:55]
    ds_read_b64_tr_b16 v[192:193], v34 offset:8192
    ds_read_b64_tr_b16 v[194:195], v34 offset:12288
    s_cmp_gt_u32 s82, 14
    s_cselect_b32 s75, s79, s83
    s_add_u32 s75, s75, 14336
    buffer_load_dwordx4 v[160:163], v1, s[44:47], s75 offen sc1
    s_waitcnt lgkmcnt(12)
    v_mfma_f32_32x32x16_bf16 v[56:71], v[140:143], v[100:103], v[56:71]
    ds_read_b64_tr_b16 v[204:205], v35 offset:16384
    ds_read_b64_tr_b16 v[206:207], v35 offset:20480
    s_waitcnt vmcnt(5)
    v_max_u32 v14, v104, v108
    v_cmp_eq_u32 vcc, -1, v14
    v_mfma_f32_32x32x16_bf16 v[40:55], v[136:139], v[100:103], v[40:55]
    ds_read_b64_tr_b16 v[200:201], v34 offset:16384
    ds_read_b64_tr_b16 v[202:203], v34 offset:20480
    s_cmp_gt_u32 s82, 15
    s_cselect_b32 s75, s79, s83
    s_add_u32 s75, s75, 15360
    buffer_load_dwordx4 v[164:167], v1, s[44:47], s75 offen sc1
    s_cbranch_vccnz L_h_stub_122
L_h_ok_121:
    s_waitcnt lgkmcnt(12)
    v_mfma_f32_32x32x16_bf16 v[56:71], v[148:151], v[104:107], v[56:71]
    v_add_u32 v32, s11, v11
    v_xor_b32 v33, 64, v32
    ds_read_b64_tr_b16 v[132:133], v33 offset:0
    ds_read_b64_tr_b16 v[134:135], v33 offset:4096
    v_mfma_f32_32x32x16_bf16 v[40:55], v[144:147], v[104:107], v[40:55]
    ds_read_b64_tr_b16 v[128:129], v32 offset:0
    ds_read_b64_tr_b16 v[130:131], v32 offset:4096
    s_cmp_gt_u32 s82, 16
    s_cselect_b32 s75, s79, s83
    s_add_u32 s75, s75, 16384
    buffer_load_dwordx4 v[168:171], v1, s[44:47], s75 offen sc1
    s_waitcnt lgkmcnt(12)
    v_mfma_f32_32x32x16_bf16 v[56:71], v[156:159], v[108:111], v[56:71]
    ds_read_b64_tr_b16 v[140:141], v33 offset:8192
    ds_read_b64_tr_b16 v[142:143], v33 offset:12288
    s_waitcnt vmcnt(5)
    v_max_u32 v14, v112, v116
    v_cmp_eq_u32 vcc, -1, v14
    v_mfma_f32_32x32x16_bf16 v[40:55], v[152:155], v[108:111], v[40:55]
    ds_read_b64_tr_b16 v[136:137], v32 offset:8192
    ds_read_b64_tr_b16 v[138:139], v32 offset:12288
    s_cmp_gt_u32 s82, 17
    s_cselect_b32 s75, s79, s83
    s_add_u32 s75, s75, 17408
    buffer_load_dwordx4 v[172:175], v1, s[44:47], s75 offen sc1
    s_cbranch_vccnz L_h_stub_124
L_h_ok_123:
    s_barrier
    s_waitcnt lgkmcnt(12)
    v_mfma_f32_32x32x16_bf16 v[56:71], v[196:199], v[112:115], v[56:71]
    ds_read_b64_tr_b16 v[148:149], v33 offset:16384
    ds_read_b64_tr_b16 v[150:151], v33 offset:20480
    v_mfma_f32_32x32x16_bf16 v[40:55], v[192:195], v[112:115], v[40:55]
    ds_read_b64_tr_b16 v[144:145], v32 offset:16384
    ds_read_b64_tr_b16 v[146:147], v32 offset:20480
    s_cmp_gt_u32 s82, 18
    s_cselect_b32 s75, s79, s83
    s_add_u32 s75, s75, 18432
    buffer_load_dwordx4 v[176:179], v1, s[44:47], s75 offen sc1
    s_waitcnt lgkmcnt(12)
    v_mfma_f32_32x32x16_bf16 v[56:71], v[204:207], v[116:119], v[56:71]
    s_add_u32 s68, s11, 49152
    v_add_u32 v34, s68, v11
    v_xor_b32 v35, 64, v34
    ds_read_b64_tr_b16 v[156:157], v35 offset:0
    ds_read_b64_tr_b16 v[158:159], v35 offset:4096
    s_waitcnt vmcnt(5)
    v_max_u32 v14, v120, v124
    v_cmp_eq_u32 vcc, -1, v14
    v_mfma_f32_32x32x16_bf16 v[40:55], v[200:203], v[116:119], v[40:55]
    ds_read_b64_tr_b16 v[152:153], v34 offset:0
    ds_read_b64_tr_b16 v[154:155], v34 offset:4096
    s_cmp_gt_u32 s82, 19
    s_cselect_b32 s75, s79, s83
    s_add_u32 s75, s75, 19456
    buffer_load_dwordx4 v[180:183], v1, s[44:47], s75 offen sc1
    s_cbranch_vccnz L_h_stub_126
L_h_ok_125:
    s_waitcnt lgkmcnt(12)
    v_mfma_f32_32x32x16_bf16 v[56:71], v[132:135], v[120:123], v[56:71]
    ds_read_b64_tr_b16 v[196:197], v35 offset:8192
    ds_read_b64_tr_b16 v[198:199], v35 offset:12288
    v_mfma_f32_32x32x16_bf16 v[40:55], v[128:131], v[120:123], v[40:55]
    ds_read_b64_tr_b16 v[192:193], v34 offset:8192
    ds_read_b64_tr_b16 v[194:195], v34 offset:12288
    s_cmp_gt_u32 s82, 20
    s_cselect_b32 s75, s79, s83
    s_add_u32 s75, s75, 20480
    buffer_load_dwordx4 v[184:187], v1, s[44:47], s75 offen sc1
    s_waitcnt lgkmcnt(12)
    v_mfma_f32_32x32x16_bf16 v[56:71], v[140:143], v[124:127], v[56:71]
    ds_read_b64_tr_b16 v[204:205], v35 offset:16384
    ds_read_b64_tr_b16 v[206:207], v35 offset:20480
    s_waitcnt vmcnt(5)
    v_max_u32 v14, v160, v164
    v_cmp_eq_u32 vcc, -1, v14
    v_mfma_f32_32x32x16_bf16 v[40:55], v[136:139], v[124:127], v[40:55]
    ds_read_b64_tr_b16 v[200:201], v34 offset:16384
    ds_read_b64_tr_b16 v[202:203], v34 offset:20480
    s_cmp_gt_u32 s82, 21
    s_cselect_b32 s75, s79, s83
    s_add_u32 s75, s75, 21504
    s_cmp_lt_u32 s55, 2
    s_cselect_b32 s75, s75, 1073741824
    buffer_load_dwordx4 v[188:191], v1, s[44:47], s75 offen sc1
    s_cbranch_vccnz L_h_stub_128
L_h_ok_127:
    s_waitcnt lgkmcnt(12)
    v_mfma_f32_32x32x16_bf16 v[56:71], v[148:151], v[160:163], v[56:71]
    v_add_u32 v32, 98304, v11
    v_xor_b32 v33, 64, v32
    ds_read_b64_tr_b16 v[132:133], v33 offset:0
    ds_read_b64_tr_b16 v[134:135], v33 offset:4096
    v_mfma_f32_32x32x16_bf16 v[40:55], v[144:147], v[160:163], v[40:55]
    ds_read_b64_tr_b16 v[128:129], v32 offset:0
    ds_read_b64_tr_b16 v[130:131], v32 offset:4096
    s_waitcnt lgkmcnt(12)
    v_mfma_f32_32x32x16_bf16 v[56:71], v[156:159], v[164:167], v[56:71]
    ds_read_b64_tr_b16 v[140:141], v33 offset:8192
    ds_read_b64_tr_b16 v[142:143], v33 offset:12288
    s_waitcnt vmcnt(4)
    v_max_u32 v14, v168, v172
    v_cmp_eq_u32 vcc, -1, v14
    v_mfma_f32_32x32x16_bf16 v[40:55], v[152:155], v[164:167], v[40:55]
    ds_read_b64_tr_b16 v[136:137], v32 offset:8192
    ds_read_b64_tr_b16 v[138:139], v32 offset:12288
    s_cbranch_vccnz L_h_stub_130
L_h_ok_129:
    s_waitcnt lgkmcnt(12)
    v_mfma_f32_32x32x16_bf16 v[56:71], v[196:199], v[168:171], v[56:71]
    ds_read_b64_tr_b16 v[148:149], v33 offset:16384
    ds_read_b64_tr_b16 v[150:151], v33 offset:20480
    v_mfma_f32_32x32x16_bf16 v[40:55], v[192:195], v[168:171], v[40:55]
    ds_read_b64_tr_b16 v[144:145], v32 offset:16384
    ds_read_b64_tr_b16 v[146:147], v32 offset:20480
    s_waitcnt lgkmcnt(12)
    v_mfma_f32_32x32x16_bf16 v[56:71], v[204:207], v[172:175], v[56:71]
    ds_read_b64_tr_b16 v[156:157], v33 offset:24576
    ds_read_b64_tr_b16 v[158:159], v33 offset:28672
    s_waitcnt vmcnt(2)
    v_max_u32 v14, v176, v180
    v_cmp_eq_u32 vcc, -1, v14
    v_mfma_f32_32x32x16_bf16 v[40:55], v[200:203], v[172:175], v[40:55]
    ds_read_b64_tr_b16 v[152:153], v32 offset:24576
    ds_read_b64_tr_b16 v[154:155], v32 offset:28672
    s_cbranch_vccnz L_h_stub_132
L_h_ok_131:
    s_waitcnt lgkmcnt(12)
    v_mfma_f32_32x32x16_bf16 v[56:71], v[132:135], v[176:179], v[56:71]
    v_mfma_f32_32x32x16_bf16 v[40:55], v[128:131], v[176:179], v[40:55]
    s_waitcnt lgkmcnt(8)
    v_mfma_f32_32x32x16_bf16 v[56:71], v[140:143], v[180:183], v[56:71]
    s_waitcnt vmcnt(0)
    v_max_u32 v14, v184, v188
    v_cmp_eq_u32 vcc, -1, v14
    v_mfma_f32_32x32x16_bf16 v[40:55], v[136:139], v[180:183], v[40:55]
    s_cbranch_vccnz L_h_stub_134
L_h_ok_133:
    s_waitcnt lgkmcnt(4)
    v_mfma_f32_32x32x16_bf16 v[56:71], v[148:151], v[184:187], v[56:71]
    v_mfma_f32_32x32x16_bf16 v[40:55], v[144:147], v[184:187], v[40:55]
    s_waitcnt lgkmcnt(0)
    v_mfma_f32_32x32x16_bf16 v[56:71], v[156:159], v[188:191], v[56:71]
    v_mfma_f32_32x32x16_bf16 v[40:55], v[152:155], v[188:191], v[40:55]
    s_setprio 2
    v_xor_b32 v13, 1024, v12
    v_xor_b32 v14, 2048, v12
    v_xor_b32 v15, 3072, v12
    s_nop 6
    ds_write_b128 v12, v[56:59] offset:8192
    ds_write_b128 v12, v[60:63] offset:12288
    ds_write_b128 v12, v[64:67] offset:16384
    ds_write_b128 v12, v[68:71] offset:20480
    ds_write_b128 v12, v[48:51] offset:0
    ds_write_b128 v12, v[52:55] offset:4096
    s_waitcnt lgkmcnt(0)
    s_barrier
    ds_read_b128 v[72:75], v13 offset:0
    ds_read_b128 v[80:83], v14 offset:8192
    ds_read_b128 v[88:91], v15 offset:16384
    ds_read_b128 v[76:79], v13 offset:4096
    ds_read_b128 v[84:87], v14 offset:12288
    ds_read_b128 v[92:95], v15 offset:20480
    s_waitcnt lgkmcnt(5)
    v_pk_add_f32 v[40:41], v[40:41], v[72:73]
    v_pk_add_f32 v[42:43], v[42:43], v[74:75]
    s_waitcnt lgkmcnt(3)
    v_pk_add_f32 v[80:81], v[80:81], v[88:89]
    v_pk_add_f32 v[82:83], v[82:83], v[90:91]
    v_pk_add_f32 v[40:41], v[40:41], v[80:81]
    v_pk_add_f32 v[42:43], v[42:43], v[82:83]
    s_waitcnt lgkmcnt(2)
    v_pk_add_f32 v[44:45], v[44:45], v[76:77]
    v_pk_add_f32 v[46:47], v[46:47], v[78:79]
    s_waitcnt lgkmcnt(0)
    v_pk_add_f32 v[84:85], v[84:85], v[92:93]
    v_pk_add_f32 v[86:87], v[86:87], v[94:95]
    v_pk_add_f32 v[44:45], v[44:45], v[84:85]
    v_pk_add_f32 v[46:47], v[46:47], v[86:87]
    v_pk_fma_f32 v[16:17], v[40:41], v[24:25], v[16:17]
    v_pk_fma_f32 v[18:19], v[42:43], v[26:27], v[18:19]
    v_pk_fma_f32 v[20:21], v[44:45], v[28:29], v[20:21]
    v_pk_fma_f32 v[22:23], v[46:47], v[30:31], v[22:23]
    v_cvt_pk_bf16_f32 v16, v16, v17
    v_cvt_pk_bf16_f32 v17, v18, v19
    v_cvt_pk_bf16_f32 v18, v20, v21
    v_cvt_pk_bf16_f32 v19, v22, v23
    s_nop 0
    v_permlane32_swap_b32 v16, v18
    v_permlane32_swap_b32 v17, v19
    buffer_store_dwordx4 v[16:19], v4, s[40:43], 0 offen
L_fin:
L_end:
    s_endpgm
L_ga_stub_6:
    s_cmp_eq_u32 s62, 0
    s_cbranch_scc1 L_ga_ok_5
    s_sub_u32 s62, s62, 1
    s_waitcnt vmcnt(0)
    s_sleep 2
    s_mov_b32 s72, 4096
    buffer_load_dwordx4 v[160:163], v36, s[44:47], s72 offen sc1
    s_mov_b32 s72, 8192
    buffer_load_dwordx4 v[164:167], v36, s[44:47], s72 offen sc1
    s_mov_b32 s72, 12288
    buffer_load_dwordx4 v[168:171], v36, s[44:47], s72 offen sc1
    s_mov_b32 s72, 16384
    buffer_load_dwordx4 v[172:175], v36, s[44:47], s72 offen sc1
    s_waitcnt vmcnt(0)
    s_branch L_ga_chk_4
L_kv_stub_12:
    s_cmp_eq_u32 s62, 0
    s_cbranch_scc1 L_kv_ok_11
    s_sub_u32 s62, s62, 1
    s_sleep 2
    s_add_u32 m0, s77, -4096
    s_xor_b32 s75, s76, 2048
    buffer_load_dwordx4 v38, s[44:47], s75 offen sc1 lds
    s_add_u32 m0, s77, 0
    s_nop 0
    buffer_load_dwordx4 v38, s[44:47], s76 offen sc1 lds
    s_add_u32 m0, s77, 4096
    s_xor_b32 s75, s76, 6144
    buffer_load_dwordx4 v38, s[44:47], s75 offen sc1 lds
    s_add_u32 m0, s77, 8192
    s_xor_b32 s75, s76, 4096
    buffer_load_dwordx4 v38, s[44:47], s75 offen sc1 lds
    s_add_u32 m0, s77, 12288
    s_xor_b32 s75, s76, 10240
    buffer_load_dwordx4 v38, s[44:47], s75 offen sc1 lds
    s_add_u32 m0, s77, 16384
    s_xor_b32 s75, s76, 8192
    buffer_load_dwordx4 v38, s[44:47], s75 offen sc1 lds
    s_add_u32 m0, s77, 20480
    s_xor_b32 s75, s76, 14336
    buffer_load_dwordx4 v38, s[44:47], s75 offen sc1 lds
    s_add_u32 m0, s77, 24576
    s_xor_b32 s75, s76, 12288
    buffer_load_dwordx4 v38, s[44:47], s75 offen sc1 lds
    s_waitcnt vmcnt(0)
    s_branch L_kv_chk_10
L_kv_stub_23:
    s_cmp_eq_u32 s62, 0
    s_cbranch_scc1 L_kv_ok_22
    s_sub_u32 s62, s62, 1
    s_sleep 2
    s_add_u32 m0, s77, 32768
    s_xor_b32 s75, s76, 16384
    buffer_load_dwordx4 v38, s[44:47], s75 offen sc1 lds
    s_add_u32 m0, s77, 40960
    s_xor_b32 s75, s76, 20480
    buffer_load_dwordx4 v38, s[44:47], s75 offen sc1 lds
    s_add_u32 m0, s77, 49152
    s_xor_b32 s75, s76, 24576
    buffer_load_dwordx4 v38, s[44:47], s75 offen sc1 lds
    s_add_u32 m0, s77, 57344
    s_xor_b32 s75, s76, 28672
    buffer_load_dwordx4 v38, s[44:47], s75 offen sc1 lds
    s_waitcnt vmcnt(0)
    s_branch L_kv_chk_21
L_kv_stub_26:
    s_cmp_eq_u32 s62, 0
    s_cbranch_scc1 L_kv_ok_25
    s_sub_u32 s62, s62, 1
    s_sleep 2
    s_add_u32 m0, s77, 98304
    s_xor_b32 s75, s76, 32768
    buffer_load_dwordx4 v38, s[44:47], s75 offen sc1 lds
    s_add_u32 m0, s77, 106496
    s_xor_b32 s75, s76, 36864
    buffer_load_dwordx4 v38, s[44:47], s75 offen sc1 lds
    s_add_u32 m0, s77, 114688
    s_xor_b32 s75, s76, 40960
    buffer_load_dwordx4 v38, s[44:47], s75 offen sc1 lds
    s_add_u32 m0, s77, 122880
    s_xor_b32 s75, s76, 45056
    buffer_load_dwordx4 v38, s[44:47], s75 offen sc1 lds
    s_add_u32 m0, s77, 131072
    s_xor_b32 s75, s76, 49152
    buffer_load_dwordx4 v38, s[44:47], s75 offen sc1 lds
    s_add_u32 m0, s77, 139264
    s_xor_b32 s75, s76, 53248
    buffer_load_dwordx4 v38, s[44:47], s75 offen sc1 lds
    s_add_u32 m0, s77, 147456
    s_xor_b32 s75, s76, 57344
    buffer_load_dwordx4 v38, s[44:47], s75 offen sc1 lds
    s_add_u32 m0, s77, 155648
    s_xor_b32 s75, s76, 61440
    buffer_load_dwordx4 v38, s[44:47], s75 offen sc1 lds
    s_waitcnt vmcnt(0)
    s_branch L_kv_chk_24
L_slow:
    s_nop 7
    v_mov_b32 v13, 0xff800000
    s_mov_b32 s68, 262144
L_sl1_135:
    buffer_load_dwordx4 v[104:107], v1, s[44:47], s68 offen sc1
    s_mov_b64 exec, s[66:67]
    buffer_load_dwordx4 v[108:111], v1, s[44:47], s68 offen offset:1024 sc1
    buffer_load_dwordx4 v[112:115], v1, s[44:47], s68 offen offset:1536 sc1
    s_mov_b64 exec, -1
    s_waitcnt vmcnt(0)
    v_max3_u32 v12, v104, v108, v112
    v_cmp_eq_u32 vcc, -1, v12
    s_cbranch_vccz L_sl1go_136
    s_cmp_eq_u32 s62, 0
    s_cbranch_scc1 L_sl1go_136
    s_sub_u32 s62, s62, 1
    s_branch L_sl1_135
L_sl1go_136:
    v_mfma_f32_32x32x16_bf16 v[40:55], v[104:107], v[16:19], 0
    s_nop 11
    v_max3_f32 v13, v13, v40, v41
    v_max3_f32 v13, v13, v42, v43
    v_max3_f32 v13, v13, v44, v45
    v_max3_f32 v13, v13, v46, v47
    v_max3_f32 v13, v13, v48, v49
    v_max3_f32 v13, v13, v50, v51
    v_max3_f32 v13, v13, v52, v53
    v_max3_f32 v13, v13, v54, v55
    s_add_u32 s68, s68, 2048
    s_cmp_lt_u32 s68, 393216
    s_cbranch_scc1 L_sl1_135
    v_mov_b32 v12, v13
    s_nop 1
    v_permlane32_swap_b32 v13, v12
    v_max_f32 v13, v13, v12
    v_sub_f32 v56, 0, v13
    v_mov_b32 v72, 0
    v_sub_f32 v57, 0, v13
    v_mov_b32 v73, 0
    v_sub_f32 v58, 0, v13
    v_mov_b32 v74, 0
    v_sub_f32 v59, 0, v13
    v_mov_b32 v75, 0
    v_sub_f32 v60, 0, v13
    v_mov_b32 v76, 0
    v_sub_f32 v61, 0, v13
    v_mov_b32 v77, 0
    v_sub_f32 v62, 0, v13
    v_mov_b32 v78, 0
    v_sub_f32 v63, 0, v13
    v_mov_b32 v79, 0
    v_sub_f32 v64, 0, v13
    v_mov_b32 v80, 0
    v_sub_f32 v65, 0, v13
    v_mov_b32 v81, 0
    v_sub_f32 v66, 0, v13
    v_mov_b32 v82, 0
    v_sub_f32 v67, 0, v13
    v_mov_b32 v83, 0
    v_sub_f32 v68, 0, v13
    v_mov_b32 v84, 0
    v_sub_f32 v69, 0, v13
    v_mov_b32 v85, 0
    v_sub_f32 v70, 0, v13
    v_mov_b32 v86, 0
    v_sub_f32 v71, 0, v13
    v_mov_b32 v87, 0
    s_mov_b32 s68, 262144
L_sl2_137:
    buffer_load_dwordx4 v[104:107], v1, s[44:47], s68 offen sc1
    s_mov_b64 exec, s[66:67]
    buffer_load_dwordx4 v[108:111], v1, s[44:47], s68 offen offset:1024 sc1
    buffer_load_dwordx4 v[112:115], v1, s[44:47], s68 offen offset:1536 sc1
    s_mov_b64 exec, -1
    s_waitcnt vmcnt(0)
    v_max3_u32 v12, v104, v108, v112
    v_cmp_eq_u32 vcc, -1, v12
    s_cbranch_vccz L_sl2go_138
    s_cmp_eq_u32 s62, 0
    s_cbranch_scc1 L_sl2go_138
    s_sub_u32 s62, s62, 1
    s_branch L_sl2_137
L_sl2go_138:
    v_mfma_f32_32x32x16_bf16 v[40:55], v[104:107], v[16:19], v[56:71]
    s_nop 11
    v_exp_f32 v40, v40
    v_exp_f32 v41, v41
    v_exp_f32 v42, v42
    v_exp_f32 v43, v43
    v_exp_f32 v44, v44
    v_exp_f32 v45, v45
    v_exp_f32 v46, v46
    v_exp_f32 v47, v47
    v_exp_f32 v48, v48
    v_exp_f32 v49, v49
    v_exp_f32 v50, v50
    v_exp_f32 v51, v51
    v_exp_f32 v52, v52
    v_exp_f32 v53, v53
    v_exp_f32 v54, v54
    v_exp_f32 v55, v55
    v_smfmac_f32_32x32x32_bf16 v[72:87], v[108:111], v[40:47], v2
    s_nop 0
    v_smfmac_f32_32x32x32_bf16 v[72:87], v[112:115], v[48:55], v2
    s_nop 7
    s_add_u32 s68, s68, 2048
    s_cmp_lt_u32 s68, 393216
    s_cbranch_scc1 L_sl2_137
    s_nop 7
    v_rcp_f32 v80, v80
    s_nop 0
    v_mul_f32 v72, v72, v80
    v_mul_f32 v73, v73, v80
    v_mul_f32 v74, v74, v80
    v_mul_f32 v75, v75, v80
    v_mul_f32 v76, v76, v80
    v_mul_f32 v77, v77, v80
    v_mul_f32 v78, v78, v80
    v_mul_f32 v79, v79, v80
    s_branch L_slow_ret
L_gb_stub_30:
    s_cmp_eq_u32 s62, 0
    s_cbranch_scc1 L_gb_ok_29
    s_sub_u32 s62, s62, 1
    s_waitcnt vmcnt(0)
    s_sleep 2
    s_mov_b32 s75, 32768
    buffer_load_dwordx4 v[24:27], v36, s[44:47], s75 offen sc1
    s_mov_b32 s75, 40960
    buffer_load_dwordx4 v[28:31], v36, s[44:47], s75 offen sc1
    s_waitcnt vmcnt(0)
    s_branch L_gb_chk_28
L_o_stub_33:
    s_cmp_eq_u32 s62, 0
    s_cbranch_scc1 L_o_ok_32
    s_sub_u32 s62, s62, 1
    s_waitcnt vmcnt(0)
    s_sleep 2
    s_xor_b32 s75, s79, 0
    buffer_load_dwordx4 v[88:91], v1, s[44:47], s75 offen sc1
    s_xor_b32 s75, s79, 1024
    buffer_load_dwordx4 v[92:95], v1, s[44:47], s75 offen sc1
    s_xor_b32 s75, s79, 2048
    buffer_load_dwordx4 v[96:99], v1, s[44:47], s75 offen sc1
    s_xor_b32 s75, s79, 3072
    buffer_load_dwordx4 v[100:103], v1, s[44:47], s75 offen sc1
    s_xor_b32 s75, s79, 4096
    buffer_load_dwordx4 v[104:107], v1, s[44:47], s75 offen sc1
    s_xor_b32 s75, s79, 5120
    buffer_load_dwordx4 v[108:111], v1, s[44:47], s75 offen sc1
    s_xor_b32 s75, s79, 6144
    buffer_load_dwordx4 v[112:115], v1, s[44:47], s75 offen sc1
    s_xor_b32 s75, s79, 7168
    buffer_load_dwordx4 v[116:119], v1, s[44:47], s75 offen sc1
    s_waitcnt vmcnt(0)
    v_max_u32 v14, v88, v92
    v_cmp_eq_u32 vcc, -1, v14
    s_cbranch_vccnz L_o_stub_33
    s_branch L_o_ok_32
L_o_stub_35:
    s_cmp_eq_u32 s62, 0
    s_cbranch_scc1 L_o_ok_34
    s_sub_u32 s62, s62, 1
    s_waitcnt vmcnt(0)
    s_sleep 2
    s_xor_b32 s75, s79, 2048
    buffer_load_dwordx4 v[96:99], v1, s[44:47], s75 offen sc1
    s_xor_b32 s75, s79, 3072
    buffer_load_dwordx4 v[100:103], v1, s[44:47], s75 offen sc1
    s_xor_b32 s75, s79, 4096
    buffer_load_dwordx4 v[104:107], v1, s[44:47], s75 offen sc1
    s_xor_b32 s75, s79, 5120
    buffer_load_dwordx4 v[108:111], v1, s[44:47], s75 offen sc1
    s_xor_b32 s75, s79, 6144
    buffer_load_dwordx4 v[112:115], v1, s[44:47], s75 offen sc1
    s_xor_b32 s75, s79, 7168
    buffer_load_dwordx4 v[116:119], v1, s[44:47], s75 offen sc1
    s_waitcnt vmcnt(0)
    v_max_u32 v14, v96, v100
    v_cmp_eq_u32 vcc, -1, v14
    s_cbranch_vccnz L_o_stub_35
    s_branch L_o_ok_34
L_o_stub_37:
    s_cmp_eq_u32 s62, 0
    s_cbranch_scc1 L_o_ok_36
    s_sub_u32 s62, s62, 1
    s_waitcnt vmcnt(0)
    s_sleep 2
    s_xor_b32 s75, s79, 4096
    buffer_load_dwordx4 v[104:107], v1, s[44:47], s75 offen sc1
    s_xor_b32 s75, s79, 5120
    buffer_load_dwordx4 v[108:111], v1, s[44:47], s75 offen sc1
    s_xor_b32 s75, s79, 6144
    buffer_load_dwordx4 v[112:115], v1, s[44:47], s75 offen sc1
    s_xor_b32 s75, s79, 7168
    buffer_load_dwordx4 v[116:119], v1, s[44:47], s75 offen sc1
    s_waitcnt vmcnt(0)
    v_max_u32 v14, v104, v108
    v_cmp_eq_u32 vcc, -1, v14
    s_cbranch_vccnz L_o_stub_37
    s_branch L_o_ok_36
L_o_stub_39:
    s_cmp_eq_u32 s62, 0
    s_cbranch_scc1 L_o_ok_38
    s_sub_u32 s62, s62, 1
    s_waitcnt vmcnt(0)
    s_sleep 2
    s_xor_b32 s75, s79, 6144
    buffer_load_dwordx4 v[112:115], v1, s[44:47], s75 offen sc1
    s_xor_b32 s75, s79, 7168
    buffer_load_dwordx4 v[116:119], v1, s[44:47], s75 offen sc1
    s_waitcnt vmcnt(0)
    v_max_u32 v14, v112, v116
    v_cmp_eq_u32 vcc, -1, v14
    s_cbranch_vccnz L_o_stub_39
    s_branch L_o_ok_38
L_y_stub_43:
    s_cmp_eq_u32 s62, 0
    s_cbranch_scc1 L_y_ok_42
    s_sub_u32 s62, s62, 1
    s_waitcnt vmcnt(0)
    s_sleep 2
    s_xor_b32 s75, s8, 0
    buffer_load_dwordx4 v[128:131], v1, s[44:47], s75 offen offset:0 sc1
    s_xor_b32 s75, s8, 0
    buffer_load_dwordx4 v[132:135], v1, s[44:47], s75 offen offset:1024 sc1
    s_xor_b32 s75, s8, 0
    buffer_load_dwordx4 v[136:139], v1, s[44:47], s75 offen offset:2048 sc1
    s_xor_b32 s75, s8, 0
    buffer_load_dwordx4 v[140:143], v1, s[44:47], s75 offen offset:3072 sc1
    s_xor_b32 s75, s8, 4096
    buffer_load_dwordx4 v[144:147], v1, s[44:47], s75 offen offset:0 sc1
    s_xor_b32 s75, s8, 4096
    buffer_load_dwordx4 v[148:151], v1, s[44:47], s75 offen offset:1024 sc1
    s_xor_b32 s75, s8, 4096
    buffer_load_dwordx4 v[152:155], v1, s[44:47], s75 offen offset:2048 sc1
    s_waitcnt vmcnt(0)
    v_max3_u32 v14, v128, v132, v136
    v_max_u32 v14, v14, v140
    v_cmp_eq_u32 vcc, -1, v14
    s_cbranch_vccnz L_y_stub_43
    s_branch L_y_ok_42
L_y_stub_45:
    s_cmp_eq_u32 s62, 0
    s_cbranch_scc1 L_y_ok_44
    s_sub_u32 s62, s62, 1
    s_waitcnt vmcnt(0)
    s_sleep 2
    s_xor_b32 s75, s8, 4096
    buffer_load_dwordx4 v[144:147], v1, s[44:47], s75 offen offset:0 sc1
    s_xor_b32 s75, s8, 4096
    buffer_load_dwordx4 v[148:151], v1, s[44:47], s75 offen offset:1024 sc1
    s_xor_b32 s75, s8, 4096
    buffer_load_dwordx4 v[152:155], v1, s[44:47], s75 offen offset:2048 sc1
    s_xor_b32 s75, s8, 4096
    buffer_load_dwordx4 v[156:159], v1, s[44:47], s75 offen offset:3072 sc1
    s_xor_b32 s75, s8, 8192
    buffer_load_dwordx4 v[160:163], v1, s[44:47], s75 offen offset:0 sc1
    s_xor_b32 s75, s8, 8192
    buffer_load_dwordx4 v[164:167], v1, s[44:47], s75 offen offset:1024 sc1
    s_xor_b32 s75, s8, 8192
    buffer_load_dwordx4 v[168:171], v1, s[44:47], s75 offen offset:2048 sc1
    s_xor_b32 s75, s8, 8192
    buffer_load_dwordx4 v[172:175], v1, s[44:47], s75 offen offset:3072 sc1
    s_xor_b32 s75, s8, 12288
    buffer_load_dwordx4 v[176:179], v1, s[44:47], s75 offen offset:0 sc1
    s_waitcnt vmcnt(0)
    v_max3_u32 v14, v144, v148, v152
    v_max_u32 v14, v14, v156
    v_cmp_eq_u32 vcc, -1, v14
    s_cbranch_vccnz L_y_stub_45
    s_branch L_y_ok_44
L_y_stub_47:
    s_cmp_eq_u32 s62, 0
    s_cbranch_scc1 L_y_ok_46
    s_sub_u32 s62, s62, 1
    s_waitcnt vmcnt(0)
    s_sleep 2
    s_xor_b32 s75, s8, 8192
    buffer_load_dwordx4 v[160:163], v1, s[44:47], s75 offen offset:0 sc1
    s_xor_b32 s75, s8, 8192
    buffer_load_dwordx4 v[164:167], v1, s[44:47], s75 offen offset:1024 sc1
    s_xor_b32 s75, s8, 8192
    buffer_load_dwordx4 v[168:171], v1, s[44:47], s75 offen offset:2048 sc1
    s_xor_b32 s75, s8, 8192
    buffer_load_dwordx4 v[172:175], v1, s[44:47], s75 offen offset:3072 sc1
    s_xor_b32 s75, s8, 12288
    buffer_load_dwordx4 v[176:179], v1, s[44:47], s75 offen offset:0 sc1
    s_xor_b32 s75, s8, 12288
    buffer_load_dwordx4 v[180:183], v1, s[44:47], s75 offen offset:1024 sc1
    s_xor_b32 s75, s8, 12288
    buffer_load_dwordx4 v[184:187], v1, s[44:47], s75 offen offset:2048 sc1
    s_xor_b32 s75, s8, 12288
    buffer_load_dwordx4 v[188:191], v1, s[44:47], s75 offen offset:3072 sc1
    s_xor_b32 s75, s8, 16384
    buffer_load_dwordx4 v[128:131], v1, s[44:47], s75 offen offset:0 sc1
    s_waitcnt vmcnt(0)
    v_max3_u32 v14, v160, v164, v168
    v_max_u32 v14, v14, v172
    v_cmp_eq_u32 vcc, -1, v14
    s_cbranch_vccnz L_y_stub_47
    s_branch L_y_ok_46
L_y_stub_49:
    s_cmp_eq_u32 s62, 0
    s_cbranch_scc1 L_y_ok_48
    s_sub_u32 s62, s62, 1
    s_waitcnt vmcnt(0)
    s_sleep 2
    s_xor_b32 s75, s8, 12288
    buffer_load_dwordx4 v[176:179], v1, s[44:47], s75 offen offset:0 sc1
    s_xor_b32 s75, s8, 12288
    buffer_load_dwordx4 v[180:183], v1, s[44:47], s75 offen offset:1024 sc1
    s_xor_b32 s75, s8, 12288
    buffer_load_dwordx4 v[184:187], v1, s[44:47], s75 offen offset:2048 sc1
    s_xor_b32 s75, s8, 12288
    buffer_load_dwordx4 v[188:191], v1, s[44:47], s75 offen offset:3072 sc1
    s_xor_b32 s75, s8, 16384
    buffer_load_dwordx4 v[128:131], v1, s[44:47], s75 offen offset:0 sc1
    s_xor_b32 s75, s8, 16384
    buffer_load_dwordx4 v[132:135], v1, s[44:47], s75 offen offset:1024 sc1
    s_xor_b32 s75, s8, 16384
    buffer_load_dwordx4 v[136:139], v1, s[44:47], s75 offen offset:2048 sc1
    s_xor_b32 s75, s8, 16384
    buffer_load_dwordx4 v[140:143], v1, s[44:47], s75 offen offset:3072 sc1
    s_xor_b32 s75, s8, 20480
    buffer_load_dwordx4 v[144:147], v1, s[44:47], s75 offen offset:0 sc1
    s_waitcnt vmcnt(0)
    v_max3_u32 v14, v176, v180, v184
    v_max_u32 v14, v14, v188
    v_cmp_eq_u32 vcc, -1, v14
    s_cbranch_vccnz L_y_stub_49
    s_branch L_y_ok_48
L_y_stub_51:
    s_cmp_eq_u32 s62, 0
    s_cbranch_scc1 L_y_ok_50
    s_sub_u32 s62, s62, 1
    s_waitcnt vmcnt(0)
    s_sleep 2
    s_xor_b32 s75, s8, 16384
    buffer_load_dwordx4 v[128:131], v1, s[44:47], s75 offen offset:0 sc1
    s_xor_b32 s75, s8, 16384
    buffer_load_dwordx4 v[132:135], v1, s[44:47], s75 offen offset:1024 sc1
    s_xor_b32 s75, s8, 16384
    buffer_load_dwordx4 v[136:139], v1, s[44:47], s75 offen offset:2048 sc1
    s_xor_b32 s75, s8, 16384
    buffer_load_dwordx4 v[140:143], v1, s[44:47], s75 offen offset:3072 sc1
    s_xor_b32 s75, s8, 20480
    buffer_load_dwordx4 v[144:147], v1, s[44:47], s75 offen offset:0 sc1
    s_xor_b32 s75, s8, 20480
    buffer_load_dwordx4 v[148:151], v1, s[44:47], s75 offen offset:1024 sc1
    s_xor_b32 s75, s8, 20480
    buffer_load_dwordx4 v[152:155], v1, s[44:47], s75 offen offset:2048 sc1
    s_xor_b32 s75, s8, 20480
    buffer_load_dwordx4 v[156:159], v1, s[44:47], s75 offen offset:3072 sc1
    s_xor_b32 s75, s8, 24576
    buffer_load_dwordx4 v[160:163], v1, s[44:47], s75 offen offset:0 sc1
    s_waitcnt vmcnt(0)
    v_max3_u32 v14, v128, v132, v136
    v_max_u32 v14, v14, v140
    v_cmp_eq_u32 vcc, -1, v14
    s_cbranch_vccnz L_y_stub_51
    s_branch L_y_ok_50
L_y_stub_53:
    s_cmp_eq_u32 s62, 0
    s_cbranch_scc1 L_y_ok_52
    s_sub_u32 s62, s62, 1
    s_waitcnt vmcnt(0)
    s_sleep 2
    s_xor_b32 s75, s8, 20480
    buffer_load_dwordx4 v[144:147], v1, s[44:47], s75 offen offset:0 sc1
    s_xor_b32 s75, s8, 20480
    buffer_load_dwordx4 v[148:151], v1, s[44:47], s75 offen offset:1024 sc1
    s_xor_b32 s75, s8, 20480
    buffer_load_dwordx4 v[152:155], v1, s[44:47], s75 offen offset:2048 sc1
    s_xor_b32 s75, s8, 20480
    buffer_load_dwordx4 v[156:159], v1, s[44:47], s75 offen offset:3072 sc1
    s_xor_b32 s75, s8, 24576
    buffer_load_dwordx4 v[160:163], v1, s[44:47], s75 offen offset:0 sc1
    s_xor_b32 s75, s8, 24576
    buffer_load_dwordx4 v[164:167], v1, s[44:47], s75 offen offset:1024 sc1
    s_xor_b32 s75, s8, 24576
    buffer_load_dwordx4 v[168:171], v1, s[44:47], s75 offen offset:2048 sc1
    s_xor_b32 s75, s8, 24576
    buffer_load_dwordx4 v[172:175], v1, s[44:47], s75 offen offset:3072 sc1
    s_xor_b32 s75, s8, 28672
    buffer_load_dwordx4 v[176:179], v1, s[44:47], s75 offen offset:0 sc1
    s_waitcnt vmcnt(0)
    v_max3_u32 v14, v144, v148, v152
    v_max_u32 v14, v14, v156
    v_cmp_eq_u32 vcc, -1, v14
    s_cbranch_vccnz L_y_stub_53
    s_branch L_y_ok_52
L_st_stub_55:
    s_cmp_eq_u32 s62, 0
    s_cbranch_scc1 L_st_ok_54
    s_sub_u32 s62, s62, 1
    s_waitcnt vmcnt(0)
    s_sleep 2
    buffer_load_dwordx2 v[32:33], v126, s[44:47], s73 offen offset:0 sc1
    buffer_load_dwordx2 v[34:35], v126, s[44:47], s73 offen offset:256 sc1
    buffer_load_dwordx2 v[36:37], v126, s[44:47], s73 offen offset:512 sc1
    buffer_load_dwordx2 v[38:39], v126, s[44:47], s73 offen offset:768 sc1
    s_waitcnt vmcnt(0)
    v_max3_u32 v14, v32, v34, v36
    v_max_u32 v14, v14, v38
    v_cmp_eq_u32 vcc, -1, v14
    s_cbranch_vccnz L_st_stub_55
    s_branch L_st_ok_54
L_y_stub_57:
    s_cmp_eq_u32 s62, 0
    s_cbranch_scc1 L_y_ok_56
    s_sub_u32 s62, s62, 1
    s_waitcnt vmcnt(0)
    s_sleep 2
    s_xor_b32 s75, s8, 24576
    buffer_load_dwordx4 v[160:163], v1, s[44:47], s75 offen offset:0 sc1
    s_xor_b32 s75, s8, 24576
    buffer_load_dwordx4 v[164:167], v1, s[44:47], s75 offen offset:1024 sc1
    s_xor_b32 s75, s8, 24576
    buffer_load_dwordx4 v[168:171], v1, s[44:47], s75 offen offset:2048 sc1
    s_xor_b32 s75, s8, 24576
    buffer_load_dwordx4 v[172:175], v1, s[44:47], s75 offen offset:3072 sc1
    s_xor_b32 s75, s8, 28672
    buffer_load_dwordx4 v[176:179], v1, s[44:47], s75 offen offset:0 sc1
    s_xor_b32 s75, s8, 28672
    buffer_load_dwordx4 v[180:183], v1, s[44:47], s75 offen offset:1024 sc1
    s_xor_b32 s75, s8, 28672
    buffer_load_dwordx4 v[184:187], v1, s[44:47], s75 offen offset:2048 sc1
    s_xor_b32 s75, s8, 28672
    buffer_load_dwordx4 v[188:191], v1, s[44:47], s75 offen offset:3072 sc1
    s_waitcnt vmcnt(0)
    v_max3_u32 v14, v160, v164, v168
    v_max_u32 v14, v14, v172
    v_cmp_eq_u32 vcc, -1, v14
    s_cbranch_vccnz L_y_stub_57
    s_branch L_y_ok_56
L_y_stub_59:
    s_cmp_eq_u32 s62, 0
    s_cbranch_scc1 L_y_ok_58
    s_sub_u32 s62, s62, 1
    s_waitcnt vmcnt(0)
    s_sleep 2
    s_xor_b32 s75, s8, 28672
    buffer_load_dwordx4 v[176:179], v1, s[44:47], s75 offen offset:0 sc1
    s_xor_b32 s75, s8, 28672
    buffer_load_dwordx4 v[180:183], v1, s[44:47], s75 offen offset:1024 sc1
    s_xor_b32 s75, s8, 28672
    buffer_load_dwordx4 v[184:187], v1, s[44:47], s75 offen offset:2048 sc1
    s_xor_b32 s75, s8, 28672
    buffer_load_dwordx4 v[188:191], v1, s[44:47], s75 offen offset:3072 sc1
    s_waitcnt vmcnt(0)
    v_max3_u32 v14, v176, v180, v184
    v_max_u32 v14, v14, v188
    v_cmp_eq_u32 vcc, -1, v14
    s_cbranch_vccnz L_y_stub_59
    s_branch L_y_ok_58
L_g_skipe:
    s_cmp_lg_u32 s55, 3
    s_cbranch_scc1 L_nost_139
    s_lshl_b32 s68, s56, 10
    s_add_u32 s68, s68, 160256
    v_lshl_add_u32 v14, v0, 2, s68
    ds_read2st64_b32 v[32:33], v14 offset0:0 offset1:1
    ds_read2st64_b32 v[34:35], v14 offset0:2 offset1:3
    s_waitcnt lgkmcnt(0)
    v_add_f32 v32, v32, v34
    v_add_f32 v33, v33, v35
    v_add_f32 v32, v32, v33
    buffer_store_dword v32, v7, s[44:47], 0 offen sc1
L_nost_139:
    v_and_b32 v14, 7, v0
    v_lshlrev_b32 v14, 12, v14
L_ypoll_141:
    s_sleep 4
    buffer_load_dword v40, v14, s[44:47], s74 offen sc1
    s_sub_u32 s62, s62, 1
    s_max_i32 s62, s62, 0
    s_waitcnt vmcnt(0)
    s_cmp_eq_u32 s62, 0
    s_cbranch_scc1 L_skb_140
    v_cmp_eq_u32 vcc, -1, v40
    s_cbranch_vccnz L_ypoll_141
L_skb_140:
    s_barrier
    ds_read_b64_tr_b16 v[128:129], v120 offset:0
    ds_read_b64_tr_b16 v[130:131], v120 offset:4096
    ds_read_b64_tr_b16 v[132:133], v121 offset:0
    ds_read_b64_tr_b16 v[134:135], v121 offset:4096
    ds_read_b64_tr_b16 v[136:137], v120 offset:8192
    ds_read_b64_tr_b16 v[138:139], v120 offset:12288
    ds_read_b64_tr_b16 v[140:141], v121 offset:8192
    ds_read_b64_tr_b16 v[142:143], v121 offset:12288
    ds_read_b64_tr_b16 v[144:145], v120 offset:16384
    ds_read_b64_tr_b16 v[146:147], v120 offset:20480
    ds_read_b64_tr_b16 v[148:149], v121 offset:16384
    ds_read_b64_tr_b16 v[150:151], v121 offset:20480
    ds_read_b64_tr_b16 v[152:153], v120 offset:24576
    ds_read_b64_tr_b16 v[154:155], v120 offset:28672
    ds_read_b64_tr_b16 v[156:157], v121 offset:24576
    ds_read_b64_tr_b16 v[158:159], v121 offset:28672
    s_waitcnt lgkmcnt(0)
    s_branch L_g_donee
L_h_stub_63:
    s_cmp_eq_u32 s62, 0
    s_cbranch_scc1 L_h_ok_62
    s_sub_u32 s62, s62, 1
    s_waitcnt vmcnt(0)
    s_sleep 2
    s_cmp_gt_u32 s82, 0
    s_cselect_b32 s75, s79, s83
    s_add_u32 s75, s75, 0
    buffer_load_dwordx4 v[72:75], v1, s[44:47], s75 offen sc1
    s_cmp_gt_u32 s82, 1
    s_cselect_b32 s75, s79, s83
    s_add_u32 s75, s75, 1024
    buffer_load_dwordx4 v[76:79], v1, s[44:47], s75 offen sc1
    s_cmp_gt_u32 s82, 2
    s_cselect_b32 s75, s79, s83
    s_add_u32 s75, s75, 2048
    buffer_load_dwordx4 v[80:83], v1, s[44:47], s75 offen sc1
    s_cmp_gt_u32 s82, 3
    s_cselect_b32 s75, s79, s83
    s_add_u32 s75, s75, 3072
    buffer_load_dwordx4 v[84:87], v1, s[44:47], s75 offen sc1
    s_cmp_gt_u32 s82, 4
    s_cselect_b32 s75, s79, s83
    s_add_u32 s75, s75, 4096
    buffer_load_dwordx4 v[88:91], v1, s[44:47], s75 offen sc1
    s_cmp_gt_u32 s82, 5
    s_cselect_b32 s75, s79, s83
    s_add_u32 s75, s75, 5120
    buffer_load_dwordx4 v[92:95], v1, s[44:47], s75 offen sc1
    s_waitcnt vmcnt(0)
    v_max_u32 v14, v72, v76
    v_cmp_eq_u32 vcc, -1, v14
    s_cbranch_vccnz L_h_stub_63
    s_branch L_h_ok_62
L_h_stub_65:
    s_cmp_eq_u32 s62, 0
    s_cbranch_scc1 L_h_ok_64
    s_sub_u32 s62, s62, 1
    s_waitcnt vmcnt(0)
    s_sleep 2
    s_cmp_gt_u32 s82, 2
    s_cselect_b32 s75, s79, s83
    s_add_u32 s75, s75, 2048
    buffer_load_dwordx4 v[80:83], v1, s[44:47], s75 offen sc1
    s_cmp_gt_u32 s82, 3
    s_cselect_b32 s75, s79, s83
    s_add_u32 s75, s75, 3072
    buffer_load_dwordx4 v[84:87], v1, s[44:47], s75 offen sc1
    s_cmp_gt_u32 s82, 4
    s_cselect_b32 s75, s79, s83
    s_add_u32 s75, s75, 4096
    buffer_load_dwordx4 v[88:91], v1, s[44:47], s75 offen sc1
    s_cmp_gt_u32 s82, 5
    s_cselect_b32 s75, s79, s83
    s_add_u32 s75, s75, 5120
    buffer_load_dwordx4 v[92:95], v1, s[44:47], s75 offen sc1
    s_cmp_gt_u32 s82, 6
    s_cselect_b32 s75, s79, s83
    s_add_u32 s75, s75, 6144
    buffer_load_dwordx4 v[96:99], v1, s[44:47], s75 offen sc1
    s_cmp_gt_u32 s82, 7
    s_cselect_b32 s75, s79, s83
    s_add_u32 s75, s75, 7168
    buffer_load_dwordx4 v[100:103], v1, s[44:47], s75 offen sc1
    s_waitcnt vmcnt(0)
    v_max_u32 v14, v80, v84
    v_cmp_eq_u32 vcc, -1, v14
    s_cbranch_vccnz L_h_stub_65
    s_branch L_h_ok_64
L_h_stub_67:
    s_cmp_eq_u32 s62, 0
    s_cbranch_scc1 L_h_ok_66
    s_sub_u32 s62, s62, 1
    s_waitcnt vmcnt(0)
    s_sleep 2
    s_cmp_gt_u32 s82, 4
    s_cselect_b32 s75, s79, s83
    s_add_u32 s75, s75, 4096
    buffer_load_dwordx4 v[88:91], v1, s[44:47], s75 offen sc1
    s_cmp_gt_u32 s82, 5
    s_cselect_b32 s75, s79, s83
    s_add_u32 s75, s75, 5120
    buffer_load_dwordx4 v[92:95], v1, s[44:47], s75 offen sc1
    s_cmp_gt_u32 s82, 6
    s_cselect_b32 s75, s79, s83
    s_add_u32 s75, s75, 6144
    buffer_load_dwordx4 v[96:99], v1, s[44:47], s75 offen sc1
    s_cmp_gt_u32 s82, 7
    s_cselect_b32 s75, s79, s83
    s_add_u32 s75, s75, 7168
    buffer_load_dwordx4 v[100:103], v1, s[44:47], s75 offen sc1
    s_cmp_gt_u32 s82, 8
    s_cselect_b32 s75, s79, s83
    s_add_u32 s75, s75, 8192
    buffer_load_dwordx4 v[104:107], v1, s[44:47], s75 offen sc1
    s_cmp_gt_u32 s82, 9
    s_cselect_b32 s75, s79, s83
    s_add_u32 s75, s75, 9216
    buffer_load_dwordx4 v[108:111], v1, s[44:47], s75 offen sc1
    s_waitcnt vmcnt(0)
    v_max_u32 v14, v88, v92
    v_cmp_eq_u32 vcc, -1, v14
    s_cbranch_vccnz L_h_stub_67
    s_branch L_h_ok_66
L_h_stub_69:
    s_cmp_eq_u32 s62, 0
    s_cbranch_scc1 L_h_ok_68
    s_sub_u32 s62, s62, 1
    s_waitcnt vmcnt(0)
    s_sleep 2
    s_cmp_gt_u32 s82, 6
    s_cselect_b32 s75, s79, s83
    s_add_u32 s75, s75, 6144
    buffer_load_dwordx4 v[96:99], v1, s[44:47], s75 offen sc1
    s_cmp_gt_u32 s82, 7
    s_cselect_b32 s75, s79, s83
    s_add_u32 s75, s75, 7168
    buffer_load_dwordx4 v[100:103], v1, s[44:47], s75 offen sc1
    s_cmp_gt_u32 s82, 8
    s_cselect_b32 s75, s79, s83
    s_add_u32 s75, s75, 8192
    buffer_load_dwordx4 v[104:107], v1, s[44:47], s75 offen sc1
    s_cmp_gt_u32 s82, 9
    s_cselect_b32 s75, s79, s83
    s_add_u32 s75, s75, 9216
    buffer_load_dwordx4 v[108:111], v1, s[44:47], s75 offen sc1
    s_cmp_gt_u32 s82, 10
    s_cselect_b32 s75, s79, s83
    s_add_u32 s75, s75, 10240
    buffer_load_dwordx4 v[112:115], v1, s[44:47], s75 offen sc1
    s_cmp_gt_u32 s82, 11
    s_cselect_b32 s75, s79, s83
    s_add_u32 s75, s75, 11264
    buffer_load_dwordx4 v[116:119], v1, s[44:47], s75 offen sc1
    s_waitcnt vmcnt(0)
    v_max_u32 v14, v96, v100
    v_cmp_eq_u32 vcc, -1, v14
    s_cbranch_vccnz L_h_stub_69
    s_branch L_h_ok_68
L_h_stub_71:
    s_cmp_eq_u32 s62, 0
    s_cbranch_scc1 L_h_ok_70
    s_sub_u32 s62, s62, 1
    s_waitcnt vmcnt(0)
    s_sleep 2
    s_cmp_gt_u32 s82, 8
    s_cselect_b32 s75, s79, s83
    s_add_u32 s75, s75, 8192
    buffer_load_dwordx4 v[104:107], v1, s[44:47], s75 offen sc1
    s_cmp_gt_u32 s82, 9
    s_cselect_b32 s75, s79, s83
    s_add_u32 s75, s75, 9216
    buffer_load_dwordx4 v[108:111], v1, s[44:47], s75 offen sc1
    s_cmp_gt_u32 s82, 10
    s_cselect_b32 s75, s79, s83
    s_add_u32 s75, s75, 10240
    buffer_load_dwordx4 v[112:115], v1, s[44:47], s75 offen sc1
    s_cmp_gt_u32 s82, 11
    s_cselect_b32 s75, s79, s83
    s_add_u32 s75, s75, 11264
    buffer_load_dwordx4 v[116:119], v1, s[44:47], s75 offen sc1
    s_cmp_gt_u32 s82, 12
    s_cselect_b32 s75, s79, s83
    s_add_u32 s75, s75, 12288
    buffer_load_dwordx4 v[120:123], v1, s[44:47], s75 offen sc1
    s_cmp_gt_u32 s82, 13
    s_cselect_b32 s75, s79, s83
    s_add_u32 s75, s75, 13312
    buffer_load_dwordx4 v[124:127], v1, s[44:47], s75 offen sc1
    s_waitcnt vmcnt(0)
    v_max_u32 v14, v104, v108
    v_cmp_eq_u32 vcc, -1, v14
    s_cbranch_vccnz L_h_stub_71
    s_branch L_h_ok_70
L_h_stub_73:
    s_cmp_eq_u32 s62, 0
    s_cbranch_scc1 L_h_ok_72
    s_sub_u32 s62, s62, 1
    s_waitcnt vmcnt(0)
    s_sleep 2
    s_cmp_gt_u32 s82, 10
    s_cselect_b32 s75, s79, s83
    s_add_u32 s75, s75, 10240
    buffer_load_dwordx4 v[112:115], v1, s[44:47], s75 offen sc1
    s_cmp_gt_u32 s82, 11
    s_cselect_b32 s75, s79, s83
    s_add_u32 s75, s75, 11264
    buffer_load_dwordx4 v[116:119], v1, s[44:47], s75 offen sc1
    s_cmp_gt_u32 s82, 12
    s_cselect_b32 s75, s79, s83
    s_add_u32 s75, s75, 12288
    buffer_load_dwordx4 v[120:123], v1, s[44:47], s75 offen sc1
    s_cmp_gt_u32 s82, 13
    s_cselect_b32 s75, s79, s83
    s_add_u32 s75, s75, 13312
    buffer_load_dwordx4 v[124:127], v1, s[44:47], s75 offen sc1
    s_cmp_gt_u32 s82, 14
    s_cselect_b32 s75, s79, s83
    s_add_u32 s75, s75, 14336
    buffer_load_dwordx4 v[160:163], v1, s[44:47], s75 offen sc1
    s_cmp_gt_u32 s82, 15
    s_cselect_b32 s75, s79, s83
    s_add_u32 s75, s75, 15360
    buffer_load_dwordx4 v[164:167], v1, s[44:47], s75 offen sc1
    s_waitcnt vmcnt(0)
    v_max_u32 v14, v112, v116
    v_cmp_eq_u32 vcc, -1, v14
    s_cbranch_vccnz L_h_stub_73
    s_branch L_h_ok_72
L_h_stub_75:
    s_cmp_eq_u32 s62, 0
    s_cbranch_scc1 L_h_ok_74
    s_sub_u32 s62, s62, 1
    s_waitcnt vmcnt(0)
    s_sleep 2
    s_cmp_gt_u32 s82, 12
    s_cselect_b32 s75, s79, s83
    s_add_u32 s75, s75, 12288
    buffer_load_dwordx4 v[120:123], v1, s[44:47], s75 offen sc1
    s_cmp_gt_u32 s82, 13
    s_cselect_b32 s75, s79, s83
    s_add_u32 s75, s75, 13312
    buffer_load_dwordx4 v[124:127], v1, s[44:47], s75 offen sc1
    s_cmp_gt_u32 s82, 14
    s_cselect_b32 s75, s79, s83
    s_add_u32 s75, s75, 14336
    buffer_load_dwordx4 v[160:163], v1, s[44:47], s75 offen sc1
    s_cmp_gt_u32 s82, 15
    s_cselect_b32 s75, s79, s83
    s_add_u32 s75, s75, 15360
    buffer_load_dwordx4 v[164:167], v1, s[44:47], s75 offen sc1
    s_cmp_gt_u32 s82, 16
    s_cselect_b32 s75, s79, s83
    s_add_u32 s75, s75, 16384
    buffer_load_dwordx4 v[168:171], v1, s[44:47], s75 offen sc1
    s_cmp_gt_u32 s82, 17
    s_cselect_b32 s75, s79, s83
    s_add_u32 s75, s75, 17408
    buffer_load_dwordx4 v[172:175], v1, s[44:47], s75 offen sc1
    s_waitcnt vmcnt(0)
    v_max_u32 v14, v120, v124
    v_cmp_eq_u32 vcc, -1, v14
    s_cbranch_vccnz L_h_stub_75
    s_branch L_h_ok_74
L_h_stub_77:
    s_cmp_eq_u32 s62, 0
    s_cbranch_scc1 L_h_ok_76
    s_sub_u32 s62, s62, 1
    s_waitcnt vmcnt(0)
    s_sleep 2
    s_cmp_gt_u32 s82, 14
    s_cselect_b32 s75, s79, s83
    s_add_u32 s75, s75, 14336
    buffer_load_dwordx4 v[160:163], v1, s[44:47], s75 offen sc1
    s_cmp_gt_u32 s82, 15
    s_cselect_b32 s75, s79, s83
    s_add_u32 s75, s75, 15360
    buffer_load_dwordx4 v[164:167], v1, s[44:47], s75 offen sc1
    s_cmp_gt_u32 s82, 16
    s_cselect_b32 s75, s79, s83
    s_add_u32 s75, s75, 16384
    buffer_load_dwordx4 v[168:171], v1, s[44:47], s75 offen sc1
    s_cmp_gt_u32 s82, 17
    s_cselect_b32 s75, s79, s83
    s_add_u32 s75, s75, 17408
    buffer_load_dwordx4 v[172:175], v1, s[44:47], s75 offen sc1
    s_cmp_gt_u32 s82, 18
    s_cselect_b32 s75, s79, s83
    s_add_u32 s75, s75, 18432
    buffer_load_dwordx4 v[176:179], v1, s[44:47], s75 offen sc1
    s_cmp_gt_u32 s82, 19
    s_cselect_b32 s75, s79, s83
    s_add_u32 s75, s75, 19456
    buffer_load_dwordx4 v[180:183], v1, s[44:47], s75 offen sc1
    s_waitcnt vmcnt(0)
    v_max_u32 v14, v160, v164
    v_cmp_eq_u32 vcc, -1, v14
    s_cbranch_vccnz L_h_stub_77
    s_branch L_h_ok_76
L_h_stub_79:
    s_cmp_eq_u32 s62, 0
    s_cbranch_scc1 L_h_ok_78
    s_sub_u32 s62, s62, 1
    s_waitcnt vmcnt(0)
    s_sleep 2
    s_cmp_gt_u32 s82, 16
    s_cselect_b32 s75, s79, s83
    s_add_u32 s75, s75, 16384
    buffer_load_dwordx4 v[168:171], v1, s[44:47], s75 offen sc1
    s_cmp_gt_u32 s82, 17
    s_cselect_b32 s75, s79, s83
    s_add_u32 s75, s75, 17408
    buffer_load_dwordx4 v[172:175], v1, s[44:47], s75 offen sc1
    s_cmp_gt_u32 s82, 18
    s_cselect_b32 s75, s79, s83
    s_add_u32 s75, s75, 18432
    buffer_load_dwordx4 v[176:179], v1, s[44:47], s75 offen sc1
    s_cmp_gt_u32 s82, 19
    s_cselect_b32 s75, s79, s83
    s_add_u32 s75, s75, 19456
    buffer_load_dwordx4 v[180:183], v1, s[44:47], s75 offen sc1
    s_cmp_gt_u32 s82, 20
    s_cselect_b32 s75, s79, s83
    s_add_u32 s75, s75, 20480
    buffer_load_dwordx4 v[184:187], v1, s[44:47], s75 offen sc1
    s_cmp_gt_u32 s82, 21
    s_cselect_b32 s75, s79, s83
    s_add_u32 s75, s75, 21504
    s_cmp_lt_u32 s55, 2
    s_cselect_b32 s75, s75, 1073741824
    buffer_load_dwordx4 v[188:191], v1, s[44:47], s75 offen sc1
    s_waitcnt vmcnt(0)
    v_max_u32 v14, v168, v172
    v_cmp_eq_u32 vcc, -1, v14
    s_cbranch_vccnz L_h_stub_79
    s_branch L_h_ok_78
L_h_stub_81:
    s_cmp_eq_u32 s62, 0
    s_cbranch_scc1 L_h_ok_80
    s_sub_u32 s62, s62, 1
    s_waitcnt vmcnt(0)
    s_sleep 2
    s_cmp_gt_u32 s82, 18
    s_cselect_b32 s75, s79, s83
    s_add_u32 s75, s75, 18432
    buffer_load_dwordx4 v[176:179], v1, s[44:47], s75 offen sc1
    s_cmp_gt_u32 s82, 19
    s_cselect_b32 s75, s79, s83
    s_add_u32 s75, s75, 19456
    buffer_load_dwordx4 v[180:183], v1, s[44:47], s75 offen sc1
    s_cmp_gt_u32 s82, 20
    s_cselect_b32 s75, s79, s83
    s_add_u32 s75, s75, 20480
    buffer_load_dwordx4 v[184:187], v1, s[44:47], s75 offen sc1
    s_cmp_gt_u32 s82, 21
    s_cselect_b32 s75, s79, s83
    s_add_u32 s75, s75, 21504
    s_cmp_lt_u32 s55, 2
    s_cselect_b32 s75, s75, 1073741824
    buffer_load_dwordx4 v[188:191], v1, s[44:47], s75 offen sc1
    s_waitcnt vmcnt(0)
    v_max_u32 v14, v176, v180
    v_cmp_eq_u32 vcc, -1, v14
    s_cbranch_vccnz L_h_stub_81
    s_branch L_h_ok_80
L_h_stub_83:
    s_cmp_eq_u32 s62, 0
    s_cbranch_scc1 L_h_ok_82
    s_sub_u32 s62, s62, 1
    s_waitcnt vmcnt(0)
    s_sleep 2
    s_cmp_gt_u32 s82, 20
    s_cselect_b32 s75, s79, s83
    s_add_u32 s75, s75, 20480
    buffer_load_dwordx4 v[184:187], v1, s[44:47], s75 offen sc1
    s_cmp_gt_u32 s82, 21
    s_cselect_b32 s75, s79, s83
    s_add_u32 s75, s75, 21504
    s_cmp_lt_u32 s55, 2
    s_cselect_b32 s75, s75, 1073741824
    buffer_load_dwordx4 v[188:191], v1, s[44:47], s75 offen sc1
    s_waitcnt vmcnt(0)
    v_max_u32 v14, v184, v188
    v_cmp_eq_u32 vcc, -1, v14
    s_cbranch_vccnz L_h_stub_83
    s_branch L_h_ok_82
L_o_stub_85:
    s_cmp_eq_u32 s62, 0
    s_cbranch_scc1 L_o_ok_84
    s_sub_u32 s62, s62, 1
    s_waitcnt vmcnt(0)
    s_sleep 2
    s_xor_b32 s75, s79, 0
    buffer_load_dwordx4 v[88:91], v1, s[44:47], s75 offen sc1
    s_xor_b32 s75, s79, 1024
    buffer_load_dwordx4 v[92:95], v1, s[44:47], s75 offen sc1
    s_xor_b32 s75, s79, 2048
    buffer_load_dwordx4 v[96:99], v1, s[44:47], s75 offen sc1
    s_xor_b32 s75, s79, 3072
    buffer_load_dwordx4 v[100:103], v1, s[44:47], s75 offen sc1
    s_xor_b32 s75, s79, 4096
    buffer_load_dwordx4 v[104:107], v1, s[44:47], s75 offen sc1
    s_xor_b32 s75, s79, 5120
    buffer_load_dwordx4 v[108:111], v1, s[44:47], s75 offen sc1
    s_xor_b32 s75, s79, 6144
    buffer_load_dwordx4 v[112:115], v1, s[44:47], s75 offen sc1
    s_xor_b32 s75, s79, 7168
    buffer_load_dwordx4 v[116:119], v1, s[44:47], s75 offen sc1
    s_waitcnt vmcnt(0)
    v_max_u32 v14, v88, v92
    v_cmp_eq_u32 vcc, -1, v14
    s_cbranch_vccnz L_o_stub_85
    s_branch L_o_ok_84
L_o_stub_87:
    s_cmp_eq_u32 s62, 0
    s_cbranch_scc1 L_o_ok_86
    s_sub_u32 s62, s62, 1
    s_waitcnt vmcnt(0)
    s_sleep 2
    s_xor_b32 s75, s79, 2048
    buffer_load_dwordx4 v[96:99], v1, s[44:47], s75 offen sc1
    s_xor_b32 s75, s79, 3072
    buffer_load_dwordx4 v[100:103], v1, s[44:47], s75 offen sc1
    s_xor_b32 s75, s79, 4096
    buffer_load_dwordx4 v[104:107], v1, s[44:47], s75 offen sc1
    s_xor_b32 s75, s79, 5120
    buffer_load_dwordx4 v[108:111], v1, s[44:47], s75 offen sc1
    s_xor_b32 s75, s79, 6144
    buffer_load_dwordx4 v[112:115], v1, s[44:47], s75 offen sc1
    s_xor_b32 s75, s79, 7168
    buffer_load_dwordx4 v[116:119], v1, s[44:47], s75 offen sc1
    s_waitcnt vmcnt(0)
    v_max_u32 v14, v96, v100
    v_cmp_eq_u32 vcc, -1, v14
    s_cbranch_vccnz L_o_stub_87
    s_branch L_o_ok_86
L_o_stub_89:
    s_cmp_eq_u32 s62, 0
    s_cbranch_scc1 L_o_ok_88
    s_sub_u32 s62, s62, 1
    s_waitcnt vmcnt(0)
    s_sleep 2
    s_xor_b32 s75, s79, 4096
    buffer_load_dwordx4 v[104:107], v1, s[44:47], s75 offen sc1
    s_xor_b32 s75, s79, 5120
    buffer_load_dwordx4 v[108:111], v1, s[44:47], s75 offen sc1
    s_xor_b32 s75, s79, 6144
    buffer_load_dwordx4 v[112:115], v1, s[44:47], s75 offen sc1
    s_xor_b32 s75, s79, 7168
    buffer_load_dwordx4 v[116:119], v1, s[44:47], s75 offen sc1
    s_waitcnt vmcnt(0)
    v_max_u32 v14, v104, v108
    v_cmp_eq_u32 vcc, -1, v14
    s_cbranch_vccnz L_o_stub_89
    s_branch L_o_ok_88
L_o_stub_91:
    s_cmp_eq_u32 s62, 0
    s_cbranch_scc1 L_o_ok_90
    s_sub_u32 s62, s62, 1
    s_waitcnt vmcnt(0)
    s_sleep 2
    s_xor_b32 s75, s79, 6144
    buffer_load_dwordx4 v[112:115], v1, s[44:47], s75 offen sc1
    s_xor_b32 s75, s79, 7168
    buffer_load_dwordx4 v[116:119], v1, s[44:47], s75 offen sc1
    s_waitcnt vmcnt(0)
    v_max_u32 v14, v112, v116
    v_cmp_eq_u32 vcc, -1, v14
    s_cbranch_vccnz L_o_stub_91
    s_branch L_o_ok_90
L_y_stub_94:
    s_cmp_eq_u32 s62, 0
    s_cbranch_scc1 L_y_ok_93
    s_sub_u32 s62, s62, 1
    s_waitcnt vmcnt(0)
    s_sleep 2
    s_xor_b32 s75, s8, 0
    buffer_load_dwordx4 v[128:131], v1, s[44:47], s75 offen offset:0 sc1
    s_xor_b32 s75, s8, 0
    buffer_load_dwordx4 v[132:135], v1, s[44:47], s75 offen offset:1024 sc1
    s_xor_b32 s75, s8, 0
    buffer_load_dwordx4 v[136:139], v1, s[44:47], s75 offen offset:2048 sc1
    s_xor_b32 s75, s8, 0
    buffer_load_dwordx4 v[140:143], v1, s[44:47], s75 offen offset:3072 sc1
    s_xor_b32 s75, s8, 4096
    buffer_load_dwordx4 v[144:147], v1, s[44:47], s75 offen offset:0 sc1
    s_xor_b32 s75, s8, 4096
    buffer_load_dwordx4 v[148:151], v1, s[44:47], s75 offen offset:1024 sc1
    s_xor_b32 s75, s8, 4096
    buffer_load_dwordx4 v[152:155], v1, s[44:47], s75 offen offset:2048 sc1
    s_xor_b32 s75, s8, 4096
    buffer_load_dwordx4 v[156:159], v1, s[44:47], s75 offen offset:3072 sc1
    s_xor_b32 s75, s8, 8192
    buffer_load_dwordx4 v[160:163], v1, s[44:47], s75 offen offset:0 sc1
    s_xor_b32 s75, s8, 8192
    buffer_load_dwordx4 v[164:167], v1, s[44:47], s75 offen offset:1024 sc1
    s_xor_b32 s75, s8, 8192
    buffer_load_dwordx4 v[168:171], v1, s[44:47], s75 offen offset:2048 sc1
    s_xor_b32 s75, s8, 8192
    buffer_load_dwordx4 v[172:175], v1, s[44:47], s75 offen offset:3072 sc1
    s_waitcnt vmcnt(0)
    v_max3_u32 v14, v128, v132, v136
    v_max_u32 v14, v14, v140
    v_cmp_eq_u32 vcc, -1, v14
    s_cbranch_vccnz L_y_stub_94
    s_branch L_y_ok_93
L_y_stub_96:
    s_cmp_eq_u32 s62, 0
    s_cbranch_scc1 L_y_ok_95
    s_sub_u32 s62, s62, 1
    s_waitcnt vmcnt(0)
    s_sleep 2
    s_xor_b32 s75, s8, 4096
    buffer_load_dwordx4 v[144:147], v1, s[44:47], s75 offen offset:0 sc1
    s_xor_b32 s75, s8, 4096
    buffer_load_dwordx4 v[148:151], v1, s[44:47], s75 offen offset:1024 sc1
    s_xor_b32 s75, s8, 4096
    buffer_load_dwordx4 v[152:155], v1, s[44:47], s75 offen offset:2048 sc1
    s_xor_b32 s75, s8, 4096
    buffer_load_dwordx4 v[156:159], v1, s[44:47], s75 offen offset:3072 sc1
    s_xor_b32 s75, s8, 8192
    buffer_load_dwordx4 v[160:163], v1, s[44:47], s75 offen offset:0 sc1
    s_xor_b32 s75, s8, 8192
    buffer_load_dwordx4 v[164:167], v1, s[44:47], s75 offen offset:1024 sc1
    s_xor_b32 s75, s8, 8192
    buffer_load_dwordx4 v[168:171], v1, s[44:47], s75 offen offset:2048 sc1
    s_xor_b32 s75, s8, 8192
    buffer_load_dwordx4 v[172:175], v1, s[44:47], s75 offen offset:3072 sc1
    s_xor_b32 s75, s8, 12288
    buffer_load_dwordx4 v[176:179], v1, s[44:47], s75 offen offset:0 sc1
    s_xor_b32 s75, s8, 12288
    buffer_load_dwordx4 v[180:183], v1, s[44:47], s75 offen offset:1024 sc1
    s_xor_b32 s75, s8, 12288
    buffer_load_dwordx4 v[184:187], v1, s[44:47], s75 offen offset:2048 sc1
    s_xor_b32 s75, s8, 12288
    buffer_load_dwordx4 v[188:191], v1, s[44:47], s75 offen offset:3072 sc1
    s_waitcnt vmcnt(0)
    v_max3_u32 v14, v144, v148, v152
    v_max_u32 v14, v14, v156
    v_cmp_eq_u32 vcc, -1, v14
    s_cbranch_vccnz L_y_stub_96
    s_branch L_y_ok_95
L_y_stub_98:
    s_cmp_eq_u32 s62, 0
    s_cbranch_scc1 L_y_ok_97
    s_sub_u32 s62, s62, 1
    s_waitcnt vmcnt(0)
    s_sleep 2
    s_xor_b32 s75, s8, 8192
    buffer_load_dwordx4 v[160:163], v1, s[44:47], s75 offen offset:0 sc1
    s_xor_b32 s75, s8, 8192
    buffer_load_dwordx4 v[164:167], v1, s[44:47], s75 offen offset:1024 sc1
    s_xor_b32 s75, s8, 8192
    buffer_load_dwordx4 v[168:171], v1, s[44:47], s75 offen offset:2048 sc1
    s_xor_b32 s75, s8, 8192
    buffer_load_dwordx4 v[172:175], v1, s[44:47], s75 offen offset:3072 sc1
    s_xor_b32 s75, s8, 12288
    buffer_load_dwordx4 v[176:179], v1, s[44:47], s75 offen offset:0 sc1
    s_xor_b32 s75, s8, 12288
    buffer_load_dwordx4 v[180:183], v1, s[44:47], s75 offen offset:1024 sc1
    s_xor_b32 s75, s8, 12288
    buffer_load_dwordx4 v[184:187], v1, s[44:47], s75 offen offset:2048 sc1
    s_xor_b32 s75, s8, 12288
    buffer_load_dwordx4 v[188:191], v1, s[44:47], s75 offen offset:3072 sc1
    s_xor_b32 s75, s8, 16384
    buffer_load_dwordx4 v[128:131], v1, s[44:47], s75 offen offset:0 sc1
    s_xor_b32 s75, s8, 16384
    buffer_load_dwordx4 v[132:135], v1, s[44:47], s75 offen offset:1024 sc1
    s_xor_b32 s75, s8, 16384
    buffer_load_dwordx4 v[136:139], v1, s[44:47], s75 offen offset:2048 sc1
    s_xor_b32 s75, s8, 16384
    buffer_load_dwordx4 v[140:143], v1, s[44:47], s75 offen offset:3072 sc1
    s_waitcnt vmcnt(0)
    v_max3_u32 v14, v160, v164, v168
    v_max_u32 v14, v14, v172
    v_cmp_eq_u32 vcc, -1, v14
    s_cbranch_vccnz L_y_stub_98
    s_branch L_y_ok_97
L_y_stub_100:
    s_cmp_eq_u32 s62, 0
    s_cbranch_scc1 L_y_ok_99
    s_sub_u32 s62, s62, 1
    s_waitcnt vmcnt(0)
    s_sleep 2
    s_xor_b32 s75, s8, 12288
    buffer_load_dwordx4 v[176:179], v1, s[44:47], s75 offen offset:0 sc1
    s_xor_b32 s75, s8, 12288
    buffer_load_dwordx4 v[180:183], v1, s[44:47], s75 offen offset:1024 sc1
    s_xor_b32 s75, s8, 12288
    buffer_load_dwordx4 v[184:187], v1, s[44:47], s75 offen offset:2048 sc1
    s_xor_b32 s75, s8, 12288
    buffer_load_dwordx4 v[188:191], v1, s[44:47], s75 offen offset:3072 sc1
    s_xor_b32 s75, s8, 16384
    buffer_load_dwordx4 v[128:131], v1, s[44:47], s75 offen offset:0 sc1
    s_xor_b32 s75, s8, 16384
    buffer_load_dwordx4 v[132:135], v1, s[44:47], s75 offen offset:1024 sc1
    s_xor_b32 s75, s8, 16384
    buffer_load_dwordx4 v[136:139], v1, s[44:47], s75 offen offset:2048 sc1
    s_xor_b32 s75, s8, 16384
    buffer_load_dwordx4 v[140:143], v1, s[44:47], s75 offen offset:3072 sc1
    s_xor_b32 s75, s8, 20480
    buffer_load_dwordx4 v[144:147], v1, s[44:47], s75 offen offset:0 sc1
    s_xor_b32 s75, s8, 20480
    buffer_load_dwordx4 v[148:151], v1, s[44:47], s75 offen offset:1024 sc1
    s_xor_b32 s75, s8, 20480
    buffer_load_dwordx4 v[152:155], v1, s[44:47], s75 offen offset:2048 sc1
    s_xor_b32 s75, s8, 20480
    buffer_load_dwordx4 v[156:159], v1, s[44:47], s75 offen offset:3072 sc1
    s_waitcnt vmcnt(0)
    v_max3_u32 v14, v176, v180, v184
    v_max_u32 v14, v14, v188
    v_cmp_eq_u32 vcc, -1, v14
    s_cbranch_vccnz L_y_stub_100
    s_branch L_y_ok_99
L_y_stub_102:
    s_cmp_eq_u32 s62, 0
    s_cbranch_scc1 L_y_ok_101
    s_sub_u32 s62, s62, 1
    s_waitcnt vmcnt(0)
    s_sleep 2
    s_xor_b32 s75, s8, 16384
    buffer_load_dwordx4 v[128:131], v1, s[44:47], s75 offen offset:0 sc1
    s_xor_b32 s75, s8, 16384
    buffer_load_dwordx4 v[132:135], v1, s[44:47], s75 offen offset:1024 sc1
    s_xor_b32 s75, s8, 16384
    buffer_load_dwordx4 v[136:139], v1, s[44:47], s75 offen offset:2048 sc1
    s_xor_b32 s75, s8, 16384
    buffer_load_dwordx4 v[140:143], v1, s[44:47], s75 offen offset:3072 sc1
    s_xor_b32 s75, s8, 20480
    buffer_load_dwordx4 v[144:147], v1, s[44:47], s75 offen offset:0 sc1
    s_xor_b32 s75, s8, 20480
    buffer_load_dwordx4 v[148:151], v1, s[44:47], s75 offen offset:1024 sc1
    s_xor_b32 s75, s8, 20480
    buffer_load_dwordx4 v[152:155], v1, s[44:47], s75 offen offset:2048 sc1
    s_xor_b32 s75, s8, 20480
    buffer_load_dwordx4 v[156:159], v1, s[44:47], s75 offen offset:3072 sc1
    s_xor_b32 s75, s8, 24576
    buffer_load_dwordx4 v[160:163], v1, s[44:47], s75 offen offset:0 sc1
    s_xor_b32 s75, s8, 24576
    buffer_load_dwordx4 v[164:167], v1, s[44:47], s75 offen offset:1024 sc1
    s_xor_b32 s75, s8, 24576
    buffer_load_dwordx4 v[168:171], v1, s[44:47], s75 offen offset:2048 sc1
    s_xor_b32 s75, s8, 24576
    buffer_load_dwordx4 v[172:175], v1, s[44:47], s75 offen offset:3072 sc1
    s_waitcnt vmcnt(0)
    v_max3_u32 v14, v128, v132, v136
    v_max_u32 v14, v14, v140
    v_cmp_eq_u32 vcc, -1, v14
    s_cbranch_vccnz L_y_stub_102
    s_branch L_y_ok_101
L_y_stub_104:
    s_cmp_eq_u32 s62, 0
    s_cbranch_scc1 L_y_ok_103
    s_sub_u32 s62, s62, 1
    s_waitcnt vmcnt(0)
    s_sleep 2
    s_xor_b32 s75, s8, 20480
    buffer_load_dwordx4 v[144:147], v1, s[44:47], s75 offen offset:0 sc1
    s_xor_b32 s75, s8, 20480
    buffer_load_dwordx4 v[148:151], v1, s[44:47], s75 offen offset:1024 sc1
    s_xor_b32 s75, s8, 20480
    buffer_load_dwordx4 v[152:155], v1, s[44:47], s75 offen offset:2048 sc1
    s_xor_b32 s75, s8, 20480
    buffer_load_dwordx4 v[156:159], v1, s[44:47], s75 offen offset:3072 sc1
    s_xor_b32 s75, s8, 24576
    buffer_load_dwordx4 v[160:163], v1, s[44:47], s75 offen offset:0 sc1
    s_xor_b32 s75, s8, 24576
    buffer_load_dwordx4 v[164:167], v1, s[44:47], s75 offen offset:1024 sc1
    s_xor_b32 s75, s8, 24576
    buffer_load_dwordx4 v[168:171], v1, s[44:47], s75 offen offset:2048 sc1
    s_xor_b32 s75, s8, 24576
    buffer_load_dwordx4 v[172:175], v1, s[44:47], s75 offen offset:3072 sc1
    s_xor_b32 s75, s8, 28672
    buffer_load_dwordx4 v[176:179], v1, s[44:47], s75 offen offset:0 sc1
    s_xor_b32 s75, s8, 28672
    buffer_load_dwordx4 v[180:183], v1, s[44:47], s75 offen offset:1024 sc1
    s_xor_b32 s75, s8, 28672
    buffer_load_dwordx4 v[184:187], v1, s[44:47], s75 offen offset:2048 sc1
    s_xor_b32 s75, s8, 28672
    buffer_load_dwordx4 v[188:191], v1, s[44:47], s75 offen offset:3072 sc1
    s_waitcnt vmcnt(0)
    v_max3_u32 v14, v144, v148, v152
    v_max_u32 v14, v14, v156
    v_cmp_eq_u32 vcc, -1, v14
    s_cbranch_vccnz L_y_stub_104
    s_branch L_y_ok_103
L_st_stub_106:
    s_cmp_eq_u32 s62, 0
    s_cbranch_scc1 L_st_ok_105
    s_sub_u32 s62, s62, 1
    s_waitcnt vmcnt(0)
    s_sleep 2
    buffer_load_dwordx2 v[32:33], v126, s[44:47], s73 offen offset:0 sc1
    buffer_load_dwordx2 v[34:35], v126, s[44:47], s73 offen offset:256 sc1
    buffer_load_dwordx2 v[36:37], v126, s[44:47], s73 offen offset:512 sc1
    buffer_load_dwordx2 v[38:39], v126, s[44:47], s73 offen offset:768 sc1
    s_waitcnt vmcnt(0)
    v_max3_u32 v14, v32, v34, v36
    v_max_u32 v14, v14, v38
    v_cmp_eq_u32 vcc, -1, v14
    s_cbranch_vccnz L_st_stub_106
    s_branch L_st_ok_105
L_y_stub_108:
    s_cmp_eq_u32 s62, 0
    s_cbranch_scc1 L_y_ok_107
    s_sub_u32 s62, s62, 1
    s_waitcnt vmcnt(0)
    s_sleep 2
    s_xor_b32 s75, s8, 24576
    buffer_load_dwordx4 v[160:163], v1, s[44:47], s75 offen offset:0 sc1
    s_xor_b32 s75, s8, 24576
    buffer_load_dwordx4 v[164:167], v1, s[44:47], s75 offen offset:1024 sc1
    s_xor_b32 s75, s8, 24576
    buffer_load_dwordx4 v[168:171], v1, s[44:47], s75 offen offset:2048 sc1
    s_xor_b32 s75, s8, 24576
    buffer_load_dwordx4 v[172:175], v1, s[44:47], s75 offen offset:3072 sc1
    s_xor_b32 s75, s8, 28672
    buffer_load_dwordx4 v[176:179], v1, s[44:47], s75 offen offset:0 sc1
    s_xor_b32 s75, s8, 28672
    buffer_load_dwordx4 v[180:183], v1, s[44:47], s75 offen offset:1024 sc1
    s_xor_b32 s75, s8, 28672
    buffer_load_dwordx4 v[184:187], v1, s[44:47], s75 offen offset:2048 sc1
    s_xor_b32 s75, s8, 28672
    buffer_load_dwordx4 v[188:191], v1, s[44:47], s75 offen offset:3072 sc1
    s_waitcnt vmcnt(0)
    v_max3_u32 v14, v160, v164, v168
    v_max_u32 v14, v14, v172
    v_cmp_eq_u32 vcc, -1, v14
    s_cbranch_vccnz L_y_stub_108
    s_branch L_y_ok_107
L_y_stub_110:
    s_cmp_eq_u32 s62, 0
    s_cbranch_scc1 L_y_ok_109
    s_sub_u32 s62, s62, 1
    s_waitcnt vmcnt(0)
    s_sleep 2
    s_xor_b32 s75, s8, 28672
    buffer_load_dwordx4 v[176:179], v1, s[44:47], s75 offen offset:0 sc1
    s_xor_b32 s75, s8, 28672
    buffer_load_dwordx4 v[180:183], v1, s[44:47], s75 offen offset:1024 sc1
    s_xor_b32 s75, s8, 28672
    buffer_load_dwordx4 v[184:187], v1, s[44:47], s75 offen offset:2048 sc1
    s_xor_b32 s75, s8, 28672
    buffer_load_dwordx4 v[188:191], v1, s[44:47], s75 offen offset:3072 sc1
    s_waitcnt vmcnt(0)
    v_max3_u32 v14, v176, v180, v184
    v_max_u32 v14, v14, v188
    v_cmp_eq_u32 vcc, -1, v14
    s_cbranch_vccnz L_y_stub_110
    s_branch L_y_ok_109
L_g_skipl:
    s_cmp_lg_u32 s55, 3
    s_cbranch_scc1 L_nost_142
    s_lshl_b32 s68, s56, 10
    s_add_u32 s68, s68, 160256
    v_lshl_add_u32 v14, v0, 2, s68
    ds_read2st64_b32 v[32:33], v14 offset0:0 offset1:1
    ds_read2st64_b32 v[34:35], v14 offset0:2 offset1:3
    s_waitcnt lgkmcnt(0)
    v_add_f32 v32, v32, v34
    v_add_f32 v33, v33, v35
    v_add_f32 v32, v32, v33
    buffer_store_dword v32, v7, s[44:47], 0 offen sc1
L_nost_142:
    s_barrier
    s_barrier
    ds_read_b64_tr_b16 v[128:129], v120 offset:0
    ds_read_b64_tr_b16 v[130:131], v120 offset:4096
    ds_read_b64_tr_b16 v[132:133], v121 offset:0
    ds_read_b64_tr_b16 v[134:135], v121 offset:4096
    ds_read_b64_tr_b16 v[136:137], v120 offset:8192
    ds_read_b64_tr_b16 v[138:139], v120 offset:12288
    ds_read_b64_tr_b16 v[140:141], v121 offset:8192
    ds_read_b64_tr_b16 v[142:143], v121 offset:12288
    ds_read_b64_tr_b16 v[144:145], v120 offset:16384
    ds_read_b64_tr_b16 v[146:147], v120 offset:20480
    ds_read_b64_tr_b16 v[148:149], v121 offset:16384
    ds_read_b64_tr_b16 v[150:151], v121 offset:20480
    ds_read_b64_tr_b16 v[152:153], v120 offset:24576
    ds_read_b64_tr_b16 v[154:155], v120 offset:28672
    ds_read_b64_tr_b16 v[156:157], v121 offset:24576
    ds_read_b64_tr_b16 v[158:159], v121 offset:28672
    s_waitcnt lgkmcnt(0)
    s_barrier
    s_branch L_g_donel
L_h_stub_114:
    s_cmp_eq_u32 s62, 0
    s_cbranch_scc1 L_h_ok_113
    s_sub_u32 s62, s62, 1
    s_waitcnt vmcnt(0)
    s_sleep 2
    s_cmp_gt_u32 s82, 0
    s_cselect_b32 s75, s79, s83
    s_add_u32 s75, s75, 0
    buffer_load_dwordx4 v[72:75], v1, s[44:47], s75 offen sc1
    s_cmp_gt_u32 s82, 1
    s_cselect_b32 s75, s79, s83
    s_add_u32 s75, s75, 1024
    buffer_load_dwordx4 v[76:79], v1, s[44:47], s75 offen sc1
    s_cmp_gt_u32 s82, 2
    s_cselect_b32 s75, s79, s83
    s_add_u32 s75, s75, 2048
    buffer_load_dwordx4 v[80:83], v1, s[44:47], s75 offen sc1
    s_cmp_gt_u32 s82, 3
    s_cselect_b32 s75, s79, s83
    s_add_u32 s75, s75, 3072
    buffer_load_dwordx4 v[84:87], v1, s[44:47], s75 offen sc1
    s_cmp_gt_u32 s82, 4
    s_cselect_b32 s75, s79, s83
    s_add_u32 s75, s75, 4096
    buffer_load_dwordx4 v[88:91], v1, s[44:47], s75 offen sc1
    s_cmp_gt_u32 s82, 5
    s_cselect_b32 s75, s79, s83
    s_add_u32 s75, s75, 5120
    buffer_load_dwordx4 v[92:95], v1, s[44:47], s75 offen sc1
    s_waitcnt vmcnt(0)
    v_max_u32 v14, v72, v76
    v_cmp_eq_u32 vcc, -1, v14
    s_cbranch_vccnz L_h_stub_114
    s_branch L_h_ok_113
L_h_stub_116:
    s_cmp_eq_u32 s62, 0
    s_cbranch_scc1 L_h_ok_115
    s_sub_u32 s62, s62, 1
    s_waitcnt vmcnt(0)
    s_sleep 2
    s_cmp_gt_u32 s82, 2
    s_cselect_b32 s75, s79, s83
    s_add_u32 s75, s75, 2048
    buffer_load_dwordx4 v[80:83], v1, s[44:47], s75 offen sc1
    s_cmp_gt_u32 s82, 3
    s_cselect_b32 s75, s79, s83
    s_add_u32 s75, s75, 3072
    buffer_load_dwordx4 v[84:87], v1, s[44:47], s75 offen sc1
    s_cmp_gt_u32 s82, 4
    s_cselect_b32 s75, s79, s83
    s_add_u32 s75, s75, 4096
    buffer_load_dwordx4 v[88:91], v1, s[44:47], s75 offen sc1
    s_cmp_gt_u32 s82, 5
    s_cselect_b32 s75, s79, s83
    s_add_u32 s75, s75, 5120
    buffer_load_dwordx4 v[92:95], v1, s[44:47], s75 offen sc1
    s_cmp_gt_u32 s82, 6
    s_cselect_b32 s75, s79, s83
    s_add_u32 s75, s75, 6144
    buffer_load_dwordx4 v[96:99], v1, s[44:47], s75 offen sc1
    s_cmp_gt_u32 s82, 7
    s_cselect_b32 s75, s79, s83
    s_add_u32 s75, s75, 7168
    buffer_load_dwordx4 v[100:103], v1, s[44:47], s75 offen sc1
    s_waitcnt vmcnt(0)
    v_max_u32 v14, v80, v84
    v_cmp_eq_u32 vcc, -1, v14
    s_cbranch_vccnz L_h_stub_116
    s_branch L_h_ok_115
L_h_stub_118:
    s_cmp_eq_u32 s62, 0
    s_cbranch_scc1 L_h_ok_117
    s_sub_u32 s62, s62, 1
    s_waitcnt vmcnt(0)
    s_sleep 2
    s_cmp_gt_u32 s82, 4
    s_cselect_b32 s75, s79, s83
    s_add_u32 s75, s75, 4096
    buffer_load_dwordx4 v[88:91], v1, s[44:47], s75 offen sc1
    s_cmp_gt_u32 s82, 5
    s_cselect_b32 s75, s79, s83
    s_add_u32 s75, s75, 5120
    buffer_load_dwordx4 v[92:95], v1, s[44:47], s75 offen sc1
    s_cmp_gt_u32 s82, 6
    s_cselect_b32 s75, s79, s83
    s_add_u32 s75, s75, 6144
    buffer_load_dwordx4 v[96:99], v1, s[44:47], s75 offen sc1
    s_cmp_gt_u32 s82, 7
    s_cselect_b32 s75, s79, s83
    s_add_u32 s75, s75, 7168
    buffer_load_dwordx4 v[100:103], v1, s[44:47], s75 offen sc1
    s_cmp_gt_u32 s82, 8
    s_cselect_b32 s75, s79, s83
    s_add_u32 s75, s75, 8192
    buffer_load_dwordx4 v[104:107], v1, s[44:47], s75 offen sc1
    s_cmp_gt_u32 s82, 9
    s_cselect_b32 s75, s79, s83
    s_add_u32 s75, s75, 9216
    buffer_load_dwordx4 v[108:111], v1, s[44:47], s75 offen sc1
    s_waitcnt vmcnt(0)
    v_max_u32 v14, v88, v92
    v_cmp_eq_u32 vcc, -1, v14
    s_cbranch_vccnz L_h_stub_118
    s_branch L_h_ok_117
L_h_stub_120:
    s_cmp_eq_u32 s62, 0
    s_cbranch_scc1 L_h_ok_119
    s_sub_u32 s62, s62, 1
    s_waitcnt vmcnt(0)
    s_sleep 2
    s_cmp_gt_u32 s82, 6
    s_cselect_b32 s75, s79, s83
    s_add_u32 s75, s75, 6144
    buffer_load_dwordx4 v[96:99], v1, s[44:47], s75 offen sc1
    s_cmp_gt_u32 s82, 7
    s_cselect_b32 s75, s79, s83
    s_add_u32 s75, s75, 7168
    buffer_load_dwordx4 v[100:103], v1, s[44:47], s75 offen sc1
    s_cmp_gt_u32 s82, 8
    s_cselect_b32 s75, s79, s83
    s_add_u32 s75, s75, 8192
    buffer_load_dwordx4 v[104:107], v1, s[44:47], s75 offen sc1
    s_cmp_gt_u32 s82, 9
    s_cselect_b32 s75, s79, s83
    s_add_u32 s75, s75, 9216
    buffer_load_dwordx4 v[108:111], v1, s[44:47], s75 offen sc1
    s_cmp_gt_u32 s82, 10
    s_cselect_b32 s75, s79, s83
    s_add_u32 s75, s75, 10240
    buffer_load_dwordx4 v[112:115], v1, s[44:47], s75 offen sc1
    s_cmp_gt_u32 s82, 11
    s_cselect_b32 s75, s79, s83
    s_add_u32 s75, s75, 11264
    buffer_load_dwordx4 v[116:119], v1, s[44:47], s75 offen sc1
    s_waitcnt vmcnt(0)
    v_max_u32 v14, v96, v100
    v_cmp_eq_u32 vcc, -1, v14
    s_cbranch_vccnz L_h_stub_120
    s_branch L_h_ok_119
L_h_stub_122:
    s_cmp_eq_u32 s62, 0
    s_cbranch_scc1 L_h_ok_121
    s_sub_u32 s62, s62, 1
    s_waitcnt vmcnt(0)
    s_sleep 2
    s_cmp_gt_u32 s82, 8
    s_cselect_b32 s75, s79, s83
    s_add_u32 s75, s75, 8192
    buffer_load_dwordx4 v[104:107], v1, s[44:47], s75 offen sc1
    s_cmp_gt_u32 s82, 9
    s_cselect_b32 s75, s79, s83
    s_add_u32 s75, s75, 9216
    buffer_load_dwordx4 v[108:111], v1, s[44:47], s75 offen sc1
    s_cmp_gt_u32 s82, 10
    s_cselect_b32 s75, s79, s83
    s_add_u32 s75, s75, 10240
    buffer_load_dwordx4 v[112:115], v1, s[44:47], s75 offen sc1
    s_cmp_gt_u32 s82, 11
    s_cselect_b32 s75, s79, s83
    s_add_u32 s75, s75, 11264
    buffer_load_dwordx4 v[116:119], v1, s[44:47], s75 offen sc1
    s_cmp_gt_u32 s82, 12
    s_cselect_b32 s75, s79, s83
    s_add_u32 s75, s75, 12288
    buffer_load_dwordx4 v[120:123], v1, s[44:47], s75 offen sc1
    s_cmp_gt_u32 s82, 13
    s_cselect_b32 s75, s79, s83
    s_add_u32 s75, s75, 13312
    buffer_load_dwordx4 v[124:127], v1, s[44:47], s75 offen sc1
    s_waitcnt vmcnt(0)
    v_max_u32 v14, v104, v108
    v_cmp_eq_u32 vcc, -1, v14
    s_cbranch_vccnz L_h_stub_122
    s_branch L_h_ok_121
L_h_stub_124:
    s_cmp_eq_u32 s62, 0
    s_cbranch_scc1 L_h_ok_123
    s_sub_u32 s62, s62, 1
    s_waitcnt vmcnt(0)
    s_sleep 2
    s_cmp_gt_u32 s82, 10
    s_cselect_b32 s75, s79, s83
    s_add_u32 s75, s75, 10240
    buffer_load_dwordx4 v[112:115], v1, s[44:47], s75 offen sc1
    s_cmp_gt_u32 s82, 11
    s_cselect_b32 s75, s79, s83
    s_add_u32 s75, s75, 11264
    buffer_load_dwordx4 v[116:119], v1, s[44:47], s75 offen sc1
    s_cmp_gt_u32 s82, 12
    s_cselect_b32 s75, s79, s83
    s_add_u32 s75, s75, 12288
    buffer_load_dwordx4 v[120:123], v1, s[44:47], s75 offen sc1
    s_cmp_gt_u32 s82, 13
    s_cselect_b32 s75, s79, s83
    s_add_u32 s75, s75, 13312
    buffer_load_dwordx4 v[124:127], v1, s[44:47], s75 offen sc1
    s_cmp_gt_u32 s82, 14
    s_cselect_b32 s75, s79, s83
    s_add_u32 s75, s75, 14336
    buffer_load_dwordx4 v[160:163], v1, s[44:47], s75 offen sc1
    s_cmp_gt_u32 s82, 15
    s_cselect_b32 s75, s79, s83
    s_add_u32 s75, s75, 15360
    buffer_load_dwordx4 v[164:167], v1, s[44:47], s75 offen sc1
    s_waitcnt vmcnt(0)
    v_max_u32 v14, v112, v116
    v_cmp_eq_u32 vcc, -1, v14
    s_cbranch_vccnz L_h_stub_124
    s_branch L_h_ok_123
L_h_stub_126:
    s_cmp_eq_u32 s62, 0
    s_cbranch_scc1 L_h_ok_125
    s_sub_u32 s62, s62, 1
    s_waitcnt vmcnt(0)
    s_sleep 2
    s_cmp_gt_u32 s82, 12
    s_cselect_b32 s75, s79, s83
    s_add_u32 s75, s75, 12288
    buffer_load_dwordx4 v[120:123], v1, s[44:47], s75 offen sc1
    s_cmp_gt_u32 s82, 13
    s_cselect_b32 s75, s79, s83
    s_add_u32 s75, s75, 13312
    buffer_load_dwordx4 v[124:127], v1, s[44:47], s75 offen sc1
    s_cmp_gt_u32 s82, 14
    s_cselect_b32 s75, s79, s83
    s_add_u32 s75, s75, 14336
    buffer_load_dwordx4 v[160:163], v1, s[44:47], s75 offen sc1
    s_cmp_gt_u32 s82, 15
    s_cselect_b32 s75, s79, s83
    s_add_u32 s75, s75, 15360
    buffer_load_dwordx4 v[164:167], v1, s[44:47], s75 offen sc1
    s_cmp_gt_u32 s82, 16
    s_cselect_b32 s75, s79, s83
    s_add_u32 s75, s75, 16384
    buffer_load_dwordx4 v[168:171], v1, s[44:47], s75 offen sc1
    s_cmp_gt_u32 s82, 17
    s_cselect_b32 s75, s79, s83
    s_add_u32 s75, s75, 17408
    buffer_load_dwordx4 v[172:175], v1, s[44:47], s75 offen sc1
    s_waitcnt vmcnt(0)
    v_max_u32 v14, v120, v124
    v_cmp_eq_u32 vcc, -1, v14
    s_cbranch_vccnz L_h_stub_126
    s_branch L_h_ok_125
L_h_stub_128:
    s_cmp_eq_u32 s62, 0
    s_cbranch_scc1 L_h_ok_127
    s_sub_u32 s62, s62, 1
    s_waitcnt vmcnt(0)
    s_sleep 2
    s_cmp_gt_u32 s82, 14
    s_cselect_b32 s75, s79, s83
    s_add_u32 s75, s75, 14336
    buffer_load_dwordx4 v[160:163], v1, s[44:47], s75 offen sc1
    s_cmp_gt_u32 s82, 15
    s_cselect_b32 s75, s79, s83
    s_add_u32 s75, s75, 15360
    buffer_load_dwordx4 v[164:167], v1, s[44:47], s75 offen sc1
    s_cmp_gt_u32 s82, 16
    s_cselect_b32 s75, s79, s83
    s_add_u32 s75, s75, 16384
    buffer_load_dwordx4 v[168:171], v1, s[44:47], s75 offen sc1
    s_cmp_gt_u32 s82, 17
    s_cselect_b32 s75, s79, s83
    s_add_u32 s75, s75, 17408
    buffer_load_dwordx4 v[172:175], v1, s[44:47], s75 offen sc1
    s_cmp_gt_u32 s82, 18
    s_cselect_b32 s75, s79, s83
    s_add_u32 s75, s75, 18432
    buffer_load_dwordx4 v[176:179], v1, s[44:47], s75 offen sc1
    s_cmp_gt_u32 s82, 19
    s_cselect_b32 s75, s79, s83
    s_add_u32 s75, s75, 19456
    buffer_load_dwordx4 v[180:183], v1, s[44:47], s75 offen sc1
    s_waitcnt vmcnt(0)
    v_max_u32 v14, v160, v164
    v_cmp_eq_u32 vcc, -1, v14
    s_cbranch_vccnz L_h_stub_128
    s_branch L_h_ok_127
L_h_stub_130:
    s_cmp_eq_u32 s62, 0
    s_cbranch_scc1 L_h_ok_129
    s_sub_u32 s62, s62, 1
    s_waitcnt vmcnt(0)
    s_sleep 2
    s_cmp_gt_u32 s82, 16
    s_cselect_b32 s75, s79, s83
    s_add_u32 s75, s75, 16384
    buffer_load_dwordx4 v[168:171], v1, s[44:47], s75 offen sc1
    s_cmp_gt_u32 s82, 17
    s_cselect_b32 s75, s79, s83
    s_add_u32 s75, s75, 17408
    buffer_load_dwordx4 v[172:175], v1, s[44:47], s75 offen sc1
    s_cmp_gt_u32 s82, 18
    s_cselect_b32 s75, s79, s83
    s_add_u32 s75, s75, 18432
    buffer_load_dwordx4 v[176:179], v1, s[44:47], s75 offen sc1
    s_cmp_gt_u32 s82, 19
    s_cselect_b32 s75, s79, s83
    s_add_u32 s75, s75, 19456
    buffer_load_dwordx4 v[180:183], v1, s[44:47], s75 offen sc1
    s_cmp_gt_u32 s82, 20
    s_cselect_b32 s75, s79, s83
    s_add_u32 s75, s75, 20480
    buffer_load_dwordx4 v[184:187], v1, s[44:47], s75 offen sc1
    s_cmp_gt_u32 s82, 21
    s_cselect_b32 s75, s79, s83
    s_add_u32 s75, s75, 21504
    s_cmp_lt_u32 s55, 2
    s_cselect_b32 s75, s75, 1073741824
    buffer_load_dwordx4 v[188:191], v1, s[44:47], s75 offen sc1
    s_waitcnt vmcnt(0)
    v_max_u32 v14, v168, v172
    v_cmp_eq_u32 vcc, -1, v14
    s_cbranch_vccnz L_h_stub_130
    s_branch L_h_ok_129
L_h_stub_132:
    s_cmp_eq_u32 s62, 0
    s_cbranch_scc1 L_h_ok_131
    s_sub_u32 s62, s62, 1
    s_waitcnt vmcnt(0)
    s_sleep 2
    s_cmp_gt_u32 s82, 18
    s_cselect_b32 s75, s79, s83
    s_add_u32 s75, s75, 18432
    buffer_load_dwordx4 v[176:179], v1, s[44:47], s75 offen sc1
    s_cmp_gt_u32 s82, 19
    s_cselect_b32 s75, s79, s83
    s_add_u32 s75, s75, 19456
    buffer_load_dwordx4 v[180:183], v1, s[44:47], s75 offen sc1
    s_cmp_gt_u32 s82, 20
    s_cselect_b32 s75, s79, s83
    s_add_u32 s75, s75, 20480
    buffer_load_dwordx4 v[184:187], v1, s[44:47], s75 offen sc1
    s_cmp_gt_u32 s82, 21
    s_cselect_b32 s75, s79, s83
    s_add_u32 s75, s75, 21504
    s_cmp_lt_u32 s55, 2
    s_cselect_b32 s75, s75, 1073741824
    buffer_load_dwordx4 v[188:191], v1, s[44:47], s75 offen sc1
    s_waitcnt vmcnt(0)
    v_max_u32 v14, v176, v180
    v_cmp_eq_u32 vcc, -1, v14
    s_cbranch_vccnz L_h_stub_132
    s_branch L_h_ok_131
L_h_stub_134:
    s_cmp_eq_u32 s62, 0
    s_cbranch_scc1 L_h_ok_133
    s_sub_u32 s62, s62, 1
    s_waitcnt vmcnt(0)
    s_sleep 2
    s_cmp_gt_u32 s82, 20
    s_cselect_b32 s75, s79, s83
    s_add_u32 s75, s75, 20480
    buffer_load_dwordx4 v[184:187], v1, s[44:47], s75 offen sc1
    s_cmp_gt_u32 s82, 21
    s_cselect_b32 s75, s79, s83
    s_add_u32 s75, s75, 21504
    s_cmp_lt_u32 s55, 2
    s_cselect_b32 s75, s75, 1073741824
    buffer_load_dwordx4 v[188:191], v1, s[44:47], s75 offen sc1
    s_waitcnt vmcnt(0)
    v_max_u32 v14, v184, v188
    v_cmp_eq_u32 vcc, -1, v14
    s_cbranch_vccnz L_h_stub_134
    s_branch L_h_ok_133
L_code_end:
    s_endpgm
.section .rodata,"a"
.p2align 6
.amdhsa_kernel adaLN_cond__grouped_kv_mqa__glu_gated_reglu__prompt_kernel
  .amdhsa_next_free_vgpr 256
  .amdhsa_next_free_sgpr 102
  .amdhsa_accum_offset 256
  .amdhsa_group_segment_fixed_size 0
  .amdhsa_kernarg_size 112
  .amdhsa_user_sgpr_count 2
  .amdhsa_user_sgpr_kernarg_segment_ptr 1
  .amdhsa_system_sgpr_workgroup_id_x 1
.end_amdhsa_kernel
```
